```python
import torch

def _softmax(x, axis=-1):
    return torch.softmax(x, dim=axis)
def _gelu(x):
    return torch.nn.functional.gelu(x, approximate="tanh")
def _silu(x):
    return torch.nn.functional.silu(x)
def _sigmoid(x):
    return torch.sigmoid(x)
def _layernorm(x, axis=-1, eps=1e-5):
    m = x.mean(dim=axis, keepdim=True)
    v = x.var(dim=axis, keepdim=True, unbiased=False)
    return (x - m) / torch.sqrt(v + eps)
def _scatter_add(tgt, idx, src, axis=0):
    return tgt.clone().index_add_(axis, idx, src)
def _segment_sum(src, seg, n):
    out = torch.zeros((n,) + src.shape[1:], dtype=src.dtype)
    return out.index_add_(0, seg, src)
def _pad(x, pw):
    flat = tuple(v for pair in reversed(pw) for v in pair)
    return torch.nn.functional.pad(x, flat)

kernel_name = 'standalone__gqa_block_cached__near_ridge'

def setup_inputs():

    _w = (lambda a: (lambda t: t.to(torch.bfloat16) if t.is_floating_point() else t)(torch.as_tensor(a)))
    B, Sq, D = 8, 128, 640
    Hq, Hkv, Sk, Dh = 32, 32, 512, 128
    assert Hq % Hkv == 0, (Hq, Hkv)
    return {
        "x": _w((lambda *s: torch.randn(*s, dtype=torch.bfloat16) * 0.8)(B, Sq, D)),
        "k_cache": _w((lambda *s: torch.randn(*s, dtype=torch.bfloat16) * 0.8)(B, Hkv, Sk, Dh)),
        "v_cache": _w((lambda *s: torch.randn(*s, dtype=torch.bfloat16) * 0.05)(B, Hkv, Sk, Dh)),
        "wq": _w((lambda *s: torch.randn(*s, dtype=torch.bfloat16) * 0.8)(D, Hq * Dh) * (D ** -0.5)),
        "wo": _w((lambda *s: torch.randn(*s, dtype=torch.bfloat16) * 0.05)(Hq * Dh, D) * ((Hq * Dh) ** -0.5)),
    }

def reference(x, k_cache, v_cache, wq, wo):
    B, Sq, D = x.shape
    Hq, Dh = 32, 128
    Hkv = k_cache.shape[1]
    rep = Hq // Hkv
    q = (lambda x, *d: x.permute(*d))((x @ wq).reshape(B, Sq, Hq, Dh), 0, 2, 1, 3)
    k = (lambda x, n, axis: torch.repeat_interleave(x, n, dim=axis))(k_cache, rep, axis=1)
    v = (lambda x, n, axis: torch.repeat_interleave(x, n, dim=axis))(v_cache, rep, axis=1)
    scores = torch.einsum("bhqd,bhkd->bhqk", q, k) * (Dh ** -0.5)
    p = _softmax(scores, axis=-1)
    o = torch.einsum("bhqk,bhkd->bhqd", p, v)
    return (lambda x, *d: x.permute(*d))(o, 0, 2, 1, 3).reshape(B, Sq, Hq * Dh) @ wo
```

```asm
; @launch grid=(256,1,1) block=(256,1,1) lds=163840
.amdgcn_target "amdgcn-amd-amdhsa--gfx950"
.text
.globl standalone__gqa_block_cached__near_ridge_kernel
.p2align 8
.type standalone__gqa_block_cached__near_ridge_kernel,@function
standalone__gqa_block_cached__near_ridge_kernel:
  s_cmp_ge_u32 s2, 256
  s_cbranch_scc1 L_done
  s_load_dwordx16 s[64:79], s[0:1], 0
  s_getpc_b64 s[100:101]
  s_and_b32 s100, s100, 0xffffff00
  s_lshr_b32 s99, s2, 3
  s_lshl_b32 s99, s99, 10
  v_and_b32 v3, 63, v0
  v_lshlrev_b32 v3, 4, v3
  v_lshrrev_b32 v4, 6, v0
  v_lshl_add_u32 v3, v4, 15, v3
  v_add_u32 v3, s99, v3
  v_min_u32 v3, (L_done-standalone__gqa_block_cached__near_ridge_kernel-16)&0xfffffff0, v3
  v_mov_b32 v5, s101
  v_add_co_u32 v4, vcc, s100, v3
  v_addc_co_u32 v5, vcc, 0, v5, vcc
  global_load_dwordx4 a[252:255], v[4:5], off
  v_lshrrev_b32 v1, 6, v0
  v_and_b32 v24, 63, v0
  v_readfirstlane_b32 s3, v1
  s_and_b32 s100, s2, 1
  s_lshl_b32 s100, s100, 2
  s_bfe_u32 s101, s2, 0x20003
  s_add_u32 s4, s100, s101
  s_bfe_u32 s5, s2, 0x20001
  s_lshr_b32 s6, s2, 5
  s_lshl_b32 s7, s5, 3
  s_add_u32 s7, s7, s6
  s_lshr_b32 s62, s101, 1
  s_and_b32 s62, s62, 1
  s_lshl_b32 s100, s101, 2
  s_lshr_b32 s34, 0x8530, s100
  s_and_b32 s34, s34, 15
  s_add_u32 s34, s34, s6
  s_cmp_ge_u32 s34, 10
  s_cselect_b32 s100, 10, 0
  s_sub_u32 s34, s34, s100
  s_and_b32 s100, s2, 1
  s_mul_i32 s100, s100, 4
  s_mul_i32 s34, s5, 2
  s_add_u32 s34, s34, s100
  s_cmp_ge_u32 s34, 10
  s_cselect_b32 s100, 10, 0
  s_sub_u32 s34, s34, s100
  s_lshl_b32 s28, s3, 12
  v_lshrrev_b32 v25, 4, v24
  v_and_b32 v26, 15, v24
  v_lshrrev_b32 v27, 3, v24
  s_lshl_b32 s29, s3, 5
  v_add_u32 v27, s29, v27
  v_mul_u32_u24 v27, 1280, v27
  v_and_b32 v28, 7, v24
  v_xor_b32 v29, v25, v28
  v_lshl_add_u32 v128, v29, 4, v27
  v_add_u32 v130, 18432, v128
  v_xor_b32 v29, 64, v128
  v_add_u32 v129, 9216, v29
  v_add_u32 v131, 27648, v29
  v_lshlrev_b32 v27, 2, v25
  v_xor_b32 v27, v27, v26
  v_lshlrev_b32 v27, 4, v27
  s_lshl_b32 s29, s3, 17
  v_lshl_add_u32 v132, v25, 13, s29
  v_add_u32 v132, v132, v27
  v_add_u32 v133, 31744, v132
  v_add_u32 v134, 63488, v132
  v_add_u32 v135, 95232, v132
  v_lshl_add_u32 v28, v25, 8, s28
  v_add_u32 v6, v27, v28
  s_waitcnt lgkmcnt(0)
  s_mul_i32 s29, s4, 163840
  s_add_u32 s8, s64, s29
  s_addc_u32 s9, s65, 0
  s_mov_b32 s10, 163840
  s_mov_b32 s11, 0x20000
  s_lshl_b32 s29, s7, 8
  s_sub_u32 s30, 5242880, s29
  s_add_u32 s12, s70, s29
  s_addc_u32 s13, s71, 0
  s_mov_b32 s14, s30
  s_mov_b32 s15, 0x20000
  s_cmp_eq_u32 s62, 0
  s_cbranch_scc1 L_noxpf
  s_lshl_b32 s100, s6, 1
  s_bfe_u32 s101, s2, 65539
  s_add_u32 s100, s100, s101
  s_lshl_b32 s100, s100, 2
  s_add_u32 s100, s100, s3
  s_lshl_b32 s101, s100, 13
  v_lshl_add_u32 v140, v24, 4, s101
  s_lshr_b32 s101, s100, 5
  s_mul_i32 s101, s101, 163840
  s_and_b32 s100, s100, 31
  s_mul_i32 s100, s100, 5120
  s_add_u32 s101, s101, s100
  v_mul_u32_u24 v141, 1280, v25
  v_lshl_add_u32 v141, v26, 4, v141
  v_add_u32 v141, s101, v141
  s_mov_b32 s36, s34
  s_add_u32 s34, s6, 0
  s_and_b32 s100, s2, 1
  s_mul_i32 s100, s100, 655360
  s_add_u32 s16, s64, s100
  s_addc_u32 s17, s65, 0
  s_mov_b32 s18, 655360
  s_mov_b32 s19, 0x20000
  s_lshl_b32 s100, s5, 11
  s_sub_u32 s101, 5242880, s100
  s_add_u32 s20, s70, s100
  s_addc_u32 s21, s71, 0
  s_mov_b32 s22, s101
  s_mov_b32 s23, 0x20000
  s_lshl_b32 s100, s36, 7
  s_lshl_b32 s101, s36, 19
  s_add_u32 s36, s36, 1
  s_cmp_ge_u32 s36, 10
  s_cselect_b32 s36, 0, s36
  buffer_load_dwordx4 a[248:251], v140, s[20:23], s101 offen
  buffer_load_dwordx4 a[248:251], v141, s[16:19], s100 offen
  buffer_load_dwordx4 a[248:251], v140, s[20:23], s101 offen offset:1024
  s_lshl_b32 s100, s36, 7
  s_lshl_b32 s101, s36, 19
  s_add_u32 s36, s36, 1
  s_cmp_ge_u32 s36, 10
  s_cselect_b32 s36, 0, s36
  buffer_load_dwordx4 a[248:251], v140, s[20:23], s101 offen
  buffer_load_dwordx4 a[248:251], v140, s[20:23], s101 offen offset:1024
  s_lshl_b32 s100, s36, 7
  s_lshl_b32 s101, s36, 19
  s_add_u32 s36, s36, 1
  s_cmp_ge_u32 s36, 10
  s_cselect_b32 s36, 0, s36
  buffer_load_dwordx4 a[248:251], v140, s[20:23], s101 offen
  buffer_load_dwordx4 a[248:251], v141, s[16:19], s100 offen
  buffer_load_dwordx4 a[248:251], v140, s[20:23], s101 offen offset:1024
  s_lshl_b32 s100, s36, 7
  s_lshl_b32 s101, s36, 19
  s_add_u32 s36, s36, 1
  s_cmp_ge_u32 s36, 10
  s_cselect_b32 s36, 0, s36
  buffer_load_dwordx4 a[248:251], v140, s[20:23], s101 offen
  buffer_load_dwordx4 a[248:251], v140, s[20:23], s101 offen offset:1024
  s_lshl_b32 s100, s36, 7
  s_lshl_b32 s101, s36, 19
  s_add_u32 s36, s36, 1
  s_cmp_ge_u32 s36, 10
  s_cselect_b32 s36, 0, s36
  buffer_load_dwordx4 a[248:251], v140, s[20:23], s101 offen
  buffer_load_dwordx4 a[248:251], v141, s[16:19], s100 offen
  buffer_load_dwordx4 a[248:251], v140, s[20:23], s101 offen offset:1024
  s_lshl_b32 s100, s36, 7
  s_lshl_b32 s101, s36, 19
  s_add_u32 s36, s36, 1
  s_cmp_ge_u32 s36, 10
  s_cselect_b32 s36, 0, s36
  buffer_load_dwordx4 a[248:251], v140, s[20:23], s101 offen
  buffer_load_dwordx4 a[248:251], v140, s[20:23], s101 offen offset:1024
  s_lshl_b32 s100, s36, 7
  s_lshl_b32 s101, s36, 19
  s_add_u32 s36, s36, 1
  s_cmp_ge_u32 s36, 10
  s_cselect_b32 s36, 0, s36
  buffer_load_dwordx4 a[248:251], v140, s[20:23], s101 offen
  buffer_load_dwordx4 a[248:251], v141, s[16:19], s100 offen
  buffer_load_dwordx4 a[248:251], v140, s[20:23], s101 offen offset:1024
  s_lshl_b32 s100, s36, 7
  s_lshl_b32 s101, s36, 19
  s_add_u32 s36, s36, 1
  s_cmp_ge_u32 s36, 10
  s_cselect_b32 s36, 0, s36
  buffer_load_dwordx4 a[248:251], v140, s[20:23], s101 offen
  buffer_load_dwordx4 a[248:251], v140, s[20:23], s101 offen offset:1024
  s_lshl_b32 s100, s36, 7
  s_lshl_b32 s101, s36, 19
  s_add_u32 s36, s36, 1
  s_cmp_ge_u32 s36, 10
  s_cselect_b32 s36, 0, s36
  buffer_load_dwordx4 a[248:251], v140, s[20:23], s101 offen
  buffer_load_dwordx4 a[248:251], v141, s[16:19], s100 offen
  buffer_load_dwordx4 a[248:251], v140, s[20:23], s101 offen offset:1024
  s_lshl_b32 s100, s36, 7
  s_lshl_b32 s101, s36, 19
  s_add_u32 s36, s36, 1
  s_cmp_ge_u32 s36, 10
  s_cselect_b32 s36, 0, s36
  buffer_load_dwordx4 a[248:251], v140, s[20:23], s101 offen
  buffer_load_dwordx4 a[248:251], v140, s[20:23], s101 offen offset:1024
  v_add_u32 v27, 0, v25
  v_xor_b32 v27, v27, v26
  v_lshl_add_u32 v2, v27, 4, v28
  v_add_u32 v27, 4, v25
  v_xor_b32 v27, v27, v26
  v_lshl_add_u32 v3, v27, 4, v28
  v_add_u32 v27, 8, v25
  v_xor_b32 v27, v27, v26
  v_lshl_add_u32 v4, v27, 4, v28
  v_add_u32 v27, 12, v25
  v_xor_b32 v27, v27, v26
  v_lshl_add_u32 v5, v27, 4, v28
  s_lshl_b32 s30, s4, 5
  s_add_u32 s30, s30, s7
  s_lshl_b32 s29, s30, 17
  s_add_u32 s16, s66, s29
  s_addc_u32 s17, s67, 0
  s_mov_b32 s18, 131072
  s_mov_b32 s19, 0x20000
  s_add_u32 s20, s68, s29
  s_addc_u32 s21, s69, 0
  s_mov_b32 s22, 131072
  s_mov_b32 s23, 0x20000
  s_add_u32 m0, s28, 147456
  s_mov_b32 s31, 0
  buffer_load_dwordx4 v2, s[16:19], s31 offen offset:0 nt lds
  s_add_u32 m0, s28, 147456
  s_nop 0
  buffer_load_dwordx4 v3, s[16:19], s31 offen offset:1024 nt lds
  s_add_u32 m0, s28, 147456
  s_nop 0
  buffer_load_dwordx4 v4, s[16:19], s31 offen offset:2048 nt lds
  s_add_u32 m0, s28, 147456
  s_nop 0
  buffer_load_dwordx4 v5, s[16:19], s31 offen offset:3072 nt lds
  s_add_u32 m0, s28, 81920
  s_mov_b32 s31, 16384
  buffer_load_dwordx4 v2, s[16:19], s31 offen offset:0 nt lds
  s_add_u32 m0, s28, 81920
  s_nop 0
  buffer_load_dwordx4 v3, s[16:19], s31 offen offset:1024 nt lds
  s_add_u32 m0, s28, 81920
  s_nop 0
  buffer_load_dwordx4 v4, s[16:19], s31 offen offset:2048 nt lds
  s_add_u32 m0, s28, 81920
  s_nop 0
  buffer_load_dwordx4 v5, s[16:19], s31 offen offset:3072 nt lds
L_noxpf:
  s_add_u32 m0, s28, 0
  s_lshl_b32 s36, s34, 7
  s_lshl_b32 s37, s34, 19
  s_add_u32 s34, s34, 1
  s_cmp_ge_u32 s34, 10
  s_cselect_b32 s34, 0, s34
  buffer_load_dwordx4 v128, s[8:11], s36 offen offset:0 lds
  buffer_load_dwordx4 v129, s[8:11], s36 offen offset:1024 lds
  buffer_load_dwordx4 v130, s[8:11], s36 offen offset:2048 lds
  buffer_load_dwordx4 v131, s[8:11], s36 offen offset:3072 lds
  s_add_u32 m0, s28, 49152
  s_nop 0
  buffer_load_dwordx4 v132, s[12:15], s37 offen offset:0 lds
  buffer_load_dwordx4 v133, s[12:15], s37 offen offset:1024 lds
  buffer_load_dwordx4 v134, s[12:15], s37 offen offset:2048 lds
  buffer_load_dwordx4 v135, s[12:15], s37 offen offset:3072 lds
  s_add_u32 m0, s28, 16384
  s_lshl_b32 s36, s34, 7
  s_lshl_b32 s37, s34, 19
  s_add_u32 s34, s34, 1
  s_cmp_ge_u32 s34, 10
  s_cselect_b32 s34, 0, s34
  buffer_load_dwordx4 v128, s[8:11], s36 offen offset:0 lds
  buffer_load_dwordx4 v129, s[8:11], s36 offen offset:1024 lds
  buffer_load_dwordx4 v130, s[8:11], s36 offen offset:2048 lds
  buffer_load_dwordx4 v131, s[8:11], s36 offen offset:3072 lds
  v_add_u32 v27, 0, v25
  v_xor_b32 v27, v27, v26
  v_lshl_add_u32 v2, v27, 4, v28
  v_add_u32 v27, 4, v25
  v_xor_b32 v27, v27, v26
  v_lshl_add_u32 v3, v27, 4, v28
  v_add_u32 v27, 8, v25
  v_xor_b32 v27, v27, v26
  v_lshl_add_u32 v4, v27, 4, v28
  v_add_u32 v27, 12, v25
  v_xor_b32 v27, v27, v26
  v_lshl_add_u32 v5, v27, 4, v28
  s_lshl_b32 s30, s4, 5
  s_add_u32 s30, s30, s7
  s_lshl_b32 s29, s30, 17
  s_add_u32 s16, s66, s29
  s_addc_u32 s17, s67, 0
  s_mov_b32 s18, 131072
  s_mov_b32 s19, 0x20000
  s_add_u32 s20, s68, s29
  s_addc_u32 s21, s69, 0
  s_mov_b32 s22, 131072
  s_mov_b32 s23, 0x20000
  s_mul_i32 s29, s5, 1310720
  s_lshl_b32 s100, s6, 1
  s_bfe_u32 s101, s2, 65539
  s_add_u32 s100, s100, s101
  s_lshl_b32 s100, s100, 2
  s_add_u32 s100, s100, s3
  s_mul_i32 s100, s100, 20480
  s_add_u32 s29, s29, s100
  s_add_u32 s24, s72, s29
  s_addc_u32 s25, s73, 0
  s_mov_b32 s26, 20480
  s_mov_b32 s27, 0x20000
  s_mov_b32 s84, s76
  s_mov_b32 s85, s77
  s_mov_b32 s86, 256
  s_mov_b32 s87, 0x20000
  s_mul_i32 s29, s5, 1310720
  s_lshl_b32 s100, s6, 2
  s_and_b32 s101, s100, 24
  s_mov_b32 s60, 0x76543210
  s_mov_b32 s61, s60
  s_lshr_b64 s[60:61], s[60:61], s101
  s_sub_u32 s100, s100, s101
  s_bfm_b32 s101, s100, 0
  s_and_b32 s61, s60, s101
  s_lshl_b32 s61, s61, 4
  s_lshl_b32 s101, -16, s100
  s_and_b32 s60, s60, s101
  s_or_b32 s60, s60, s61
  s_or_b32 s60, s60, s6
  s_mul_i32 s30, s6, 160
  s_add_u32 s29, s29, s30
  s_sub_u32 s30, 5242880, s29
  s_add_u32 s80, s72, s29
  s_addc_u32 s81, s73, 0
  s_mov_b32 s82, s30
  s_mov_b32 s83, 0x20000
  s_mov_b32 s29, 29360128
  s_add_u32 s88, s78, s29
  s_addc_u32 s89, s79, 0
  s_mov_b32 s90, 262272
  s_mov_b32 s91, 0x20000
  s_lshl_b32 s29, s4, 3
  s_add_u32 s29, s29, s6
  s_mul_i32 s29, s29, 81920
  s_add_u32 s29, s29, 16777216
  s_add_u32 s96, s78, s29
  s_addc_u32 s97, s79, 0
  s_mov_b32 s98, 81920
  s_mov_b32 s99, 0x20000
  s_lshl_b32 s33, s5, 2
  s_add_u32 s33, s33, s3
  s_mul_i32 s33, s33, 5120
  v_and_b32 v25, 31, v24
  v_lshrrev_b32 v26, 5, v24
  v_bfe_u32 v27, v24, 1, 3
  v_xor_b32 v27, v27, v26
  v_lshlrev_b32 v27, 4, v27
  v_lshl_add_u32 v28, v25, 7, s28
  v_add_u32 v7, v27, v28
  v_and_b32 v27, 19, v25
  v_bfe_u32 v28, v25, 2, 1
  v_lshl_or_b32 v27, v28, 3, v27
  v_bfe_u32 v28, v25, 3, 1
  v_lshl_or_b32 v27, v28, 2, v27
  v_and_b32 v28, 15, v27
  v_xor_b32 v28, v28, v26
  v_lshlrev_b32 v28, 4, v28
  v_lshl_add_u32 v9, v27, 8, v28
  v_bfe_u32 v27, v24, 2, 2
  v_mul_u32_u24 v27, 320, v27
  v_lshl_add_u32 v27, v26, 11, v27
  v_bfe_u32 v28, v24, 4, 1
  v_lshl_add_u32 v27, v28, 5, v27
  v_and_b32 v28, 1, v24
  v_lshl_add_u32 v27, v28, 4, v27
  v_bfe_u32 v28, v24, 1, 1
  v_lshl_add_u32 v8, v28, 3, v27
  v_lshlrev_b32 v10, 4, v24
  s_mov_b32 s32, 1040356334
  s_add_u32 m0, s28, 65536
  s_nop 0
  buffer_load_dwordx4 v132, s[12:15], s37 offen offset:0 lds
  buffer_load_dwordx4 v133, s[12:15], s37 offen offset:1024 lds
  buffer_load_dwordx4 v134, s[12:15], s37 offen offset:2048 lds
  buffer_load_dwordx4 v135, s[12:15], s37 offen offset:3072 lds
  s_mov_b32 s100, 262144
  buffer_load_dword v11, off, s[88:91], s100 sc1
  v_or_b32 v1, s2, v0
  v_mov_b32 v25, 0x7fffffff
  v_cmp_eq_u32 vcc, 0, v1
  s_nop 1
  v_cndmask_b32 v30, v25, 0, vcc
  v_and_b32 v25, 7, v24
  s_and_b32 s100, s2, 31
  s_lshl_b32 s100, s100, 10
  v_lshl_add_u32 v31, v25, 15, s100
  v_add_u32 v25, 0, v24
  v_mul_u32_u24 v26, 6554, v25
  v_lshrrev_b32 v26, 16, v26
  v_mul_u32_u24 v27, 10, v26
  v_sub_u32 v27, v25, v27
  v_mul_u32_u24 v26, 1280, v26
  v_lshl_add_u32 v0, v27, 4, v26
  v_add_u32 v25, 64, v24
  v_mul_u32_u24 v26, 6554, v25
  v_lshrrev_b32 v26, 16, v26
  v_mul_u32_u24 v27, 10, v26
  v_sub_u32 v27, v25, v27
  v_mul_u32_u24 v26, 1280, v26
  v_lshl_add_u32 v26, v27, 4, v26
  v_subrev_u32 v1, 1024, v26
  v_add_u32 v25, 128, v24
  v_mul_u32_u24 v26, 6554, v25
  v_lshrrev_b32 v26, 16, v26
  v_mul_u32_u24 v27, 10, v26
  v_sub_u32 v27, v25, v27
  v_mul_u32_u24 v26, 1280, v26
  v_lshl_add_u32 v26, v27, 4, v26
  v_subrev_u32 v23, 2048, v26
  v_add_u32 v25, 192, v24
  v_mul_u32_u24 v26, 6554, v25
  v_lshrrev_b32 v26, 16, v26
  v_mul_u32_u24 v27, 10, v26
  v_sub_u32 v27, v25, v27
  v_mul_u32_u24 v26, 1280, v26
  v_lshl_add_u32 v26, v27, 4, v26
  v_subrev_u32 v26, 3072, v26
  v_accvgpr_write_b32 a64, v26
  v_add_u32 v25, 256, v24
  v_mul_u32_u24 v26, 6554, v25
  v_lshrrev_b32 v26, 16, v26
  v_mul_u32_u24 v27, 10, v26
  v_sub_u32 v27, v25, v27
  v_mul_u32_u24 v26, 1280, v26
  v_lshl_add_u32 v29, v27, 4, v26
  s_cmp_eq_u32 s62, 0
  s_cbranch_scc1 L_roleA
  s_waitcnt vmcnt(9)
  s_barrier
  v_add_u32 v12, 49152, v8
  v_add_u32 v16, 0, v7
  v_xor_b32 v13, 64, v12
  v_xor_b32 v17, 32, v16
  v_xor_b32 v14, 128, v12
  v_xor_b32 v18, 64, v16
  v_xor_b32 v15, 192, v12
  v_xor_b32 v19, 96, v16
  ds_read_b128 a[32:35], v16
  ds_read_b64_tr_b16 a[0:1], v12 offset:0
  ds_read_b64_tr_b16 a[2:3], v12 offset:1024
  ds_read_b64_tr_b16 a[4:5], v13 offset:0
  ds_read_b64_tr_b16 a[6:7], v13 offset:1024
  ds_read_b64_tr_b16 a[8:9], v14 offset:0
  ds_read_b64_tr_b16 a[10:11], v14 offset:1024
  ds_read_b64_tr_b16 a[12:13], v15 offset:0
  ds_read_b64_tr_b16 a[14:15], v15 offset:1024
  ds_read_b128 a[36:39], v17
  ds_read_b64_tr_b16 a[16:17], v12 offset:4096
  ds_read_b64_tr_b16 a[18:19], v12 offset:5120
  ds_read_b64_tr_b16 a[20:21], v13 offset:4096
  ds_read_b64_tr_b16 a[22:23], v13 offset:5120
  s_waitcnt lgkmcnt(9)
  v_mfma_f32_32x32x16_bf16 v[64:79], a[0:3], a[32:35], 0
  ds_read_b64_tr_b16 a[24:25], v14 offset:4096
  ds_read_b64_tr_b16 a[26:27], v14 offset:5120
  s_add_u32 m0, s28, 32768
  s_lshl_b32 s36, s34, 7
  s_lshl_b32 s37, s34, 19
  s_add_u32 s34, s34, 1
  s_cmp_ge_u32 s34, 10
  s_cselect_b32 s34, 0, s34
  buffer_load_dwordx4 v128, s[8:11], s36 offen offset:0 lds
  v_mfma_f32_32x32x16_bf16 v[80:95], a[4:7], a[32:35], 0
  ds_read_b64_tr_b16 a[28:29], v15 offset:4096
  ds_read_b64_tr_b16 a[30:31], v15 offset:5120
  s_waitcnt lgkmcnt(9)
  v_mfma_f32_32x32x16_bf16 v[96:111], a[8:11], a[32:35], 0
  ds_read_b128 a[40:43], v18
  ds_read_b64_tr_b16 a[0:1], v12 offset:8192
  ds_read_b64_tr_b16 a[2:3], v12 offset:9216
  buffer_load_dwordx4 v129, s[8:11], s36 offen offset:1024 lds
  v_mfma_f32_32x32x16_bf16 v[112:127], a[12:15], a[32:35], 0
  ds_read_b64_tr_b16 a[4:5], v13 offset:8192
  ds_read_b64_tr_b16 a[6:7], v13 offset:9216
  s_waitcnt lgkmcnt(9)
  v_mfma_f32_32x32x16_bf16 v[64:79], a[16:19], a[36:39], v[64:79]
  ds_read_b64_tr_b16 a[8:9], v14 offset:8192
  ds_read_b64_tr_b16 a[10:11], v14 offset:9216
  buffer_load_dwordx4 v130, s[8:11], s36 offen offset:2048 lds
  v_mfma_f32_32x32x16_bf16 v[80:95], a[20:23], a[36:39], v[80:95]
  ds_read_b64_tr_b16 a[12:13], v15 offset:8192
  ds_read_b64_tr_b16 a[14:15], v15 offset:9216
  s_waitcnt lgkmcnt(9)
  v_mfma_f32_32x32x16_bf16 v[96:111], a[24:27], a[36:39], v[96:111]
  ds_read_b128 a[32:35], v19
  ds_read_b64_tr_b16 a[16:17], v12 offset:12288
  ds_read_b64_tr_b16 a[18:19], v12 offset:13312
  buffer_load_dwordx4 v131, s[8:11], s36 offen offset:3072 lds
  v_mfma_f32_32x32x16_bf16 v[112:127], a[28:31], a[36:39], v[112:127]
  ds_read_b64_tr_b16 a[20:21], v13 offset:12288
  ds_read_b64_tr_b16 a[22:23], v13 offset:13312
  s_waitcnt lgkmcnt(9)
  v_mfma_f32_32x32x16_bf16 v[64:79], a[0:3], a[40:43], v[64:79]
  ds_read_b64_tr_b16 a[24:25], v14 offset:12288
  ds_read_b64_tr_b16 a[26:27], v14 offset:13312
  s_add_u32 m0, s28, 131072
  s_nop 0
  buffer_load_dwordx4 v132, s[12:15], s37 offen offset:0 lds
  v_mfma_f32_32x32x16_bf16 v[80:95], a[4:7], a[40:43], v[80:95]
  ds_read_b64_tr_b16 a[28:29], v15 offset:12288
  ds_read_b64_tr_b16 a[30:31], v15 offset:13312
  s_waitcnt lgkmcnt(9)
  v_mfma_f32_32x32x16_bf16 v[96:111], a[8:11], a[40:43], v[96:111]
  s_waitcnt vmcnt(6)
  s_barrier
  v_add_u32 v12, 65536, v8
  v_add_u32 v16, 16384, v7
  v_xor_b32 v13, 64, v12
  v_xor_b32 v17, 32, v16
  v_xor_b32 v14, 128, v12
  v_xor_b32 v18, 64, v16
  v_xor_b32 v15, 192, v12
  v_xor_b32 v19, 96, v16
  ds_read_b128 a[36:39], v16
  ds_read_b64_tr_b16 a[0:1], v12 offset:0
  ds_read_b64_tr_b16 a[2:3], v12 offset:1024
  buffer_load_dwordx4 v133, s[12:15], s37 offen offset:1024 lds
  v_mfma_f32_32x32x16_bf16 v[112:127], a[12:15], a[40:43], v[112:127]
  ds_read_b64_tr_b16 a[4:5], v13 offset:0
  ds_read_b64_tr_b16 a[6:7], v13 offset:1024
  s_waitcnt lgkmcnt(9)
  v_mfma_f32_32x32x16_bf16 v[64:79], a[16:19], a[32:35], v[64:79]
  ds_read_b64_tr_b16 a[8:9], v14 offset:0
  ds_read_b64_tr_b16 a[10:11], v14 offset:1024
  buffer_load_dwordx4 v134, s[12:15], s37 offen offset:2048 lds
  v_mfma_f32_32x32x16_bf16 v[80:95], a[20:23], a[32:35], v[80:95]
  ds_read_b64_tr_b16 a[12:13], v15 offset:0
  ds_read_b64_tr_b16 a[14:15], v15 offset:1024
  s_waitcnt lgkmcnt(9)
  v_mfma_f32_32x32x16_bf16 v[96:111], a[24:27], a[32:35], v[96:111]
  ds_read_b128 a[40:43], v17
  ds_read_b64_tr_b16 a[16:17], v12 offset:4096
  ds_read_b64_tr_b16 a[18:19], v12 offset:5120
  buffer_load_dwordx4 v135, s[12:15], s37 offen offset:3072 lds
  v_mfma_f32_32x32x16_bf16 v[112:127], a[28:31], a[32:35], v[112:127]
  ds_read_b64_tr_b16 a[20:21], v13 offset:4096
  ds_read_b64_tr_b16 a[22:23], v13 offset:5120
  s_waitcnt lgkmcnt(9)
  v_mfma_f32_32x32x16_bf16 v[64:79], a[0:3], a[36:39], v[64:79]
  s_barrier
  ds_read_b64_tr_b16 a[24:25], v14 offset:4096
  ds_read_b64_tr_b16 a[26:27], v14 offset:5120
  s_add_u32 m0, s28, 0
  s_lshl_b32 s36, s34, 7
  s_lshl_b32 s37, s34, 19
  s_add_u32 s34, s34, 1
  s_cmp_ge_u32 s34, 10
  s_cselect_b32 s34, 0, s34
  buffer_load_dwordx4 v128, s[8:11], s36 offen offset:0 lds
  v_mfma_f32_32x32x16_bf16 v[80:95], a[4:7], a[36:39], v[80:95]
  ds_read_b64_tr_b16 a[28:29], v15 offset:4096
  ds_read_b64_tr_b16 a[30:31], v15 offset:5120
  s_waitcnt lgkmcnt(9)
  v_mfma_f32_32x32x16_bf16 v[96:111], a[8:11], a[36:39], v[96:111]
  ds_read_b128 a[32:35], v18
  ds_read_b64_tr_b16 a[0:1], v12 offset:8192
  ds_read_b64_tr_b16 a[2:3], v12 offset:9216
  buffer_load_dwordx4 v129, s[8:11], s36 offen offset:1024 lds
  v_mfma_f32_32x32x16_bf16 v[112:127], a[12:15], a[36:39], v[112:127]
  ds_read_b64_tr_b16 a[4:5], v13 offset:8192
  ds_read_b64_tr_b16 a[6:7], v13 offset:9216
  s_waitcnt lgkmcnt(9)
  v_mfma_f32_32x32x16_bf16 v[64:79], a[16:19], a[40:43], v[64:79]
  ds_read_b64_tr_b16 a[8:9], v14 offset:8192
  ds_read_b64_tr_b16 a[10:11], v14 offset:9216
  buffer_load_dwordx4 v130, s[8:11], s36 offen offset:2048 lds
  v_mfma_f32_32x32x16_bf16 v[80:95], a[20:23], a[40:43], v[80:95]
  ds_read_b64_tr_b16 a[12:13], v15 offset:8192
  ds_read_b64_tr_b16 a[14:15], v15 offset:9216
  s_waitcnt lgkmcnt(9)
  v_mfma_f32_32x32x16_bf16 v[96:111], a[24:27], a[40:43], v[96:111]
  ds_read_b128 a[36:39], v19
  ds_read_b64_tr_b16 a[16:17], v12 offset:12288
  ds_read_b64_tr_b16 a[18:19], v12 offset:13312
  buffer_load_dwordx4 v131, s[8:11], s36 offen offset:3072 lds
  v_mfma_f32_32x32x16_bf16 v[112:127], a[28:31], a[40:43], v[112:127]
  ds_read_b64_tr_b16 a[20:21], v13 offset:12288
  ds_read_b64_tr_b16 a[22:23], v13 offset:13312
  s_waitcnt lgkmcnt(9)
  v_mfma_f32_32x32x16_bf16 v[64:79], a[0:3], a[32:35], v[64:79]
  ds_read_b64_tr_b16 a[24:25], v14 offset:12288
  ds_read_b64_tr_b16 a[26:27], v14 offset:13312
  s_add_u32 m0, s28, 49152
  s_nop 0
  buffer_load_dwordx4 v132, s[12:15], s37 offen offset:0 lds
  v_mfma_f32_32x32x16_bf16 v[80:95], a[4:7], a[32:35], v[80:95]
  ds_read_b64_tr_b16 a[28:29], v15 offset:12288
  ds_read_b64_tr_b16 a[30:31], v15 offset:13312
  s_waitcnt lgkmcnt(9)
  v_mfma_f32_32x32x16_bf16 v[96:111], a[8:11], a[32:35], v[96:111]
  s_waitcnt vmcnt(5)
  s_barrier
  v_add_u32 v12, 131072, v8
  v_add_u32 v16, 32768, v7
  v_xor_b32 v13, 64, v12
  v_xor_b32 v17, 32, v16
  v_xor_b32 v14, 128, v12
  v_xor_b32 v18, 64, v16
  v_xor_b32 v15, 192, v12
  v_xor_b32 v19, 96, v16
  ds_read_b128 a[40:43], v16
  ds_read_b64_tr_b16 a[0:1], v12 offset:0
  ds_read_b64_tr_b16 a[2:3], v12 offset:1024
  buffer_load_dwordx4 v133, s[12:15], s37 offen offset:1024 lds
  v_mfma_f32_32x32x16_bf16 v[112:127], a[12:15], a[32:35], v[112:127]
  ds_read_b64_tr_b16 a[4:5], v13 offset:0
  ds_read_b64_tr_b16 a[6:7], v13 offset:1024
  s_waitcnt lgkmcnt(9)
  v_mfma_f32_32x32x16_bf16 v[64:79], a[16:19], a[36:39], v[64:79]
  ds_read_b64_tr_b16 a[8:9], v14 offset:0
  ds_read_b64_tr_b16 a[10:11], v14 offset:1024
  buffer_load_dwordx4 v134, s[12:15], s37 offen offset:2048 lds
  v_mfma_f32_32x32x16_bf16 v[80:95], a[20:23], a[36:39], v[80:95]
  ds_read_b64_tr_b16 a[12:13], v15 offset:0
  ds_read_b64_tr_b16 a[14:15], v15 offset:1024
  s_waitcnt lgkmcnt(9)
  v_mfma_f32_32x32x16_bf16 v[96:111], a[24:27], a[36:39], v[96:111]
  ds_read_b128 a[32:35], v17
  ds_read_b64_tr_b16 a[16:17], v12 offset:4096
  ds_read_b64_tr_b16 a[18:19], v12 offset:5120
  buffer_load_dwordx4 v135, s[12:15], s37 offen offset:3072 lds
  v_mfma_f32_32x32x16_bf16 v[112:127], a[28:31], a[36:39], v[112:127]
  ds_read_b64_tr_b16 a[20:21], v13 offset:4096
  ds_read_b64_tr_b16 a[22:23], v13 offset:5120
  s_waitcnt lgkmcnt(9)
  v_mfma_f32_32x32x16_bf16 v[64:79], a[0:3], a[40:43], v[64:79]
  s_barrier
  ds_read_b64_tr_b16 a[24:25], v14 offset:4096
  ds_read_b64_tr_b16 a[26:27], v14 offset:5120
  s_add_u32 m0, s28, 16384
  s_lshl_b32 s36, s34, 7
  s_lshl_b32 s37, s34, 19
  s_add_u32 s34, s34, 1
  s_cmp_ge_u32 s34, 10
  s_cselect_b32 s34, 0, s34
  buffer_load_dwordx4 v128, s[8:11], s36 offen offset:0 lds
  v_mfma_f32_32x32x16_bf16 v[80:95], a[4:7], a[40:43], v[80:95]
  ds_read_b64_tr_b16 a[28:29], v15 offset:4096
  ds_read_b64_tr_b16 a[30:31], v15 offset:5120
  s_waitcnt lgkmcnt(9)
  v_mfma_f32_32x32x16_bf16 v[96:111], a[8:11], a[40:43], v[96:111]
  ds_read_b128 a[36:39], v18
  ds_read_b64_tr_b16 a[0:1], v12 offset:8192
  ds_read_b64_tr_b16 a[2:3], v12 offset:9216
  buffer_load_dwordx4 v129, s[8:11], s36 offen offset:1024 lds
  v_mfma_f32_32x32x16_bf16 v[112:127], a[12:15], a[40:43], v[112:127]
  ds_read_b64_tr_b16 a[4:5], v13 offset:8192
  ds_read_b64_tr_b16 a[6:7], v13 offset:9216
  s_waitcnt lgkmcnt(9)
  v_mfma_f32_32x32x16_bf16 v[64:79], a[16:19], a[32:35], v[64:79]
  ds_read_b64_tr_b16 a[8:9], v14 offset:8192
  ds_read_b64_tr_b16 a[10:11], v14 offset:9216
  buffer_load_dwordx4 v130, s[8:11], s36 offen offset:2048 lds
  v_mfma_f32_32x32x16_bf16 v[80:95], a[20:23], a[32:35], v[80:95]
  ds_read_b64_tr_b16 a[12:13], v15 offset:8192
  ds_read_b64_tr_b16 a[14:15], v15 offset:9216
  s_waitcnt lgkmcnt(9)
  v_mfma_f32_32x32x16_bf16 v[96:111], a[24:27], a[32:35], v[96:111]
  ds_read_b128 a[40:43], v19
  ds_read_b64_tr_b16 a[16:17], v12 offset:12288
  ds_read_b64_tr_b16 a[18:19], v12 offset:13312
  buffer_load_dwordx4 v131, s[8:11], s36 offen offset:3072 lds
  v_mfma_f32_32x32x16_bf16 v[112:127], a[28:31], a[32:35], v[112:127]
  ds_read_b64_tr_b16 a[20:21], v13 offset:12288
  ds_read_b64_tr_b16 a[22:23], v13 offset:13312
  s_waitcnt lgkmcnt(9)
  v_mfma_f32_32x32x16_bf16 v[64:79], a[0:3], a[36:39], v[64:79]
  ds_read_b64_tr_b16 a[24:25], v14 offset:12288
  ds_read_b64_tr_b16 a[26:27], v14 offset:13312
  s_add_u32 m0, s28, 65536
  s_nop 0
  buffer_load_dwordx4 v132, s[12:15], s37 offen offset:0 lds
  v_mfma_f32_32x32x16_bf16 v[80:95], a[4:7], a[36:39], v[80:95]
  ds_read_b64_tr_b16 a[28:29], v15 offset:12288
  ds_read_b64_tr_b16 a[30:31], v15 offset:13312
  s_waitcnt lgkmcnt(9)
  v_mfma_f32_32x32x16_bf16 v[96:111], a[8:11], a[36:39], v[96:111]
  s_waitcnt vmcnt(5)
  s_barrier
  v_add_u32 v12, 49152, v8
  v_add_u32 v16, 0, v7
  v_xor_b32 v13, 64, v12
  v_xor_b32 v17, 32, v16
  v_xor_b32 v14, 128, v12
  v_xor_b32 v18, 64, v16
  v_xor_b32 v15, 192, v12
  v_xor_b32 v19, 96, v16
  ds_read_b128 a[32:35], v16
  ds_read_b64_tr_b16 a[0:1], v12 offset:0
  ds_read_b64_tr_b16 a[2:3], v12 offset:1024
  buffer_load_dwordx4 v133, s[12:15], s37 offen offset:1024 lds
  v_mfma_f32_32x32x16_bf16 v[112:127], a[12:15], a[36:39], v[112:127]
  ds_read_b64_tr_b16 a[4:5], v13 offset:0
  ds_read_b64_tr_b16 a[6:7], v13 offset:1024
  s_waitcnt lgkmcnt(9)
  v_mfma_f32_32x32x16_bf16 v[64:79], a[16:19], a[40:43], v[64:79]
  ds_read_b64_tr_b16 a[8:9], v14 offset:0
  ds_read_b64_tr_b16 a[10:11], v14 offset:1024
  buffer_load_dwordx4 v134, s[12:15], s37 offen offset:2048 lds
  v_mfma_f32_32x32x16_bf16 v[80:95], a[20:23], a[40:43], v[80:95]
  ds_read_b64_tr_b16 a[12:13], v15 offset:0
  ds_read_b64_tr_b16 a[14:15], v15 offset:1024
  s_waitcnt lgkmcnt(9)
  v_mfma_f32_32x32x16_bf16 v[96:111], a[24:27], a[40:43], v[96:111]
  ds_read_b128 a[36:39], v17
  ds_read_b64_tr_b16 a[16:17], v12 offset:4096
  ds_read_b64_tr_b16 a[18:19], v12 offset:5120
  buffer_load_dwordx4 v135, s[12:15], s37 offen offset:3072 lds
  v_mfma_f32_32x32x16_bf16 v[112:127], a[28:31], a[40:43], v[112:127]
  ds_read_b64_tr_b16 a[20:21], v13 offset:4096
  ds_read_b64_tr_b16 a[22:23], v13 offset:5120
  s_waitcnt lgkmcnt(9)
  v_mfma_f32_32x32x16_bf16 v[64:79], a[0:3], a[32:35], v[64:79]
  s_barrier
  ds_read_b64_tr_b16 a[24:25], v14 offset:4096
  ds_read_b64_tr_b16 a[26:27], v14 offset:5120
  s_add_u32 m0, s28, 32768
  s_lshl_b32 s36, s34, 7
  s_lshl_b32 s37, s34, 19
  s_add_u32 s34, s34, 1
  s_cmp_ge_u32 s34, 10
  s_cselect_b32 s34, 0, s34
  buffer_load_dwordx4 v128, s[8:11], s36 offen offset:0 lds
  v_mfma_f32_32x32x16_bf16 v[80:95], a[4:7], a[32:35], v[80:95]
  ds_read_b64_tr_b16 a[28:29], v15 offset:4096
  ds_read_b64_tr_b16 a[30:31], v15 offset:5120
  s_waitcnt lgkmcnt(9)
  v_mfma_f32_32x32x16_bf16 v[96:111], a[8:11], a[32:35], v[96:111]
  ds_read_b128 a[40:43], v18
  ds_read_b64_tr_b16 a[0:1], v12 offset:8192
  ds_read_b64_tr_b16 a[2:3], v12 offset:9216
  buffer_load_dwordx4 v129, s[8:11], s36 offen offset:1024 lds
  v_mfma_f32_32x32x16_bf16 v[112:127], a[12:15], a[32:35], v[112:127]
  ds_read_b64_tr_b16 a[4:5], v13 offset:8192
  ds_read_b64_tr_b16 a[6:7], v13 offset:9216
  s_waitcnt lgkmcnt(9)
  v_mfma_f32_32x32x16_bf16 v[64:79], a[16:19], a[36:39], v[64:79]
  ds_read_b64_tr_b16 a[8:9], v14 offset:8192
  ds_read_b64_tr_b16 a[10:11], v14 offset:9216
  buffer_load_dwordx4 v130, s[8:11], s36 offen offset:2048 lds
  v_mfma_f32_32x32x16_bf16 v[80:95], a[20:23], a[36:39], v[80:95]
  ds_read_b64_tr_b16 a[12:13], v15 offset:8192
  ds_read_b64_tr_b16 a[14:15], v15 offset:9216
  s_waitcnt lgkmcnt(9)
  v_mfma_f32_32x32x16_bf16 v[96:111], a[24:27], a[36:39], v[96:111]
  ds_read_b128 a[32:35], v19
  ds_read_b64_tr_b16 a[16:17], v12 offset:12288
  ds_read_b64_tr_b16 a[18:19], v12 offset:13312
  buffer_load_dwordx4 v131, s[8:11], s36 offen offset:3072 lds
  v_mfma_f32_32x32x16_bf16 v[112:127], a[28:31], a[36:39], v[112:127]
  ds_read_b64_tr_b16 a[20:21], v13 offset:12288
  ds_read_b64_tr_b16 a[22:23], v13 offset:13312
  s_waitcnt lgkmcnt(9)
  v_mfma_f32_32x32x16_bf16 v[64:79], a[0:3], a[40:43], v[64:79]
  ds_read_b64_tr_b16 a[24:25], v14 offset:12288
  ds_read_b64_tr_b16 a[26:27], v14 offset:13312
  s_add_u32 m0, s28, 131072
  s_nop 0
  buffer_load_dwordx4 v132, s[12:15], s37 offen offset:0 lds
  v_mfma_f32_32x32x16_bf16 v[80:95], a[4:7], a[40:43], v[80:95]
  ds_read_b64_tr_b16 a[28:29], v15 offset:12288
  ds_read_b64_tr_b16 a[30:31], v15 offset:13312
  s_waitcnt lgkmcnt(9)
  v_mfma_f32_32x32x16_bf16 v[96:111], a[8:11], a[40:43], v[96:111]
  s_waitcnt vmcnt(5)
  s_barrier
  v_add_u32 v12, 65536, v8
  v_add_u32 v16, 16384, v7
  v_xor_b32 v13, 64, v12
  v_xor_b32 v17, 32, v16
  v_xor_b32 v14, 128, v12
  v_xor_b32 v18, 64, v16
  v_xor_b32 v15, 192, v12
  v_xor_b32 v19, 96, v16
  ds_read_b128 a[36:39], v16
  ds_read_b64_tr_b16 a[0:1], v12 offset:0
  ds_read_b64_tr_b16 a[2:3], v12 offset:1024
  buffer_load_dwordx4 v133, s[12:15], s37 offen offset:1024 lds
  v_mfma_f32_32x32x16_bf16 v[112:127], a[12:15], a[40:43], v[112:127]
  ds_read_b64_tr_b16 a[4:5], v13 offset:0
  ds_read_b64_tr_b16 a[6:7], v13 offset:1024
  s_waitcnt lgkmcnt(9)
  v_mfma_f32_32x32x16_bf16 v[64:79], a[16:19], a[32:35], v[64:79]
  ds_read_b64_tr_b16 a[8:9], v14 offset:0
  ds_read_b64_tr_b16 a[10:11], v14 offset:1024
  buffer_load_dwordx4 v134, s[12:15], s37 offen offset:2048 lds
  v_mfma_f32_32x32x16_bf16 v[80:95], a[20:23], a[32:35], v[80:95]
  ds_read_b64_tr_b16 a[12:13], v15 offset:0
  ds_read_b64_tr_b16 a[14:15], v15 offset:1024
  s_waitcnt lgkmcnt(9)
  v_mfma_f32_32x32x16_bf16 v[96:111], a[24:27], a[32:35], v[96:111]
  ds_read_b128 a[40:43], v17
  ds_read_b64_tr_b16 a[16:17], v12 offset:4096
  ds_read_b64_tr_b16 a[18:19], v12 offset:5120
  buffer_load_dwordx4 v135, s[12:15], s37 offen offset:3072 lds
  v_mfma_f32_32x32x16_bf16 v[112:127], a[28:31], a[32:35], v[112:127]
  ds_read_b64_tr_b16 a[20:21], v13 offset:4096
  ds_read_b64_tr_b16 a[22:23], v13 offset:5120
  s_waitcnt lgkmcnt(9)
  v_mfma_f32_32x32x16_bf16 v[64:79], a[0:3], a[36:39], v[64:79]
  s_barrier
  ds_read_b64_tr_b16 a[24:25], v14 offset:4096
  ds_read_b64_tr_b16 a[26:27], v14 offset:5120
  s_add_u32 m0, s28, 0
  s_lshl_b32 s36, s34, 7
  s_lshl_b32 s37, s34, 19
  s_add_u32 s34, s34, 1
  s_cmp_ge_u32 s34, 10
  s_cselect_b32 s34, 0, s34
  buffer_load_dwordx4 v128, s[8:11], s36 offen offset:0 lds
  v_mfma_f32_32x32x16_bf16 v[80:95], a[4:7], a[36:39], v[80:95]
  ds_read_b64_tr_b16 a[28:29], v15 offset:4096
  ds_read_b64_tr_b16 a[30:31], v15 offset:5120
  s_waitcnt lgkmcnt(9)
  v_mfma_f32_32x32x16_bf16 v[96:111], a[8:11], a[36:39], v[96:111]
  ds_read_b128 a[32:35], v18
  ds_read_b64_tr_b16 a[0:1], v12 offset:8192
  ds_read_b64_tr_b16 a[2:3], v12 offset:9216
  buffer_load_dwordx4 v129, s[8:11], s36 offen offset:1024 lds
  v_mfma_f32_32x32x16_bf16 v[112:127], a[12:15], a[36:39], v[112:127]
  ds_read_b64_tr_b16 a[4:5], v13 offset:8192
  ds_read_b64_tr_b16 a[6:7], v13 offset:9216
  s_waitcnt lgkmcnt(9)
  v_mfma_f32_32x32x16_bf16 v[64:79], a[16:19], a[40:43], v[64:79]
  ds_read_b64_tr_b16 a[8:9], v14 offset:8192
  ds_read_b64_tr_b16 a[10:11], v14 offset:9216
  buffer_load_dwordx4 v130, s[8:11], s36 offen offset:2048 lds
  v_mfma_f32_32x32x16_bf16 v[80:95], a[20:23], a[40:43], v[80:95]
  ds_read_b64_tr_b16 a[12:13], v15 offset:8192
  ds_read_b64_tr_b16 a[14:15], v15 offset:9216
  s_waitcnt lgkmcnt(9)
  v_mfma_f32_32x32x16_bf16 v[96:111], a[24:27], a[40:43], v[96:111]
  ds_read_b128 a[36:39], v19
  ds_read_b64_tr_b16 a[16:17], v12 offset:12288
  ds_read_b64_tr_b16 a[18:19], v12 offset:13312
  buffer_load_dwordx4 v131, s[8:11], s36 offen offset:3072 lds
  v_mfma_f32_32x32x16_bf16 v[112:127], a[28:31], a[40:43], v[112:127]
  ds_read_b64_tr_b16 a[20:21], v13 offset:12288
  ds_read_b64_tr_b16 a[22:23], v13 offset:13312
  s_waitcnt lgkmcnt(9)
  v_mfma_f32_32x32x16_bf16 v[64:79], a[0:3], a[32:35], v[64:79]
  ds_read_b64_tr_b16 a[24:25], v14 offset:12288
  ds_read_b64_tr_b16 a[26:27], v14 offset:13312
  s_add_u32 m0, s28, 49152
  s_nop 0
  buffer_load_dwordx4 v132, s[12:15], s37 offen offset:0 lds
  v_mfma_f32_32x32x16_bf16 v[80:95], a[4:7], a[32:35], v[80:95]
  ds_read_b64_tr_b16 a[28:29], v15 offset:12288
  ds_read_b64_tr_b16 a[30:31], v15 offset:13312
  s_waitcnt lgkmcnt(9)
  v_mfma_f32_32x32x16_bf16 v[96:111], a[8:11], a[32:35], v[96:111]
  s_waitcnt vmcnt(5)
  s_barrier
  v_add_u32 v12, 131072, v8
  v_add_u32 v16, 32768, v7
  v_xor_b32 v13, 64, v12
  v_xor_b32 v17, 32, v16
  v_xor_b32 v14, 128, v12
  v_xor_b32 v18, 64, v16
  v_xor_b32 v15, 192, v12
  v_xor_b32 v19, 96, v16
  ds_read_b128 a[40:43], v16
  ds_read_b64_tr_b16 a[0:1], v12 offset:0
  ds_read_b64_tr_b16 a[2:3], v12 offset:1024
  buffer_load_dwordx4 v133, s[12:15], s37 offen offset:1024 lds
  v_mfma_f32_32x32x16_bf16 v[112:127], a[12:15], a[32:35], v[112:127]
  ds_read_b64_tr_b16 a[4:5], v13 offset:0
  ds_read_b64_tr_b16 a[6:7], v13 offset:1024
  s_waitcnt lgkmcnt(9)
  v_mfma_f32_32x32x16_bf16 v[64:79], a[16:19], a[36:39], v[64:79]
  ds_read_b64_tr_b16 a[8:9], v14 offset:0
  ds_read_b64_tr_b16 a[10:11], v14 offset:1024
  buffer_load_dwordx4 v134, s[12:15], s37 offen offset:2048 lds
  v_mfma_f32_32x32x16_bf16 v[80:95], a[20:23], a[36:39], v[80:95]
  ds_read_b64_tr_b16 a[12:13], v15 offset:0
  ds_read_b64_tr_b16 a[14:15], v15 offset:1024
  s_waitcnt lgkmcnt(9)
  v_mfma_f32_32x32x16_bf16 v[96:111], a[24:27], a[36:39], v[96:111]
  ds_read_b128 a[32:35], v17
  ds_read_b64_tr_b16 a[16:17], v12 offset:4096
  ds_read_b64_tr_b16 a[18:19], v12 offset:5120
  buffer_load_dwordx4 v135, s[12:15], s37 offen offset:3072 lds
  v_mfma_f32_32x32x16_bf16 v[112:127], a[28:31], a[36:39], v[112:127]
  ds_read_b64_tr_b16 a[20:21], v13 offset:4096
  ds_read_b64_tr_b16 a[22:23], v13 offset:5120
  s_waitcnt lgkmcnt(9)
  v_mfma_f32_32x32x16_bf16 v[64:79], a[0:3], a[40:43], v[64:79]
  s_barrier
  ds_read_b64_tr_b16 a[24:25], v14 offset:4096
  ds_read_b64_tr_b16 a[26:27], v14 offset:5120
  s_add_u32 m0, s28, 16384
  s_lshl_b32 s36, s34, 7
  s_lshl_b32 s37, s34, 19
  s_add_u32 s34, s34, 1
  s_cmp_ge_u32 s34, 10
  s_cselect_b32 s34, 0, s34
  buffer_load_dwordx4 v128, s[8:11], s36 offen offset:0 lds
  v_mfma_f32_32x32x16_bf16 v[80:95], a[4:7], a[40:43], v[80:95]
  ds_read_b64_tr_b16 a[28:29], v15 offset:4096
  ds_read_b64_tr_b16 a[30:31], v15 offset:5120
  s_waitcnt lgkmcnt(9)
  v_mfma_f32_32x32x16_bf16 v[96:111], a[8:11], a[40:43], v[96:111]
  ds_read_b128 a[36:39], v18
  ds_read_b64_tr_b16 a[0:1], v12 offset:8192
  ds_read_b64_tr_b16 a[2:3], v12 offset:9216
  buffer_load_dwordx4 v129, s[8:11], s36 offen offset:1024 lds
  v_mfma_f32_32x32x16_bf16 v[112:127], a[12:15], a[40:43], v[112:127]
  ds_read_b64_tr_b16 a[4:5], v13 offset:8192
  ds_read_b64_tr_b16 a[6:7], v13 offset:9216
  s_waitcnt lgkmcnt(9)
  v_mfma_f32_32x32x16_bf16 v[64:79], a[16:19], a[32:35], v[64:79]
  ds_read_b64_tr_b16 a[8:9], v14 offset:8192
  ds_read_b64_tr_b16 a[10:11], v14 offset:9216
  buffer_load_dwordx4 v130, s[8:11], s36 offen offset:2048 lds
  v_mfma_f32_32x32x16_bf16 v[80:95], a[20:23], a[32:35], v[80:95]
  ds_read_b64_tr_b16 a[12:13], v15 offset:8192
  ds_read_b64_tr_b16 a[14:15], v15 offset:9216
  s_waitcnt lgkmcnt(9)
  v_mfma_f32_32x32x16_bf16 v[96:111], a[24:27], a[32:35], v[96:111]
  ds_read_b128 a[40:43], v19
  ds_read_b64_tr_b16 a[16:17], v12 offset:12288
  ds_read_b64_tr_b16 a[18:19], v12 offset:13312
  buffer_load_dwordx4 v131, s[8:11], s36 offen offset:3072 lds
  v_mfma_f32_32x32x16_bf16 v[112:127], a[28:31], a[32:35], v[112:127]
  ds_read_b64_tr_b16 a[20:21], v13 offset:12288
  ds_read_b64_tr_b16 a[22:23], v13 offset:13312
  s_waitcnt lgkmcnt(9)
  v_mfma_f32_32x32x16_bf16 v[64:79], a[0:3], a[36:39], v[64:79]
  ds_read_b64_tr_b16 a[24:25], v14 offset:12288
  ds_read_b64_tr_b16 a[26:27], v14 offset:13312
  s_add_u32 m0, s28, 65536
  s_nop 0
  buffer_load_dwordx4 v132, s[12:15], s37 offen offset:0 lds
  v_mfma_f32_32x32x16_bf16 v[80:95], a[4:7], a[36:39], v[80:95]
  ds_read_b64_tr_b16 a[28:29], v15 offset:12288
  ds_read_b64_tr_b16 a[30:31], v15 offset:13312
  s_waitcnt lgkmcnt(9)
  v_mfma_f32_32x32x16_bf16 v[96:111], a[8:11], a[36:39], v[96:111]
  s_waitcnt vmcnt(5)
  s_barrier
  v_add_u32 v12, 49152, v8
  v_add_u32 v16, 0, v7
  v_xor_b32 v13, 64, v12
  v_xor_b32 v17, 32, v16
  v_xor_b32 v14, 128, v12
  v_xor_b32 v18, 64, v16
  v_xor_b32 v15, 192, v12
  v_xor_b32 v19, 96, v16
  ds_read_b128 a[32:35], v16
  ds_read_b64_tr_b16 a[0:1], v12 offset:0
  ds_read_b64_tr_b16 a[2:3], v12 offset:1024
  buffer_load_dwordx4 v133, s[12:15], s37 offen offset:1024 lds
  v_mfma_f32_32x32x16_bf16 v[112:127], a[12:15], a[36:39], v[112:127]
  ds_read_b64_tr_b16 a[4:5], v13 offset:0
  ds_read_b64_tr_b16 a[6:7], v13 offset:1024
  s_waitcnt lgkmcnt(9)
  v_mfma_f32_32x32x16_bf16 v[64:79], a[16:19], a[40:43], v[64:79]
  ds_read_b64_tr_b16 a[8:9], v14 offset:0
  ds_read_b64_tr_b16 a[10:11], v14 offset:1024
  buffer_load_dwordx4 v134, s[12:15], s37 offen offset:2048 lds
  v_mfma_f32_32x32x16_bf16 v[80:95], a[20:23], a[40:43], v[80:95]
  ds_read_b64_tr_b16 a[12:13], v15 offset:0
  ds_read_b64_tr_b16 a[14:15], v15 offset:1024
  s_waitcnt lgkmcnt(9)
  v_mfma_f32_32x32x16_bf16 v[96:111], a[24:27], a[40:43], v[96:111]
  ds_read_b128 a[36:39], v17
  ds_read_b64_tr_b16 a[16:17], v12 offset:4096
  ds_read_b64_tr_b16 a[18:19], v12 offset:5120
  buffer_load_dwordx4 v135, s[12:15], s37 offen offset:3072 lds
  v_mfma_f32_32x32x16_bf16 v[112:127], a[28:31], a[40:43], v[112:127]
  ds_read_b64_tr_b16 a[20:21], v13 offset:4096
  ds_read_b64_tr_b16 a[22:23], v13 offset:5120
  s_waitcnt lgkmcnt(9)
  v_mfma_f32_32x32x16_bf16 v[64:79], a[0:3], a[32:35], v[64:79]
  s_barrier
  ds_read_b64_tr_b16 a[24:25], v14 offset:4096
  ds_read_b64_tr_b16 a[26:27], v14 offset:5120
  s_add_u32 m0, s28, 32768
  s_lshl_b32 s36, s34, 7
  s_lshl_b32 s37, s34, 19
  s_add_u32 s34, s34, 1
  s_cmp_ge_u32 s34, 10
  s_cselect_b32 s34, 0, s34
  buffer_load_dwordx4 v128, s[8:11], s36 offen offset:0 lds
  v_mfma_f32_32x32x16_bf16 v[80:95], a[4:7], a[32:35], v[80:95]
  ds_read_b64_tr_b16 a[28:29], v15 offset:4096
  ds_read_b64_tr_b16 a[30:31], v15 offset:5120
  s_waitcnt lgkmcnt(9)
  v_mfma_f32_32x32x16_bf16 v[96:111], a[8:11], a[32:35], v[96:111]
  ds_read_b128 a[40:43], v18
  ds_read_b64_tr_b16 a[0:1], v12 offset:8192
  ds_read_b64_tr_b16 a[2:3], v12 offset:9216
  buffer_load_dwordx4 v129, s[8:11], s36 offen offset:1024 lds
  v_mfma_f32_32x32x16_bf16 v[112:127], a[12:15], a[32:35], v[112:127]
  ds_read_b64_tr_b16 a[4:5], v13 offset:8192
  ds_read_b64_tr_b16 a[6:7], v13 offset:9216
  s_waitcnt lgkmcnt(9)
  v_mfma_f32_32x32x16_bf16 v[64:79], a[16:19], a[36:39], v[64:79]
  ds_read_b64_tr_b16 a[8:9], v14 offset:8192
  ds_read_b64_tr_b16 a[10:11], v14 offset:9216
  buffer_load_dwordx4 v130, s[8:11], s36 offen offset:2048 lds
  v_mfma_f32_32x32x16_bf16 v[80:95], a[20:23], a[36:39], v[80:95]
  ds_read_b64_tr_b16 a[12:13], v15 offset:8192
  ds_read_b64_tr_b16 a[14:15], v15 offset:9216
  s_waitcnt lgkmcnt(9)
  v_mfma_f32_32x32x16_bf16 v[96:111], a[24:27], a[36:39], v[96:111]
  ds_read_b128 a[32:35], v19
  ds_read_b64_tr_b16 a[16:17], v12 offset:12288
  ds_read_b64_tr_b16 a[18:19], v12 offset:13312
  buffer_load_dwordx4 v131, s[8:11], s36 offen offset:3072 lds
  v_mfma_f32_32x32x16_bf16 v[112:127], a[28:31], a[36:39], v[112:127]
  ds_read_b64_tr_b16 a[20:21], v13 offset:12288
  ds_read_b64_tr_b16 a[22:23], v13 offset:13312
  s_waitcnt lgkmcnt(9)
  v_mfma_f32_32x32x16_bf16 v[64:79], a[0:3], a[40:43], v[64:79]
  ds_read_b64_tr_b16 a[24:25], v14 offset:12288
  ds_read_b64_tr_b16 a[26:27], v14 offset:13312
  s_add_u32 m0, s28, 131072
  s_nop 0
  buffer_load_dwordx4 v132, s[12:15], s37 offen offset:0 lds
  v_mfma_f32_32x32x16_bf16 v[80:95], a[4:7], a[40:43], v[80:95]
  ds_read_b64_tr_b16 a[28:29], v15 offset:12288
  ds_read_b64_tr_b16 a[30:31], v15 offset:13312
  s_waitcnt lgkmcnt(9)
  v_mfma_f32_32x32x16_bf16 v[96:111], a[8:11], a[40:43], v[96:111]
  s_waitcnt vmcnt(5)
  s_barrier
  v_add_u32 v12, 65536, v8
  v_add_u32 v16, 16384, v7
  v_xor_b32 v13, 64, v12
  v_xor_b32 v17, 32, v16
  v_xor_b32 v14, 128, v12
  v_xor_b32 v18, 64, v16
  v_xor_b32 v15, 192, v12
  v_xor_b32 v19, 96, v16
  ds_read_b128 a[36:39], v16
  ds_read_b64_tr_b16 a[0:1], v12 offset:0
  ds_read_b64_tr_b16 a[2:3], v12 offset:1024
  buffer_load_dwordx4 v133, s[12:15], s37 offen offset:1024 lds
  v_mfma_f32_32x32x16_bf16 v[112:127], a[12:15], a[40:43], v[112:127]
  ds_read_b64_tr_b16 a[4:5], v13 offset:0
  ds_read_b64_tr_b16 a[6:7], v13 offset:1024
  s_waitcnt lgkmcnt(9)
  v_mfma_f32_32x32x16_bf16 v[64:79], a[16:19], a[32:35], v[64:79]
  ds_read_b64_tr_b16 a[8:9], v14 offset:0
  ds_read_b64_tr_b16 a[10:11], v14 offset:1024
  buffer_load_dwordx4 v134, s[12:15], s37 offen offset:2048 lds
  v_mfma_f32_32x32x16_bf16 v[80:95], a[20:23], a[32:35], v[80:95]
  ds_read_b64_tr_b16 a[12:13], v15 offset:0
  ds_read_b64_tr_b16 a[14:15], v15 offset:1024
  s_waitcnt lgkmcnt(9)
  v_mfma_f32_32x32x16_bf16 v[96:111], a[24:27], a[32:35], v[96:111]
  ds_read_b128 a[40:43], v17
  ds_read_b64_tr_b16 a[16:17], v12 offset:4096
  ds_read_b64_tr_b16 a[18:19], v12 offset:5120
  buffer_load_dwordx4 v135, s[12:15], s37 offen offset:3072 lds
  v_mfma_f32_32x32x16_bf16 v[112:127], a[28:31], a[32:35], v[112:127]
  ds_read_b64_tr_b16 a[20:21], v13 offset:4096
  ds_read_b64_tr_b16 a[22:23], v13 offset:5120
  s_waitcnt lgkmcnt(9)
  v_mfma_f32_32x32x16_bf16 v[64:79], a[0:3], a[36:39], v[64:79]
  s_barrier
  ds_read_b64_tr_b16 a[24:25], v14 offset:4096
  ds_read_b64_tr_b16 a[26:27], v14 offset:5120
  s_add_u32 m0, s28, 0
  s_lshl_b32 s36, s34, 7
  s_lshl_b32 s37, s34, 19
  s_add_u32 s34, s34, 1
  s_cmp_ge_u32 s34, 10
  s_cselect_b32 s34, 0, s34
  buffer_load_dwordx4 v128, s[8:11], s36 offen offset:0 lds
  v_mfma_f32_32x32x16_bf16 v[80:95], a[4:7], a[36:39], v[80:95]
  ds_read_b64_tr_b16 a[28:29], v15 offset:4096
  ds_read_b64_tr_b16 a[30:31], v15 offset:5120
  s_waitcnt lgkmcnt(9)
  v_mfma_f32_32x32x16_bf16 v[96:111], a[8:11], a[36:39], v[96:111]
  ds_read_b128 a[32:35], v18
  ds_read_b64_tr_b16 a[0:1], v12 offset:8192
  ds_read_b64_tr_b16 a[2:3], v12 offset:9216
  buffer_load_dwordx4 v129, s[8:11], s36 offen offset:1024 lds
  v_mfma_f32_32x32x16_bf16 v[112:127], a[12:15], a[36:39], v[112:127]
  ds_read_b64_tr_b16 a[4:5], v13 offset:8192
  ds_read_b64_tr_b16 a[6:7], v13 offset:9216
  s_waitcnt lgkmcnt(9)
  v_mfma_f32_32x32x16_bf16 v[64:79], a[16:19], a[40:43], v[64:79]
  ds_read_b64_tr_b16 a[8:9], v14 offset:8192
  ds_read_b64_tr_b16 a[10:11], v14 offset:9216
  buffer_load_dwordx4 v130, s[8:11], s36 offen offset:2048 lds
  v_mfma_f32_32x32x16_bf16 v[80:95], a[20:23], a[40:43], v[80:95]
  ds_read_b64_tr_b16 a[12:13], v15 offset:8192
  ds_read_b64_tr_b16 a[14:15], v15 offset:9216
  s_waitcnt lgkmcnt(9)
  v_mfma_f32_32x32x16_bf16 v[96:111], a[24:27], a[40:43], v[96:111]
  ds_read_b128 a[36:39], v19
  ds_read_b64_tr_b16 a[16:17], v12 offset:12288
  ds_read_b64_tr_b16 a[18:19], v12 offset:13312
  buffer_load_dwordx4 v131, s[8:11], s36 offen offset:3072 lds
  v_mfma_f32_32x32x16_bf16 v[112:127], a[28:31], a[40:43], v[112:127]
  ds_read_b64_tr_b16 a[20:21], v13 offset:12288
  ds_read_b64_tr_b16 a[22:23], v13 offset:13312
  s_waitcnt lgkmcnt(9)
  v_mfma_f32_32x32x16_bf16 v[64:79], a[0:3], a[32:35], v[64:79]
  ds_read_b64_tr_b16 a[24:25], v14 offset:12288
  ds_read_b64_tr_b16 a[26:27], v14 offset:13312
  s_add_u32 m0, s28, 49152
  s_nop 0
  buffer_load_dwordx4 v132, s[12:15], s37 offen offset:0 lds
  v_mfma_f32_32x32x16_bf16 v[80:95], a[4:7], a[32:35], v[80:95]
  ds_read_b64_tr_b16 a[28:29], v15 offset:12288
  ds_read_b64_tr_b16 a[30:31], v15 offset:13312
  s_waitcnt lgkmcnt(9)
  v_mfma_f32_32x32x16_bf16 v[96:111], a[8:11], a[32:35], v[96:111]
  s_waitcnt vmcnt(5)
  s_barrier
  v_add_u32 v12, 131072, v8
  v_add_u32 v16, 32768, v7
  v_xor_b32 v13, 64, v12
  v_xor_b32 v17, 32, v16
  v_xor_b32 v14, 128, v12
  v_xor_b32 v18, 64, v16
  v_xor_b32 v15, 192, v12
  v_xor_b32 v19, 96, v16
  ds_read_b128 a[40:43], v16
  ds_read_b64_tr_b16 a[0:1], v12 offset:0
  ds_read_b64_tr_b16 a[2:3], v12 offset:1024
  buffer_load_dwordx4 v133, s[12:15], s37 offen offset:1024 lds
  v_mfma_f32_32x32x16_bf16 v[112:127], a[12:15], a[32:35], v[112:127]
  ds_read_b64_tr_b16 a[4:5], v13 offset:0
  ds_read_b64_tr_b16 a[6:7], v13 offset:1024
  s_waitcnt lgkmcnt(9)
  v_mfma_f32_32x32x16_bf16 v[64:79], a[16:19], a[36:39], v[64:79]
  ds_read_b64_tr_b16 a[8:9], v14 offset:0
  ds_read_b64_tr_b16 a[10:11], v14 offset:1024
  buffer_load_dwordx4 v134, s[12:15], s37 offen offset:2048 lds
  v_mfma_f32_32x32x16_bf16 v[80:95], a[20:23], a[36:39], v[80:95]
  ds_read_b64_tr_b16 a[12:13], v15 offset:0
  ds_read_b64_tr_b16 a[14:15], v15 offset:1024
  s_waitcnt lgkmcnt(9)
  v_mfma_f32_32x32x16_bf16 v[96:111], a[24:27], a[36:39], v[96:111]
  ds_read_b128 a[32:35], v17
  ds_read_b64_tr_b16 a[16:17], v12 offset:4096
  ds_read_b64_tr_b16 a[18:19], v12 offset:5120
  buffer_load_dwordx4 v135, s[12:15], s37 offen offset:3072 lds
  v_mfma_f32_32x32x16_bf16 v[112:127], a[28:31], a[36:39], v[112:127]
  ds_read_b64_tr_b16 a[20:21], v13 offset:4096
  ds_read_b64_tr_b16 a[22:23], v13 offset:5120
  s_waitcnt lgkmcnt(9)
  v_mfma_f32_32x32x16_bf16 v[64:79], a[0:3], a[40:43], v[64:79]
  ds_read_b64_tr_b16 a[24:25], v14 offset:4096
  ds_read_b64_tr_b16 a[26:27], v14 offset:5120
  v_mfma_f32_32x32x16_bf16 v[80:95], a[4:7], a[40:43], v[80:95]
  ds_read_b64_tr_b16 a[28:29], v15 offset:4096
  ds_read_b64_tr_b16 a[30:31], v15 offset:5120
  s_waitcnt lgkmcnt(9)
  v_mfma_f32_32x32x16_bf16 v[96:111], a[8:11], a[40:43], v[96:111]
  ds_read_b128 a[36:39], v18
  ds_read_b64_tr_b16 a[0:1], v12 offset:8192
  ds_read_b64_tr_b16 a[2:3], v12 offset:9216
  s_add_u32 m0, s28, 98304
  s_mov_b32 s31, 32768
  buffer_load_dwordx4 v2, s[16:19], s31 offen offset:0 nt lds
  v_mfma_f32_32x32x16_bf16 v[112:127], a[12:15], a[40:43], v[112:127]
  ds_read_b64_tr_b16 a[4:5], v13 offset:8192
  ds_read_b64_tr_b16 a[6:7], v13 offset:9216
  s_waitcnt lgkmcnt(9)
  v_mfma_f32_32x32x16_bf16 v[64:79], a[16:19], a[32:35], v[64:79]
  ds_read_b64_tr_b16 a[8:9], v14 offset:8192
  ds_read_b64_tr_b16 a[10:11], v14 offset:9216
  v_mfma_f32_32x32x16_bf16 v[80:95], a[20:23], a[32:35], v[80:95]
  ds_read_b64_tr_b16 a[12:13], v15 offset:8192
  ds_read_b64_tr_b16 a[14:15], v15 offset:9216
  s_waitcnt lgkmcnt(9)
  v_mfma_f32_32x32x16_bf16 v[96:111], a[24:27], a[32:35], v[96:111]
  ds_read_b128 a[40:43], v19
  ds_read_b64_tr_b16 a[16:17], v12 offset:12288
  ds_read_b64_tr_b16 a[18:19], v12 offset:13312
  s_add_u32 m0, s28, 98304
  s_nop 0
  buffer_load_dwordx4 v3, s[16:19], s31 offen offset:1024 nt lds
  v_mfma_f32_32x32x16_bf16 v[112:127], a[28:31], a[32:35], v[112:127]
  ds_read_b64_tr_b16 a[20:21], v13 offset:12288
  ds_read_b64_tr_b16 a[22:23], v13 offset:13312
  s_waitcnt lgkmcnt(9)
  v_mfma_f32_32x32x16_bf16 v[64:79], a[0:3], a[36:39], v[64:79]
  ds_read_b64_tr_b16 a[24:25], v14 offset:12288
  ds_read_b64_tr_b16 a[26:27], v14 offset:13312
  v_mfma_f32_32x32x16_bf16 v[80:95], a[4:7], a[36:39], v[80:95]
  ds_read_b64_tr_b16 a[28:29], v15 offset:12288
  ds_read_b64_tr_b16 a[30:31], v15 offset:13312
  s_waitcnt lgkmcnt(9)
  v_mfma_f32_32x32x16_bf16 v[96:111], a[8:11], a[36:39], v[96:111]
  s_waitcnt vmcnt(2)
  s_barrier
  v_add_u32 v11, 1, v11
  v_cmp_eq_u32 vcc, 0, v11
  s_mov_b32 s100, 262144
  s_nop 0
  v_cndmask_b32 v11, v11, 1, vcc
  buffer_store_dword v11, v30, s[84:87], 0 offen sc1
  buffer_store_dword v11, v30, s[88:91], s100 offen sc1
  v_add_u32 v12, 49152, v8
  v_add_u32 v16, 0, v7
  v_xor_b32 v13, 64, v12
  v_xor_b32 v17, 32, v16
  v_xor_b32 v14, 128, v12
  v_xor_b32 v18, 64, v16
  v_xor_b32 v15, 192, v12
  v_xor_b32 v19, 96, v16
  ds_read_b128 a[32:35], v16
  ds_read_b64_tr_b16 a[0:1], v12 offset:0
  ds_read_b64_tr_b16 a[2:3], v12 offset:1024
  s_add_u32 m0, s28, 98304
  s_nop 0
  buffer_load_dwordx4 v4, s[16:19], s31 offen offset:2048 nt lds
  v_mfma_f32_32x32x16_bf16 v[112:127], a[12:15], a[36:39], v[112:127]
  ds_read_b64_tr_b16 a[4:5], v13 offset:0
  ds_read_b64_tr_b16 a[6:7], v13 offset:1024
  s_waitcnt lgkmcnt(9)
  v_mfma_f32_32x32x16_bf16 v[64:79], a[16:19], a[40:43], v[64:79]
  ds_read_b64_tr_b16 a[8:9], v14 offset:0
  ds_read_b64_tr_b16 a[10:11], v14 offset:1024
  v_mfma_f32_32x32x16_bf16 v[80:95], a[20:23], a[40:43], v[80:95]
  ds_read_b64_tr_b16 a[12:13], v15 offset:0
  ds_read_b64_tr_b16 a[14:15], v15 offset:1024
  s_waitcnt lgkmcnt(9)
  v_mfma_f32_32x32x16_bf16 v[96:111], a[24:27], a[40:43], v[96:111]
  ds_read_b128 a[36:39], v17
  ds_read_b64_tr_b16 a[16:17], v12 offset:4096
  ds_read_b64_tr_b16 a[18:19], v12 offset:5120
  s_add_u32 m0, s28, 98304
  s_nop 0
  buffer_load_dwordx4 v5, s[16:19], s31 offen offset:3072 nt lds
  v_mfma_f32_32x32x16_bf16 v[112:127], a[28:31], a[40:43], v[112:127]
  ds_read_b64_tr_b16 a[20:21], v13 offset:4096
  ds_read_b64_tr_b16 a[22:23], v13 offset:5120
  s_waitcnt lgkmcnt(9)
  v_mfma_f32_32x32x16_bf16 v[64:79], a[0:3], a[32:35], v[64:79]
  ds_read_b64_tr_b16 a[24:25], v14 offset:4096
  ds_read_b64_tr_b16 a[26:27], v14 offset:5120
  v_mfma_f32_32x32x16_bf16 v[80:95], a[4:7], a[32:35], v[80:95]
  ds_read_b64_tr_b16 a[28:29], v15 offset:4096
  ds_read_b64_tr_b16 a[30:31], v15 offset:5120
  s_waitcnt lgkmcnt(9)
  v_mfma_f32_32x32x16_bf16 v[96:111], a[8:11], a[32:35], v[96:111]
  ds_read_b128 a[40:43], v18
  ds_read_b64_tr_b16 a[0:1], v12 offset:8192
  ds_read_b64_tr_b16 a[2:3], v12 offset:9216
  s_add_u32 m0, s28, 114688
  s_mov_b32 s31, 49152
  buffer_load_dwordx4 v2, s[16:19], s31 offen offset:0 nt lds
  v_mfma_f32_32x32x16_bf16 v[112:127], a[12:15], a[32:35], v[112:127]
  ds_read_b64_tr_b16 a[4:5], v13 offset:8192
  ds_read_b64_tr_b16 a[6:7], v13 offset:9216
  s_waitcnt lgkmcnt(9)
  v_mfma_f32_32x32x16_bf16 v[64:79], a[16:19], a[36:39], v[64:79]
  ds_read_b64_tr_b16 a[8:9], v14 offset:8192
  ds_read_b64_tr_b16 a[10:11], v14 offset:9216
  v_mfma_f32_32x32x16_bf16 v[80:95], a[20:23], a[36:39], v[80:95]
  ds_read_b64_tr_b16 a[12:13], v15 offset:8192
  ds_read_b64_tr_b16 a[14:15], v15 offset:9216
  s_waitcnt lgkmcnt(9)
  v_mfma_f32_32x32x16_bf16 v[96:111], a[24:27], a[36:39], v[96:111]
  ds_read_b128 a[32:35], v19
  ds_read_b64_tr_b16 a[16:17], v12 offset:12288
  ds_read_b64_tr_b16 a[18:19], v12 offset:13312
  s_add_u32 m0, s28, 114688
  s_nop 0
  buffer_load_dwordx4 v3, s[16:19], s31 offen offset:1024 nt lds
  v_mfma_f32_32x32x16_bf16 v[112:127], a[28:31], a[36:39], v[112:127]
  ds_read_b64_tr_b16 a[20:21], v13 offset:12288
  ds_read_b64_tr_b16 a[22:23], v13 offset:13312
  s_waitcnt lgkmcnt(9)
  v_mfma_f32_32x32x16_bf16 v[64:79], a[0:3], a[40:43], v[64:79]
  ds_read_b64_tr_b16 a[24:25], v14 offset:12288
  ds_read_b64_tr_b16 a[26:27], v14 offset:13312
  v_mfma_f32_32x32x16_bf16 v[80:95], a[4:7], a[40:43], v[80:95]
  ds_read_b64_tr_b16 a[28:29], v15 offset:12288
  ds_read_b64_tr_b16 a[30:31], v15 offset:13312
  s_waitcnt lgkmcnt(9)
  v_mfma_f32_32x32x16_bf16 v[96:111], a[8:11], a[40:43], v[96:111]
  s_add_u32 m0, s28, 114688
  s_nop 0
  buffer_load_dwordx4 v4, s[16:19], s31 offen offset:2048 nt lds
  v_mfma_f32_32x32x16_bf16 v[112:127], a[12:15], a[40:43], v[112:127]
  s_waitcnt lgkmcnt(4)
  v_mfma_f32_32x32x16_bf16 v[64:79], a[16:19], a[32:35], v[64:79]
  v_mfma_f32_32x32x16_bf16 v[80:95], a[20:23], a[32:35], v[80:95]
  s_waitcnt lgkmcnt(0)
  v_mfma_f32_32x32x16_bf16 v[96:111], a[24:27], a[32:35], v[96:111]
  s_add_u32 m0, s28, 114688
  s_nop 0
  buffer_load_dwordx4 v5, s[16:19], s31 offen offset:3072 nt lds
  v_mfma_f32_32x32x16_bf16 v[112:127], a[28:31], a[32:35], v[112:127]
  s_waitcnt vmcnt(63)
  s_barrier
  v_add_u32 v12, 147456, v9
  v_xor_b32 v13, 32, v12
  v_xor_b32 v14, 64, v12
  v_xor_b32 v15, 96, v12
  v_xor_b32 v16, 128, v12
  v_xor_b32 v17, 160, v12
  v_xor_b32 v18, 192, v12
  v_xor_b32 v19, 224, v12
  ds_read_b128 a[0:3], v12 offset:0
  ds_read_b128 a[4:7], v13 offset:0
  ds_read_b128 a[8:11], v14 offset:0
  ds_read_b128 a[12:15], v15 offset:0
  ds_read_b128 a[16:19], v16 offset:0
  ds_read_b128 a[20:23], v17 offset:0
  v_mov_b32 v26, s32
  v_accvgpr_read_b32 v7, a64
  s_mov_b32 s61, 0
  v_mov_b32 v25, 0x3f803f80
  v_accvgpr_write_b32 a116, v25
  v_accvgpr_write_b32 a117, v25
  v_accvgpr_write_b32 a118, v25
  v_accvgpr_write_b32 a119, v25
  v_pk_mul_f32 v[64:65], v[64:65], v[26:27] op_sel_hi:[1,0]
  v_pk_mul_f32 v[66:67], v[66:67], v[26:27] op_sel_hi:[1,0]
  v_pk_mul_f32 v[68:69], v[68:69], v[26:27] op_sel_hi:[1,0]
  v_pk_mul_f32 v[70:71], v[70:71], v[26:27] op_sel_hi:[1,0]
  v_pk_mul_f32 v[72:73], v[72:73], v[26:27] op_sel_hi:[1,0]
  v_pk_mul_f32 v[74:75], v[74:75], v[26:27] op_sel_hi:[1,0]
  v_pk_mul_f32 v[76:77], v[76:77], v[26:27] op_sel_hi:[1,0]
  v_pk_mul_f32 v[78:79], v[78:79], v[26:27] op_sel_hi:[1,0]
  v_cvt_pk_bf16_f32 v64, v64, v65
  v_cvt_pk_bf16_f32 v65, v66, v67
  v_cvt_pk_bf16_f32 v66, v68, v69
  v_cvt_pk_bf16_f32 v67, v70, v71
  v_cvt_pk_bf16_f32 v68, v72, v73
  v_cvt_pk_bf16_f32 v69, v74, v75
  v_cvt_pk_bf16_f32 v70, v76, v77
  v_cvt_pk_bf16_f32 v71, v78, v79
  v_accvgpr_write_b32 a32, v64
  v_accvgpr_write_b32 a33, v65
  v_accvgpr_write_b32 a34, v66
  v_accvgpr_write_b32 a35, v67
  v_accvgpr_write_b32 a36, v68
  v_accvgpr_write_b32 a37, v69
  v_accvgpr_write_b32 a38, v70
  v_accvgpr_write_b32 a39, v71
  v_pk_mul_f32 v[80:81], v[80:81], v[26:27] op_sel_hi:[1,0]
  v_pk_mul_f32 v[82:83], v[82:83], v[26:27] op_sel_hi:[1,0]
  v_pk_mul_f32 v[84:85], v[84:85], v[26:27] op_sel_hi:[1,0]
  v_pk_mul_f32 v[86:87], v[86:87], v[26:27] op_sel_hi:[1,0]
  v_pk_mul_f32 v[88:89], v[88:89], v[26:27] op_sel_hi:[1,0]
  v_pk_mul_f32 v[90:91], v[90:91], v[26:27] op_sel_hi:[1,0]
  v_pk_mul_f32 v[92:93], v[92:93], v[26:27] op_sel_hi:[1,0]
  v_pk_mul_f32 v[94:95], v[94:95], v[26:27] op_sel_hi:[1,0]
  v_cvt_pk_bf16_f32 v80, v80, v81
  v_cvt_pk_bf16_f32 v81, v82, v83
  v_cvt_pk_bf16_f32 v82, v84, v85
  v_cvt_pk_bf16_f32 v83, v86, v87
  v_cvt_pk_bf16_f32 v84, v88, v89
  v_cvt_pk_bf16_f32 v85, v90, v91
  v_cvt_pk_bf16_f32 v86, v92, v93
  v_cvt_pk_bf16_f32 v87, v94, v95
  v_accvgpr_write_b32 a40, v80
  v_accvgpr_write_b32 a41, v81
  v_accvgpr_write_b32 a42, v82
  v_accvgpr_write_b32 a43, v83
  v_accvgpr_write_b32 a44, v84
  v_accvgpr_write_b32 a45, v85
  v_accvgpr_write_b32 a46, v86
  v_accvgpr_write_b32 a47, v87
  s_waitcnt lgkmcnt(4)
  v_mfma_f32_32x32x16_bf16 v[128:143], a[0:3], a[32:35], 0
  ds_read_b128 a[24:27], v18 offset:0
  v_mul_f32 v96, v96, v26
  v_mul_f32 v97, v97, v26
  v_mul_f32 v98, v98, v26
  v_mul_f32 v99, v99, v26
  v_mul_f32 v100, v100, v26
  v_mul_f32 v101, v101, v26
  v_mul_f32 v102, v102, v26
  v_mul_f32 v103, v103, v26
  v_mul_f32 v104, v104, v26
  v_mul_f32 v105, v105, v26
  v_mul_f32 v106, v106, v26
  v_mfma_f32_32x32x16_bf16 v[128:143], a[4:7], a[36:39], v[128:143]
  ds_read_b128 a[28:31], v19 offset:0
  v_mul_f32 v107, v107, v26
  v_mul_f32 v108, v108, v26
  v_mul_f32 v109, v109, v26
  v_mul_f32 v110, v110, v26
  v_mul_f32 v111, v111, v26
  v_cvt_pk_bf16_f32 v96, v96, v97
  v_cvt_pk_bf16_f32 v97, v98, v99
  v_cvt_pk_bf16_f32 v98, v100, v101
  v_cvt_pk_bf16_f32 v99, v102, v103
  v_cvt_pk_bf16_f32 v100, v104, v105
  v_cvt_pk_bf16_f32 v101, v106, v107
  s_waitcnt lgkmcnt(4)
  v_mfma_f32_32x32x16_bf16 v[128:143], a[8:11], a[40:43], v[128:143]
  ds_read_b128 a[0:3], v12 offset:8192
  v_cvt_pk_bf16_f32 v102, v108, v109
  v_cvt_pk_bf16_f32 v103, v110, v111
  v_accvgpr_write_b32 a48, v96
  v_accvgpr_write_b32 a49, v97
  v_accvgpr_write_b32 a50, v98
  v_accvgpr_write_b32 a51, v99
  v_accvgpr_write_b32 a52, v100
  v_accvgpr_write_b32 a53, v101
  v_accvgpr_write_b32 a54, v102
  v_accvgpr_write_b32 a55, v103
  v_mul_f32 v112, v112, v26
  v_mfma_f32_32x32x16_bf16 v[128:143], a[12:15], a[44:47], v[128:143]
  ds_read_b128 a[4:7], v13 offset:8192
  v_mul_f32 v113, v113, v26
  v_mul_f32 v114, v114, v26
  v_mul_f32 v115, v115, v26
  v_mul_f32 v116, v116, v26
  v_mul_f32 v117, v117, v26
  v_mul_f32 v118, v118, v26
  v_mul_f32 v119, v119, v26
  v_mul_f32 v120, v120, v26
  v_mul_f32 v121, v121, v26
  v_mul_f32 v122, v122, v26
  v_mul_f32 v123, v123, v26
  s_waitcnt lgkmcnt(4)
  v_mfma_f32_32x32x16_bf16 v[128:143], a[16:19], a[48:51], v[128:143]
  ds_read_b128 a[8:11], v14 offset:8192
  v_mul_f32 v124, v124, v26
  v_mul_f32 v125, v125, v26
  v_mul_f32 v126, v126, v26
  v_mul_f32 v127, v127, v26
  v_cvt_pk_bf16_f32 v112, v112, v113
  v_cvt_pk_bf16_f32 v113, v114, v115
  v_cvt_pk_bf16_f32 v114, v116, v117
  v_cvt_pk_bf16_f32 v115, v118, v119
  v_cvt_pk_bf16_f32 v116, v120, v121
  v_cvt_pk_bf16_f32 v117, v122, v123
  v_cvt_pk_bf16_f32 v118, v124, v125
  v_mfma_f32_32x32x16_bf16 v[128:143], a[20:23], a[52:55], v[128:143]
  ds_read_b128 a[12:15], v15 offset:8192
  v_cvt_pk_bf16_f32 v119, v126, v127
  v_accvgpr_write_b32 a56, v112
  v_accvgpr_write_b32 a57, v113
  v_accvgpr_write_b32 a58, v114
  v_accvgpr_write_b32 a59, v115
  v_accvgpr_write_b32 a60, v116
  v_accvgpr_write_b32 a61, v117
  v_accvgpr_write_b32 a62, v118
  v_accvgpr_write_b32 a63, v119
  s_waitcnt lgkmcnt(4)
  v_mfma_f32_32x32x16_bf16 v[128:143], a[24:27], a[56:59], v[128:143]
  ds_read_b128 a[16:19], v16 offset:8192
  v_mfma_f32_32x32x16_bf16 v[128:143], a[28:31], a[60:63], v[128:143]
  ds_read_b128 a[20:23], v17 offset:8192
  s_waitcnt lgkmcnt(4)
  v_mfma_f32_32x32x16_bf16 v[144:159], a[0:3], a[32:35], 0
  ds_read_b128 a[24:27], v18 offset:8192
  v_add_u32 v52, 81920, v8
  v_xor_b32 v53, 64, v52
  v_mfma_f32_32x32x16_bf16 v[144:159], a[4:7], a[36:39], v[144:159]
  ds_read_b128 a[28:31], v19 offset:8192
  v_xor_b32 v54, 128, v52
  v_xor_b32 v55, 192, v52
  s_waitcnt lgkmcnt(4)
  v_mfma_f32_32x32x16_bf16 v[144:159], a[8:11], a[40:43], v[144:159]
  s_waitcnt vmcnt(63)
  s_barrier
  v_xor_b32 v12, 196608, v12
  v_xor_b32 v13, 196608, v13
  v_xor_b32 v14, 196608, v14
  v_xor_b32 v15, 196608, v15
  v_xor_b32 v16, 196608, v16
  v_xor_b32 v17, 196608, v17
  v_xor_b32 v18, 196608, v18
  v_xor_b32 v19, 196608, v19
  ds_read_b128 a[0:3], v12 offset:0
  v_add_u32 v56, 65536, v52
  v_add_u32 v57, 65536, v53
  v_mfma_f32_32x32x16_bf16 v[144:159], a[12:15], a[44:47], v[144:159]
  ds_read_b128 a[4:7], v13 offset:0
  v_add_u32 v58, 65536, v54
  v_add_u32 v59, 65536, v55
  s_waitcnt lgkmcnt(4)
  v_mfma_f32_32x32x16_bf16 v[144:159], a[16:19], a[48:51], v[144:159]
  ds_read_b128 a[8:11], v14 offset:0
  v_max_f32 v20, v128, v129
  v_max3_f32 v20, v20, v130, v131
  v_mfma_f32_32x32x16_bf16 v[144:159], a[20:23], a[52:55], v[144:159]
  ds_read_b128 a[12:15], v15 offset:0
  v_max3_f32 v20, v20, v132, v133
  v_max3_f32 v20, v20, v134, v135
  s_waitcnt lgkmcnt(4)
  v_mfma_f32_32x32x16_bf16 v[144:159], a[24:27], a[56:59], v[144:159]
  ds_read_b128 a[16:19], v16 offset:0
  v_max3_f32 v20, v20, v136, v137
  v_max3_f32 v20, v20, v138, v139
  v_mfma_f32_32x32x16_bf16 v[144:159], a[28:31], a[60:63], v[144:159]
  ds_read_b128 a[20:23], v17 offset:0
  v_max3_f32 v20, v20, v140, v141
  v_max3_f32 v20, v20, v142, v143
  s_waitcnt lgkmcnt(4)
  v_mfma_f32_32x32x16_bf16 v[160:175], a[0:3], a[32:35], 0
  ds_read_b128 a[24:27], v18 offset:0
  v_mfma_f32_32x32x16_bf16 v[160:175], a[4:7], a[36:39], v[160:175]
  ds_read_b128 a[28:31], v19 offset:0
  s_add_u32 m0, s28, 131072
  s_mov_b32 s31, 0
  buffer_load_dwordx4 v6, s[20:23], s31 offen offset:0 nt lds
  s_waitcnt lgkmcnt(4)
  v_mfma_f32_32x32x16_bf16 v[160:175], a[8:11], a[40:43], v[160:175]
  ds_read_b128 a[0:3], v12 offset:8192
  v_mfma_f32_32x32x16_bf16 v[160:175], a[12:15], a[44:47], v[160:175]
  ds_read_b128 a[4:7], v13 offset:8192
  s_add_u32 m0, s28, 131072
  s_nop 0
  buffer_load_dwordx4 v6, s[20:23], s31 offen offset:1024 nt lds
  s_waitcnt lgkmcnt(4)
  v_mfma_f32_32x32x16_bf16 v[160:175], a[16:19], a[48:51], v[160:175]
  ds_read_b128 a[8:11], v14 offset:8192
  v_max3_f32 v20, v20, v144, v145
  v_max3_f32 v20, v20, v146, v147
  v_mfma_f32_32x32x16_bf16 v[160:175], a[20:23], a[52:55], v[160:175]
  ds_read_b128 a[12:15], v15 offset:8192
  s_add_u32 m0, s28, 131072
  s_nop 0
  buffer_load_dwordx4 v6, s[20:23], s31 offen offset:2048 nt lds
  v_max3_f32 v20, v20, v148, v149
  v_max3_f32 v20, v20, v150, v151
  s_waitcnt lgkmcnt(4)
  v_mfma_f32_32x32x16_bf16 v[160:175], a[24:27], a[56:59], v[160:175]
  ds_read_b128 a[16:19], v16 offset:8192
  v_max3_f32 v20, v20, v152, v153
  v_max3_f32 v20, v20, v154, v155
  v_mfma_f32_32x32x16_bf16 v[160:175], a[28:31], a[60:63], v[160:175]
  ds_read_b128 a[20:23], v17 offset:8192
  s_add_u32 m0, s28, 131072
  s_nop 0
  buffer_load_dwordx4 v6, s[20:23], s31 offen offset:3072 nt lds
  v_max3_f32 v20, v20, v156, v157
  v_max3_f32 v20, v20, v158, v159
  s_waitcnt lgkmcnt(4)
  v_mfma_f32_32x32x16_bf16 v[176:191], a[0:3], a[32:35], 0
  ds_read_b128 a[24:27], v18 offset:8192
  v_mfma_f32_32x32x16_bf16 v[176:191], a[4:7], a[36:39], v[176:191]
  ds_read_b128 a[28:31], v19 offset:8192
  s_waitcnt lgkmcnt(4)
  v_mfma_f32_32x32x16_bf16 v[176:191], a[8:11], a[40:43], v[176:191]
  s_waitcnt vmcnt(8)
  s_barrier
  ds_read_b128 a[0:3], v12 offset:16384
  v_mfma_f32_32x32x16_bf16 v[176:191], a[12:15], a[44:47], v[176:191]
  ds_read_b128 a[4:7], v13 offset:16384
  s_waitcnt lgkmcnt(4)
  v_mfma_f32_32x32x16_bf16 v[176:191], a[16:19], a[48:51], v[176:191]
  ds_read_b128 a[8:11], v14 offset:16384
  v_max3_f32 v20, v20, v160, v161
  v_max3_f32 v20, v20, v162, v163
  v_mfma_f32_32x32x16_bf16 v[176:191], a[20:23], a[52:55], v[176:191]
  ds_read_b128 a[12:15], v15 offset:16384
  v_max3_f32 v20, v20, v164, v165
  v_max3_f32 v20, v20, v166, v167
  s_waitcnt lgkmcnt(4)
  v_mfma_f32_32x32x16_bf16 v[176:191], a[24:27], a[56:59], v[176:191]
  ds_read_b128 a[16:19], v16 offset:16384
  v_max3_f32 v20, v20, v168, v169
  v_max3_f32 v20, v20, v170, v171
  v_mfma_f32_32x32x16_bf16 v[176:191], a[28:31], a[60:63], v[176:191]
  ds_read_b128 a[20:23], v17 offset:16384
  v_max3_f32 v20, v20, v172, v173
  v_max3_f32 v20, v20, v174, v175
  s_nop 8
  v_max3_f32 v20, v20, v176, v177
  v_max3_f32 v20, v20, v178, v179
  v_max3_f32 v20, v20, v180, v181
  v_max3_f32 v20, v20, v182, v183
  v_max3_f32 v20, v20, v184, v185
  v_max3_f32 v20, v20, v186, v187
  v_max3_f32 v20, v20, v188, v189
  v_max3_f32 v20, v20, v190, v191
  v_mov_b32 v25, v20
  s_nop 1
  v_permlane32_swap_b32 v25, v20
  v_max_f32 v20, v25, v20
  v_sub_f32 v32, 0, v20
  v_sub_f32 v33, 0, v20
  v_sub_f32 v34, 0, v20
  v_sub_f32 v35, 0, v20
  v_sub_f32 v36, 0, v20
  v_sub_f32 v37, 0, v20
  v_sub_f32 v38, 0, v20
  v_sub_f32 v39, 0, v20
  v_sub_f32 v40, 0, v20
  v_sub_f32 v41, 0, v20
  v_sub_f32 v42, 0, v20
  v_sub_f32 v43, 0, v20
  v_sub_f32 v44, 0, v20
  v_sub_f32 v45, 0, v20
  v_sub_f32 v46, 0, v20
  v_sub_f32 v47, 0, v20
  s_waitcnt lgkmcnt(4)
  s_nop 0
  v_mfma_f32_32x32x16_bf16 v[192:207], a[0:3], a[32:35], v[32:47]
  ds_read_b128 a[24:27], v18 offset:16384
  v_add_f32 v128, v128, v32
  v_add_f32 v129, v129, v32
  v_add_f32 v130, v130, v32
  v_add_f32 v131, v131, v32
  v_add_f32 v132, v132, v32
  v_add_f32 v133, v133, v32
  v_add_f32 v134, v134, v32
  v_mfma_f32_32x32x16_bf16 v[192:207], a[4:7], a[36:39], v[192:207]
  ds_read_b128 a[28:31], v19 offset:16384
  s_add_u32 m0, s28, 147456
  s_mov_b32 s31, 16384
  buffer_load_dwordx4 v6, s[20:23], s31 offen offset:0 nt lds
  v_add_f32 v135, v135, v32
  v_exp_f32 v128, v128
  s_waitcnt lgkmcnt(4)
  v_mfma_f32_32x32x16_bf16 v[192:207], a[8:11], a[40:43], v[192:207]
  ds_read_b128 a[0:3], v12 offset:24576
  v_exp_f32 v129, v129
  v_exp_f32 v130, v130
  v_exp_f32 v131, v131
  v_mfma_f32_32x32x16_bf16 v[192:207], a[12:15], a[44:47], v[192:207]
  ds_read_b128 a[4:7], v13 offset:24576
  s_add_u32 m0, s28, 147456
  s_nop 0
  buffer_load_dwordx4 v6, s[20:23], s31 offen offset:1024 nt lds
  v_exp_f32 v132, v132
  v_exp_f32 v133, v133
  s_waitcnt lgkmcnt(4)
  v_mfma_f32_32x32x16_bf16 v[192:207], a[16:19], a[48:51], v[192:207]
  ds_read_b128 a[8:11], v14 offset:24576
  v_exp_f32 v134, v134
  v_exp_f32 v135, v135
  v_cvt_pk_bf16_f32 v128, v128, v129
  v_cvt_pk_bf16_f32 v129, v130, v131
  v_cvt_pk_bf16_f32 v130, v132, v133
  v_mfma_f32_32x32x16_bf16 v[192:207], a[20:23], a[52:55], v[192:207]
  ds_read_b128 a[12:15], v15 offset:24576
  s_add_u32 m0, s28, 147456
  s_nop 0
  buffer_load_dwordx4 v6, s[20:23], s31 offen offset:2048 nt lds
  v_cvt_pk_bf16_f32 v131, v134, v135
  v_add_f32 v136, v136, v32
  v_add_f32 v137, v137, v32
  v_add_f32 v138, v138, v32
  v_add_f32 v139, v139, v32
  s_waitcnt lgkmcnt(4)
  v_mfma_f32_32x32x16_bf16 v[192:207], a[24:27], a[56:59], v[192:207]
  ds_read_b128 a[16:19], v16 offset:24576
  v_add_f32 v140, v140, v32
  v_add_f32 v141, v141, v32
  v_add_f32 v142, v142, v32
  v_add_f32 v143, v143, v32
  v_exp_f32 v136, v136
  v_mfma_f32_32x32x16_bf16 v[192:207], a[28:31], a[60:63], v[192:207]
  ds_read_b128 a[20:23], v17 offset:24576
  s_add_u32 m0, s28, 147456
  s_nop 0
  buffer_load_dwordx4 v6, s[20:23], s31 offen offset:3072 nt lds
  v_exp_f32 v137, v137
  v_exp_f32 v138, v138
  s_waitcnt lgkmcnt(4)
  v_mfma_f32_32x32x16_bf16 v[208:223], a[0:3], a[32:35], v[32:47]
  ds_read_b128 a[24:27], v18 offset:24576
  v_exp_f32 v139, v139
  v_exp_f32 v140, v140
  v_exp_f32 v141, v141
  v_mfma_f32_32x32x16_bf16 v[208:223], a[4:7], a[36:39], v[208:223]
  ds_read_b128 a[28:31], v19 offset:24576
  v_exp_f32 v142, v142
  v_exp_f32 v143, v143
  v_cvt_pk_bf16_f32 v136, v136, v137
  v_cvt_pk_bf16_f32 v137, v138, v139
  v_cvt_pk_bf16_f32 v138, v140, v141
  s_waitcnt lgkmcnt(4)
  v_mfma_f32_32x32x16_bf16 v[208:223], a[8:11], a[40:43], v[208:223]
  s_waitcnt vmcnt(8)
  s_barrier
  ds_read_b128 a[0:3], v12 offset:32768
  v_cvt_pk_bf16_f32 v139, v142, v143
  v_add_f32 v144, v144, v32
  v_add_f32 v145, v145, v32
  v_add_f32 v146, v146, v32
  v_add_f32 v147, v147, v32
  v_add_f32 v148, v148, v32
  v_add_f32 v149, v149, v32
  v_mfma_f32_32x32x16_bf16 v[208:223], a[12:15], a[44:47], v[208:223]
  ds_read_b128 a[4:7], v13 offset:32768
  v_add_f32 v150, v150, v32
  v_add_f32 v151, v151, v32
  v_exp_f32 v144, v144
  v_exp_f32 v145, v145
  s_waitcnt lgkmcnt(4)
  v_mfma_f32_32x32x16_bf16 v[208:223], a[16:19], a[48:51], v[208:223]
  ds_read_b128 a[8:11], v14 offset:32768
  v_max_f32 v20, v192, v193
  v_max3_f32 v20, v20, v194, v195
  v_exp_f32 v146, v146
  v_exp_f32 v147, v147
  v_mfma_f32_32x32x16_bf16 v[208:223], a[20:23], a[52:55], v[208:223]
  ds_read_b128 a[12:15], v15 offset:32768
  v_max3_f32 v20, v20, v196, v197
  v_max3_f32 v20, v20, v198, v199
  v_exp_f32 v148, v148
  v_exp_f32 v149, v149
  s_waitcnt lgkmcnt(4)
  v_mfma_f32_32x32x16_bf16 v[208:223], a[24:27], a[56:59], v[208:223]
  ds_read_b128 a[16:19], v16 offset:32768
  v_max3_f32 v20, v20, v200, v201
  v_max3_f32 v20, v20, v202, v203
  v_exp_f32 v150, v150
  v_exp_f32 v151, v151
  v_cvt_pk_bf16_f32 v144, v144, v145
  v_mfma_f32_32x32x16_bf16 v[208:223], a[28:31], a[60:63], v[208:223]
  ds_read_b128 a[20:23], v17 offset:32768
  v_max3_f32 v20, v20, v204, v205
  v_max3_f32 v20, v20, v206, v207
  v_cvt_pk_bf16_f32 v145, v146, v147
  v_cvt_pk_bf16_f32 v146, v148, v149
  v_cvt_pk_bf16_f32 v147, v150, v151
  v_add_f32 v152, v152, v32
  v_add_f32 v153, v153, v32
  s_waitcnt lgkmcnt(4)
  v_mfma_f32_32x32x16_bf16 v[224:239], a[0:3], a[32:35], v[32:47]
  ds_read_b128 a[24:27], v18 offset:32768
  v_add_f32 v154, v154, v32
  v_add_f32 v155, v155, v32
  v_add_f32 v156, v156, v32
  v_add_f32 v157, v157, v32
  v_add_f32 v158, v158, v32
  v_add_f32 v159, v159, v32
  v_mfma_f32_32x32x16_bf16 v[224:239], a[4:7], a[36:39], v[224:239]
  ds_read_b128 a[28:31], v19 offset:32768
  s_add_u32 m0, s28, 81920
  s_mov_b32 s31, 65536
  buffer_load_dwordx4 v2, s[16:19], s31 offen offset:0 nt lds
  v_exp_f32 v152, v152
  v_exp_f32 v153, v153
  s_waitcnt lgkmcnt(4)
  v_mfma_f32_32x32x16_bf16 v[224:239], a[8:11], a[40:43], v[224:239]
  ds_read_b128 a[0:3], v12 offset:40960
  v_exp_f32 v154, v154
  v_exp_f32 v155, v155
  v_exp_f32 v156, v156
  v_mfma_f32_32x32x16_bf16 v[224:239], a[12:15], a[44:47], v[224:239]
  ds_read_b128 a[4:7], v13 offset:40960
  s_add_u32 m0, s28, 81920
  s_nop 0
  buffer_load_dwordx4 v3, s[16:19], s31 offen offset:1024 nt lds
  v_exp_f32 v157, v157
  v_exp_f32 v158, v158
  s_waitcnt lgkmcnt(4)
  v_mfma_f32_32x32x16_bf16 v[224:239], a[16:19], a[48:51], v[224:239]
  ds_read_b128 a[8:11], v14 offset:40960
  v_max3_f32 v20, v20, v208, v209
  v_max3_f32 v20, v20, v210, v211
  v_exp_f32 v159, v159
  v_cvt_pk_bf16_f32 v152, v152, v153
  v_cvt_pk_bf16_f32 v153, v154, v155
  v_cvt_pk_bf16_f32 v154, v156, v157
  v_mfma_f32_32x32x16_bf16 v[224:239], a[20:23], a[52:55], v[224:239]
  ds_read_b128 a[12:15], v15 offset:40960
  s_add_u32 m0, s28, 81920
  s_nop 0
  buffer_load_dwordx4 v4, s[16:19], s31 offen offset:2048 nt lds
  v_max3_f32 v20, v20, v212, v213
  v_max3_f32 v20, v20, v214, v215
  v_cvt_pk_bf16_f32 v155, v158, v159
  v_add_f32 v160, v160, v32
  v_add_f32 v161, v161, v32
  s_waitcnt lgkmcnt(4)
  v_mfma_f32_32x32x16_bf16 v[224:239], a[24:27], a[56:59], v[224:239]
  ds_read_b128 a[16:19], v16 offset:40960
  v_max3_f32 v20, v20, v216, v217
  v_max3_f32 v20, v20, v218, v219
  v_add_f32 v162, v162, v32
  v_add_f32 v163, v163, v32
  v_add_f32 v164, v164, v32
  v_add_f32 v165, v165, v32
  v_add_f32 v166, v166, v32
  v_mfma_f32_32x32x16_bf16 v[224:239], a[28:31], a[60:63], v[224:239]
  ds_read_b128 a[20:23], v17 offset:40960
  s_add_u32 m0, s28, 81920
  s_nop 0
  buffer_load_dwordx4 v5, s[16:19], s31 offen offset:3072 nt lds
  v_max3_f32 v20, v20, v220, v221
  v_max3_f32 v20, v20, v222, v223
  v_add_f32 v167, v167, v32
  v_exp_f32 v160, v160
  s_waitcnt lgkmcnt(4)
  v_mfma_f32_32x32x16_bf16 v[240:255], a[0:3], a[32:35], v[32:47]
  ds_read_b128 a[24:27], v18 offset:40960
  v_exp_f32 v161, v161
  v_exp_f32 v162, v162
  v_exp_f32 v163, v163
  v_mfma_f32_32x32x16_bf16 v[240:255], a[4:7], a[36:39], v[240:255]
  ds_read_b128 a[28:31], v19 offset:40960
  v_exp_f32 v164, v164
  v_exp_f32 v165, v165
  v_exp_f32 v166, v166
  s_waitcnt lgkmcnt(4)
  v_mfma_f32_32x32x16_bf16 v[240:255], a[8:11], a[40:43], v[240:255]
  s_waitcnt vmcnt(8)
  s_barrier
  buffer_load_dword v28, off, s[84:87], 0 sc1
  v_exp_f32 v167, v167
  v_cvt_pk_bf16_f32 v160, v160, v161
  v_cvt_pk_bf16_f32 v161, v162, v163
  v_cvt_pk_bf16_f32 v162, v164, v165
  v_cvt_pk_bf16_f32 v163, v166, v167
  v_add_f32 v168, v168, v32
  v_add_f32 v169, v169, v32
  v_mfma_f32_32x32x16_bf16 v[240:255], a[12:15], a[44:47], v[240:255]
  ds_read_b64_tr_b16 a[0:1], v52 offset:49152
  ds_read_b64_tr_b16 a[2:3], v52 offset:50176
  v_add_f32 v170, v170, v32
  v_add_f32 v171, v171, v32
  v_add_f32 v172, v172, v32
  v_add_f32 v173, v173, v32
  v_add_f32 v174, v174, v32
  v_add_f32 v175, v175, v32
  s_waitcnt lgkmcnt(4)
  v_mfma_f32_32x32x16_bf16 v[240:255], a[16:19], a[48:51], v[240:255]
  ds_read_b64_tr_b16 a[4:5], v53 offset:49152
  ds_read_b64_tr_b16 a[6:7], v53 offset:50176
  v_max3_f32 v20, v20, v224, v225
  v_max3_f32 v20, v20, v226, v227
  v_exp_f32 v168, v168
  v_exp_f32 v169, v169
  v_mfma_f32_32x32x16_bf16 v[240:255], a[20:23], a[52:55], v[240:255]
  ds_read_b64_tr_b16 a[8:9], v54 offset:49152
  ds_read_b64_tr_b16 a[10:11], v54 offset:50176
  v_max3_f32 v20, v20, v228, v229
  v_max3_f32 v20, v20, v230, v231
  v_exp_f32 v170, v170
  v_exp_f32 v171, v171
  s_waitcnt lgkmcnt(6)
  v_mfma_f32_32x32x16_bf16 v[240:255], a[24:27], a[56:59], v[240:255]
  ds_read_b64_tr_b16 a[12:13], v55 offset:49152
  ds_read_b64_tr_b16 a[14:15], v55 offset:50176
  v_max3_f32 v20, v20, v232, v233
  v_max3_f32 v20, v20, v234, v235
  v_exp_f32 v172, v172
  v_exp_f32 v173, v173
  v_mfma_f32_32x32x16_bf16 v[240:255], a[28:31], a[60:63], v[240:255]
  v_max3_f32 v20, v20, v236, v237
  v_max3_f32 v20, v20, v238, v239
  v_exp_f32 v174, v174
  v_exp_f32 v175, v175
  v_cvt_pk_bf16_f32 v168, v168, v169
  v_cvt_pk_bf16_f32 v169, v170, v171
  v_mfma_f32_32x32x16_bf16 a[120:135], a[116:119], v[128:131], 0
  ds_read_b64_tr_b16 a[16:17], v52 offset:53248
  ds_read_b64_tr_b16 a[18:19], v52 offset:54272
  v_cvt_pk_bf16_f32 v170, v172, v173
  v_cvt_pk_bf16_f32 v171, v174, v175
  v_add_f32 v176, v176, v32
  v_add_f32 v177, v177, v32
  v_add_f32 v178, v178, v32
  v_add_f32 v179, v179, v32
  s_waitcnt lgkmcnt(6)
  v_mfma_f32_32x32x16_bf16 v[64:79], a[0:3], v[128:131], 0
  ds_read_b64_tr_b16 a[20:21], v53 offset:53248
  ds_read_b64_tr_b16 a[22:23], v53 offset:54272
  s_add_u32 m0, s28, 98304
  s_mov_b32 s31, 81920
  buffer_load_dwordx4 v2, s[16:19], s31 offen offset:0 nt lds
  v_add_f32 v180, v180, v32
  v_add_f32 v181, v181, v32
  v_add_f32 v182, v182, v32
  v_mfma_f32_32x32x16_bf16 v[80:95], a[4:7], v[128:131], 0
  ds_read_b64_tr_b16 a[24:25], v54 offset:53248
  ds_read_b64_tr_b16 a[26:27], v54 offset:54272
  v_add_f32 v183, v183, v32
  v_exp_f32 v176, v176
  v_exp_f32 v177, v177
  s_waitcnt lgkmcnt(6)
  v_mfma_f32_32x32x16_bf16 v[96:111], a[8:11], v[128:131], 0
  ds_read_b64_tr_b16 a[28:29], v55 offset:53248
  ds_read_b64_tr_b16 a[30:31], v55 offset:54272
  s_add_u32 m0, s28, 98304
  s_nop 0
  buffer_load_dwordx4 v3, s[16:19], s31 offen offset:1024 nt lds
  v_max3_f32 v20, v20, v240, v241
  v_max3_f32 v20, v20, v242, v243
  v_exp_f32 v178, v178
  v_mfma_f32_32x32x16_bf16 v[112:127], a[12:15], v[128:131], 0
  v_max3_f32 v20, v20, v244, v245
  v_max3_f32 v20, v20, v246, v247
  v_exp_f32 v179, v179
  v_exp_f32 v180, v180
  v_exp_f32 v181, v181
  v_mfma_f32_32x32x16_bf16 a[120:135], a[116:119], v[136:139], a[120:135]
  ds_read_b64_tr_b16 a[0:1], v52 offset:57344
  ds_read_b64_tr_b16 a[2:3], v52 offset:58368
  s_add_u32 m0, s28, 98304
  s_nop 0
  buffer_load_dwordx4 v4, s[16:19], s31 offen offset:2048 nt lds
  v_max3_f32 v20, v20, v248, v249
  v_max3_f32 v20, v20, v250, v251
  v_exp_f32 v182, v182
  s_waitcnt lgkmcnt(6)
  v_mfma_f32_32x32x16_bf16 v[64:79], a[16:19], v[136:139], v[64:79]
  ds_read_b64_tr_b16 a[4:5], v53 offset:57344
  ds_read_b64_tr_b16 a[6:7], v53 offset:58368
  v_max3_f32 v20, v20, v252, v253
  v_max3_f32 v20, v20, v254, v255
  v_exp_f32 v183, v183
  v_cvt_pk_bf16_f32 v176, v176, v177
  v_cvt_pk_bf16_f32 v177, v178, v179
  v_mfma_f32_32x32x16_bf16 v[80:95], a[20:23], v[136:139], v[80:95]
  ds_read_b64_tr_b16 a[8:9], v54 offset:57344
  ds_read_b64_tr_b16 a[10:11], v54 offset:58368
  s_add_u32 m0, s28, 98304
  s_nop 0
  buffer_load_dwordx4 v5, s[16:19], s31 offen offset:3072 nt lds
  v_cvt_pk_bf16_f32 v178, v180, v181
  v_cvt_pk_bf16_f32 v179, v182, v183
  v_add_f32 v184, v184, v32
  v_add_f32 v185, v185, v32
  s_waitcnt lgkmcnt(6)
  v_mfma_f32_32x32x16_bf16 v[96:111], a[24:27], v[136:139], v[96:111]
  ds_read_b64_tr_b16 a[12:13], v55 offset:57344
  ds_read_b64_tr_b16 a[14:15], v55 offset:58368
  v_add_f32 v186, v186, v32
  v_add_f32 v187, v187, v32
  v_add_f32 v188, v188, v32
  v_add_f32 v189, v189, v32
  v_add_f32 v190, v190, v32
  v_add_f32 v191, v191, v32
  v_mfma_f32_32x32x16_bf16 v[112:127], a[28:31], v[136:139], v[112:127]
  v_exp_f32 v184, v184
  v_exp_f32 v185, v185
  v_exp_f32 v186, v186
  v_exp_f32 v187, v187
  v_mfma_f32_32x32x16_bf16 a[120:135], a[116:119], v[144:147], a[120:135]
  ds_read_b64_tr_b16 a[16:17], v52 offset:61440
  ds_read_b64_tr_b16 a[18:19], v52 offset:62464
  v_exp_f32 v188, v188
  v_exp_f32 v189, v189
  v_exp_f32 v190, v190
  s_waitcnt lgkmcnt(6)
  v_mfma_f32_32x32x16_bf16 v[64:79], a[0:3], v[144:147], v[64:79]
  ds_read_b64_tr_b16 a[20:21], v53 offset:61440
  ds_read_b64_tr_b16 a[22:23], v53 offset:62464
  v_exp_f32 v191, v191
  v_cvt_pk_bf16_f32 v184, v184, v185
  v_cvt_pk_bf16_f32 v185, v186, v187
  v_cvt_pk_bf16_f32 v186, v188, v189
  v_cvt_pk_bf16_f32 v187, v190, v191
  v_mfma_f32_32x32x16_bf16 v[80:95], a[4:7], v[144:147], v[80:95]
  ds_read_b64_tr_b16 a[24:25], v54 offset:61440
  ds_read_b64_tr_b16 a[26:27], v54 offset:62464
  s_waitcnt lgkmcnt(6)
  v_mfma_f32_32x32x16_bf16 v[96:111], a[8:11], v[144:147], v[96:111]
  ds_read_b64_tr_b16 a[28:29], v55 offset:61440
  ds_read_b64_tr_b16 a[30:31], v55 offset:62464
  v_cmp_lt_f32 vcc, 1090519040, v20
  s_nop 0
  s_cmp_lg_u64 vcc, 0
  s_cbranch_scc1 L_rr1
L_rb2:
  v_mfma_f32_32x32x16_bf16 v[112:127], a[12:15], v[144:147], v[112:127]
  s_waitcnt vmcnt(9)
  s_barrier
  v_exp_f32 v192, v192
  v_exp_f32 v193, v193
  v_exp_f32 v194, v194
  v_mfma_f32_32x32x16_bf16 a[120:135], a[116:119], v[152:155], a[120:135]
  ds_read_b64_tr_b16 a[0:1], v56 offset:0
  ds_read_b64_tr_b16 a[2:3], v56 offset:1024
  v_exp_f32 v195, v195
  v_exp_f32 v196, v196
  s_waitcnt lgkmcnt(6)
  v_mfma_f32_32x32x16_bf16 v[64:79], a[16:19], v[152:155], v[64:79]
  ds_read_b64_tr_b16 a[4:5], v57 offset:0
  ds_read_b64_tr_b16 a[6:7], v57 offset:1024
  v_exp_f32 v197, v197
  v_exp_f32 v198, v198
  v_mfma_f32_32x32x16_bf16 v[80:95], a[20:23], v[152:155], v[80:95]
  ds_read_b64_tr_b16 a[8:9], v58 offset:0
  ds_read_b64_tr_b16 a[10:11], v58 offset:1024
  v_exp_f32 v199, v199
  v_cvt_pk_bf16_f32 v192, v192, v193
  v_cvt_pk_bf16_f32 v193, v194, v195
  s_waitcnt lgkmcnt(6)
  v_mfma_f32_32x32x16_bf16 v[96:111], a[24:27], v[152:155], v[96:111]
  ds_read_b64_tr_b16 a[12:13], v59 offset:0
  ds_read_b64_tr_b16 a[14:15], v59 offset:1024
  v_cvt_pk_bf16_f32 v194, v196, v197
  v_cvt_pk_bf16_f32 v195, v198, v199
  v_exp_f32 v200, v200
  v_mfma_f32_32x32x16_bf16 v[112:127], a[28:31], v[152:155], v[112:127]
  v_exp_f32 v201, v201
  v_exp_f32 v202, v202
  v_exp_f32 v203, v203
  v_mfma_f32_32x32x16_bf16 a[120:135], a[116:119], v[160:163], a[120:135]
  ds_read_b64_tr_b16 a[16:17], v56 offset:4096
  ds_read_b64_tr_b16 a[18:19], v56 offset:5120
  v_exp_f32 v204, v204
  v_exp_f32 v205, v205
  s_waitcnt lgkmcnt(6)
  v_mfma_f32_32x32x16_bf16 v[64:79], a[0:3], v[160:163], v[64:79]
  ds_read_b64_tr_b16 a[20:21], v57 offset:4096
  ds_read_b64_tr_b16 a[22:23], v57 offset:5120
  s_add_u32 m0, s28, 114688
  s_mov_b32 s31, 32768
  buffer_load_dwordx4 v6, s[20:23], s31 offen offset:0 nt lds
  v_mfma_f32_32x32x16_bf16 v[80:95], a[4:7], v[160:163], v[80:95]
  ds_read_b64_tr_b16 a[24:25], v58 offset:4096
  ds_read_b64_tr_b16 a[26:27], v58 offset:5120
  v_exp_f32 v206, v206
  v_exp_f32 v207, v207
  s_waitcnt lgkmcnt(6)
  v_mfma_f32_32x32x16_bf16 v[96:111], a[8:11], v[160:163], v[96:111]
  ds_read_b64_tr_b16 a[28:29], v59 offset:4096
  ds_read_b64_tr_b16 a[30:31], v59 offset:5120
  s_add_u32 m0, s28, 114688
  s_nop 0
  buffer_load_dwordx4 v6, s[20:23], s31 offen offset:1024 nt lds
  v_cvt_pk_bf16_f32 v200, v200, v201
  v_cvt_pk_bf16_f32 v201, v202, v203
  v_mfma_f32_32x32x16_bf16 v[112:127], a[12:15], v[160:163], v[112:127]
  v_cvt_pk_bf16_f32 v202, v204, v205
  v_cvt_pk_bf16_f32 v203, v206, v207
  v_exp_f32 v208, v208
  v_exp_f32 v209, v209
  v_mfma_f32_32x32x16_bf16 a[120:135], a[116:119], v[168:171], a[120:135]
  ds_read_b64_tr_b16 a[0:1], v56 offset:8192
  ds_read_b64_tr_b16 a[2:3], v56 offset:9216
  s_add_u32 m0, s28, 114688
  s_nop 0
  buffer_load_dwordx4 v6, s[20:23], s31 offen offset:2048 nt lds
  v_exp_f32 v210, v210
  s_waitcnt lgkmcnt(6)
  v_mfma_f32_32x32x16_bf16 v[64:79], a[16:19], v[168:171], v[64:79]
  ds_read_b64_tr_b16 a[4:5], v57 offset:8192
  ds_read_b64_tr_b16 a[6:7], v57 offset:9216
  v_exp_f32 v211, v211
  v_exp_f32 v212, v212
  v_mfma_f32_32x32x16_bf16 v[80:95], a[20:23], v[168:171], v[80:95]
  ds_read_b64_tr_b16 a[8:9], v58 offset:8192
  ds_read_b64_tr_b16 a[10:11], v58 offset:9216
  s_add_u32 m0, s28, 114688
  s_nop 0
  buffer_load_dwordx4 v6, s[20:23], s31 offen offset:3072 nt lds
  v_exp_f32 v213, v213
  s_waitcnt lgkmcnt(6)
  v_mfma_f32_32x32x16_bf16 v[96:111], a[24:27], v[168:171], v[96:111]
  ds_read_b64_tr_b16 a[12:13], v59 offset:8192
  ds_read_b64_tr_b16 a[14:15], v59 offset:9216
  v_exp_f32 v214, v214
  v_exp_f32 v215, v215
  v_mfma_f32_32x32x16_bf16 v[112:127], a[28:31], v[168:171], v[112:127]
  v_cvt_pk_bf16_f32 v208, v208, v209
  v_cvt_pk_bf16_f32 v209, v210, v211
  v_cvt_pk_bf16_f32 v210, v212, v213
  v_cvt_pk_bf16_f32 v211, v214, v215
  v_exp_f32 v216, v216
  v_mfma_f32_32x32x16_bf16 a[120:135], a[116:119], v[176:179], a[120:135]
  ds_read_b64_tr_b16 a[16:17], v56 offset:12288
  ds_read_b64_tr_b16 a[18:19], v56 offset:13312
  v_exp_f32 v217, v217
  v_exp_f32 v218, v218
  s_waitcnt lgkmcnt(6)
  v_mfma_f32_32x32x16_bf16 v[64:79], a[0:3], v[176:179], v[64:79]
  ds_read_b64_tr_b16 a[20:21], v57 offset:12288
  ds_read_b64_tr_b16 a[22:23], v57 offset:13312
  v_exp_f32 v219, v219
  v_exp_f32 v220, v220
  v_mfma_f32_32x32x16_bf16 v[80:95], a[4:7], v[176:179], v[80:95]
  ds_read_b64_tr_b16 a[24:25], v58 offset:12288
  ds_read_b64_tr_b16 a[26:27], v58 offset:13312
  v_exp_f32 v221, v221
  v_exp_f32 v222, v222
  s_waitcnt lgkmcnt(6)
  v_mfma_f32_32x32x16_bf16 v[96:111], a[8:11], v[176:179], v[96:111]
  ds_read_b64_tr_b16 a[28:29], v59 offset:12288
  ds_read_b64_tr_b16 a[30:31], v59 offset:13312
  v_exp_f32 v223, v223
  v_cvt_pk_bf16_f32 v216, v216, v217
  v_cvt_pk_bf16_f32 v217, v218, v219
  v_mfma_f32_32x32x16_bf16 v[112:127], a[12:15], v[176:179], v[112:127]
  s_waitcnt vmcnt(9)
  s_barrier
  ds_read_b128 a[0:3], v12 offset:0
  v_cvt_pk_bf16_f32 v218, v220, v221
  v_cvt_pk_bf16_f32 v219, v222, v223
  v_exp_f32 v224, v224
  v_mfma_f32_32x32x16_bf16 a[120:135], a[116:119], v[184:187], a[120:135]
  ds_read_b128 a[4:7], v13 offset:0
  v_exp_f32 v225, v225
  v_exp_f32 v226, v226
  s_waitcnt lgkmcnt(6)
  v_mfma_f32_32x32x16_bf16 v[64:79], a[16:19], v[184:187], v[64:79]
  ds_read_b128 a[8:11], v14 offset:0
  v_exp_f32 v227, v227
  v_exp_f32 v228, v228
  v_mfma_f32_32x32x16_bf16 v[80:95], a[20:23], v[184:187], v[80:95]
  ds_read_b128 a[12:15], v15 offset:0
  v_exp_f32 v229, v229
  v_exp_f32 v230, v230
  s_waitcnt lgkmcnt(4)
  v_mfma_f32_32x32x16_bf16 v[96:111], a[24:27], v[184:187], v[96:111]
  ds_read_b128 a[16:19], v16 offset:0
  v_exp_f32 v231, v231
  v_cvt_pk_bf16_f32 v224, v224, v225
  v_cvt_pk_bf16_f32 v225, v226, v227
  v_cvt_pk_bf16_f32 v226, v228, v229
  v_mfma_f32_32x32x16_bf16 v[112:127], a[28:31], v[184:187], v[112:127]
  ds_read_b128 a[20:23], v17 offset:0
  v_cvt_pk_bf16_f32 v227, v230, v231
  v_exp_f32 v232, v232
  v_exp_f32 v233, v233
  s_waitcnt lgkmcnt(4)
  v_mfma_f32_32x32x16_bf16 v[128:143], a[0:3], a[32:35], v[32:47]
  ds_read_b128 a[24:27], v18 offset:0
  s_cmp_lg_u32 s61, 0
  s_cbranch_scc1 L_rr3
L_rb4:
  v_exp_f32 v234, v234
  v_mfma_f32_32x32x16_bf16 v[128:143], a[4:7], a[36:39], v[128:143]
  ds_read_b128 a[28:31], v19 offset:0
  s_add_u32 m0, s28, 131072
  s_mov_b32 s31, 49152
  buffer_load_dwordx4 v6, s[20:23], s31 offen offset:0 nt lds
  v_exp_f32 v235, v235
  s_waitcnt lgkmcnt(4)
  v_mfma_f32_32x32x16_bf16 v[128:143], a[8:11], a[40:43], v[128:143]
  ds_read_b128 a[0:3], v12 offset:8192
  v_exp_f32 v236, v236
  v_exp_f32 v237, v237
  v_mfma_f32_32x32x16_bf16 v[128:143], a[12:15], a[44:47], v[128:143]
  ds_read_b128 a[4:7], v13 offset:8192
  s_add_u32 m0, s28, 131072
  s_nop 0
  buffer_load_dwordx4 v6, s[20:23], s31 offen offset:1024 nt lds
  v_exp_f32 v238, v238
  s_waitcnt lgkmcnt(4)
  v_mfma_f32_32x32x16_bf16 v[128:143], a[16:19], a[48:51], v[128:143]
  ds_read_b128 a[8:11], v14 offset:8192
  v_exp_f32 v239, v239
  v_cvt_pk_bf16_f32 v232, v232, v233
  v_cvt_pk_bf16_f32 v233, v234, v235
  v_cvt_pk_bf16_f32 v234, v236, v237
  v_mfma_f32_32x32x16_bf16 v[128:143], a[20:23], a[52:55], v[128:143]
  ds_read_b128 a[12:15], v15 offset:8192
  s_add_u32 m0, s28, 131072
  s_nop 0
  buffer_load_dwordx4 v6, s[20:23], s31 offen offset:2048 nt lds
  v_cvt_pk_bf16_f32 v235, v238, v239
  v_exp_f32 v240, v240
  s_waitcnt lgkmcnt(4)
  v_mfma_f32_32x32x16_bf16 v[128:143], a[24:27], a[56:59], v[128:143]
  ds_read_b128 a[16:19], v16 offset:8192
  v_exp_f32 v241, v241
  v_exp_f32 v242, v242
  v_mfma_f32_32x32x16_bf16 v[128:143], a[28:31], a[60:63], v[128:143]
  ds_read_b128 a[20:23], v17 offset:8192
  s_add_u32 m0, s28, 131072
  s_nop 0
  buffer_load_dwordx4 v6, s[20:23], s31 offen offset:3072 nt lds
  v_exp_f32 v243, v243
  s_waitcnt lgkmcnt(4)
  v_mfma_f32_32x32x16_bf16 v[144:159], a[0:3], a[32:35], v[32:47]
  ds_read_b128 a[24:27], v18 offset:8192
  v_exp_f32 v244, v244
  v_exp_f32 v245, v245
  v_mfma_f32_32x32x16_bf16 v[144:159], a[4:7], a[36:39], v[144:159]
  ds_read_b128 a[28:31], v19 offset:8192
  v_exp_f32 v246, v246
  v_exp_f32 v247, v247
  v_cvt_pk_bf16_f32 v240, v240, v241
  s_waitcnt lgkmcnt(4)
  v_mfma_f32_32x32x16_bf16 v[144:159], a[8:11], a[40:43], v[144:159]
  s_waitcnt vmcnt(8)
  s_barrier
  s_mov_b32 s101, 0
L_nc5:
  v_readfirstlane_b32 s63, v28
  s_add_u32 s101, s101, 1
  s_cmp_lg_u32 s63, 0
  s_cbranch_scc1 L_nc6
  s_cmp_ge_u32 s101, 262144
  s_cbranch_scc1 L_nc6
  s_sleep 8
  buffer_load_dword v28, off, s[84:87], 0 sc1
  s_waitcnt vmcnt(0)
  s_branch L_nc5
L_nc6:
  s_getreg_b32 s100, hwreg(HW_REG_XCC_ID)
  s_and_b32 s100, s100, 15
  s_lshl_b32 s101, s63, 4
  s_or_b32 s100, s100, s101
  v_mov_b32 v11, s100
  s_lshl_b32 s100, s2, 10
  buffer_store_dword v11, off, s[88:91], s100 offset:512 sc1
  ds_read_b128 a[0:3], v12 offset:16384
  v_cvt_pk_bf16_f32 v241, v242, v243
  v_cvt_pk_bf16_f32 v242, v244, v245
  v_cvt_pk_bf16_f32 v243, v246, v247
  v_exp_f32 v248, v248
  v_mfma_f32_32x32x16_bf16 v[144:159], a[12:15], a[44:47], v[144:159]
  ds_read_b128 a[4:7], v13 offset:16384
  v_exp_f32 v249, v249
  v_exp_f32 v250, v250
  s_waitcnt lgkmcnt(4)
  v_mfma_f32_32x32x16_bf16 v[144:159], a[16:19], a[48:51], v[144:159]
  ds_read_b128 a[8:11], v14 offset:16384
  v_max_f32 v20, v128, v129
  v_max3_f32 v20, v20, v130, v131
  v_exp_f32 v251, v251
  v_mfma_f32_32x32x16_bf16 v[144:159], a[20:23], a[52:55], v[144:159]
  ds_read_b128 a[12:15], v15 offset:16384
  v_max3_f32 v20, v20, v132, v133
  v_max3_f32 v20, v20, v134, v135
  v_exp_f32 v252, v252
  s_waitcnt lgkmcnt(4)
  v_mfma_f32_32x32x16_bf16 v[144:159], a[24:27], a[56:59], v[144:159]
  ds_read_b128 a[16:19], v16 offset:16384
  v_max3_f32 v20, v20, v136, v137
  v_max3_f32 v20, v20, v138, v139
  v_exp_f32 v253, v253
  v_mfma_f32_32x32x16_bf16 v[144:159], a[28:31], a[60:63], v[144:159]
  ds_read_b128 a[20:23], v17 offset:16384
  v_max3_f32 v20, v20, v140, v141
  v_max3_f32 v20, v20, v142, v143
  v_exp_f32 v254, v254
  s_waitcnt lgkmcnt(4)
  v_mfma_f32_32x32x16_bf16 v[160:175], a[0:3], a[32:35], v[32:47]
  ds_read_b128 a[24:27], v18 offset:16384
  v_exp_f32 v255, v255
  v_cvt_pk_bf16_f32 v248, v248, v249
  v_cvt_pk_bf16_f32 v249, v250, v251
  v_cvt_pk_bf16_f32 v250, v252, v253
  v_mfma_f32_32x32x16_bf16 v[160:175], a[4:7], a[36:39], v[160:175]
  ds_read_b128 a[28:31], v19 offset:16384
  s_add_u32 m0, s28, 147456
  s_mov_b32 s31, 98304
  buffer_load_dwordx4 v2, s[16:19], s31 offen offset:0 nt lds
  v_cvt_pk_bf16_f32 v251, v254, v255
  s_waitcnt lgkmcnt(4)
  v_mfma_f32_32x32x16_bf16 v[160:175], a[8:11], a[40:43], v[160:175]
  ds_read_b128 a[0:3], v12 offset:24576
  v_mfma_f32_32x32x16_bf16 v[160:175], a[12:15], a[44:47], v[160:175]
  ds_read_b128 a[4:7], v13 offset:24576
  s_add_u32 m0, s28, 147456
  s_nop 0
  buffer_load_dwordx4 v3, s[16:19], s31 offen offset:1024 nt lds
  s_waitcnt lgkmcnt(4)
  v_mfma_f32_32x32x16_bf16 v[160:175], a[16:19], a[48:51], v[160:175]
  ds_read_b128 a[8:11], v14 offset:24576
  v_max3_f32 v20, v20, v144, v145
  v_max3_f32 v20, v20, v146, v147
  v_mfma_f32_32x32x16_bf16 v[160:175], a[20:23], a[52:55], v[160:175]
  ds_read_b128 a[12:15], v15 offset:24576
  s_add_u32 m0, s28, 147456
  s_nop 0
  buffer_load_dwordx4 v4, s[16:19], s31 offen offset:2048 nt lds
  v_max3_f32 v20, v20, v148, v149
  v_max3_f32 v20, v20, v150, v151
  s_waitcnt lgkmcnt(4)
  v_mfma_f32_32x32x16_bf16 v[160:175], a[24:27], a[56:59], v[160:175]
  ds_read_b128 a[16:19], v16 offset:24576
  v_max3_f32 v20, v20, v152, v153
  v_max3_f32 v20, v20, v154, v155
  v_mfma_f32_32x32x16_bf16 v[160:175], a[28:31], a[60:63], v[160:175]
  ds_read_b128 a[20:23], v17 offset:24576
  s_add_u32 m0, s28, 147456
  s_nop 0
  buffer_load_dwordx4 v5, s[16:19], s31 offen offset:3072 nt lds
  v_max3_f32 v20, v20, v156, v157
  v_max3_f32 v20, v20, v158, v159
  s_waitcnt lgkmcnt(4)
  v_mfma_f32_32x32x16_bf16 v[176:191], a[0:3], a[32:35], v[32:47]
  ds_read_b128 a[24:27], v18 offset:24576
  v_mfma_f32_32x32x16_bf16 v[176:191], a[4:7], a[36:39], v[176:191]
  ds_read_b128 a[28:31], v19 offset:24576
  s_waitcnt lgkmcnt(4)
  v_mfma_f32_32x32x16_bf16 v[176:191], a[8:11], a[40:43], v[176:191]
  s_waitcnt vmcnt(9)
  s_barrier
  v_mfma_f32_32x32x16_bf16 v[176:191], a[12:15], a[44:47], v[176:191]
  ds_read_b64_tr_b16 a[0:1], v52 offset:32768
  ds_read_b64_tr_b16 a[2:3], v52 offset:33792
  s_waitcnt lgkmcnt(4)
  v_mfma_f32_32x32x16_bf16 v[176:191], a[16:19], a[48:51], v[176:191]
  ds_read_b64_tr_b16 a[4:5], v53 offset:32768
  ds_read_b64_tr_b16 a[6:7], v53 offset:33792
  v_max3_f32 v20, v20, v160, v161
  v_max3_f32 v20, v20, v162, v163
  v_mfma_f32_32x32x16_bf16 v[176:191], a[20:23], a[52:55], v[176:191]
  ds_read_b64_tr_b16 a[8:9], v54 offset:32768
  ds_read_b64_tr_b16 a[10:11], v54 offset:33792
  v_max3_f32 v20, v20, v164, v165
  v_max3_f32 v20, v20, v166, v167
  s_waitcnt lgkmcnt(6)
  v_mfma_f32_32x32x16_bf16 v[176:191], a[24:27], a[56:59], v[176:191]
  ds_read_b64_tr_b16 a[12:13], v55 offset:32768
  ds_read_b64_tr_b16 a[14:15], v55 offset:33792
  v_max3_f32 v20, v20, v168, v169
  v_max3_f32 v20, v20, v170, v171
  v_mfma_f32_32x32x16_bf16 v[176:191], a[28:31], a[60:63], v[176:191]
  v_max3_f32 v20, v20, v172, v173
  v_max3_f32 v20, v20, v174, v175
  v_mfma_f32_32x32x16_bf16 a[120:135], a[116:119], v[192:195], a[120:135]
  ds_read_b64_tr_b16 a[16:17], v52 offset:36864
  ds_read_b64_tr_b16 a[18:19], v52 offset:37888
  s_waitcnt lgkmcnt(6)
  v_mfma_f32_32x32x16_bf16 v[64:79], a[0:3], v[192:195], v[64:79]
  ds_read_b64_tr_b16 a[20:21], v53 offset:36864
  ds_read_b64_tr_b16 a[22:23], v53 offset:37888
  s_add_u32 m0, s28, 81920
  s_mov_b32 s31, 114688
  buffer_load_dwordx4 v2, s[16:19], s31 offen offset:0 nt lds
  v_mfma_f32_32x32x16_bf16 v[80:95], a[4:7], v[192:195], v[80:95]
  ds_read_b64_tr_b16 a[24:25], v54 offset:36864
  ds_read_b64_tr_b16 a[26:27], v54 offset:37888
  s_waitcnt lgkmcnt(6)
  v_mfma_f32_32x32x16_bf16 v[96:111], a[8:11], v[192:195], v[96:111]
  ds_read_b64_tr_b16 a[28:29], v55 offset:36864
  ds_read_b64_tr_b16 a[30:31], v55 offset:37888
  s_add_u32 m0, s28, 81920
  s_nop 0
  buffer_load_dwordx4 v3, s[16:19], s31 offen offset:1024 nt lds
  v_max3_f32 v20, v20, v176, v177
  v_max3_f32 v20, v20, v178, v179
  v_mfma_f32_32x32x16_bf16 v[112:127], a[12:15], v[192:195], v[112:127]
  v_max3_f32 v20, v20, v180, v181
  v_max3_f32 v20, v20, v182, v183
  v_mfma_f32_32x32x16_bf16 a[120:135], a[116:119], v[200:203], a[120:135]
  ds_read_b64_tr_b16 a[0:1], v52 offset:40960
  ds_read_b64_tr_b16 a[2:3], v52 offset:41984
  s_add_u32 m0, s28, 81920
  s_nop 0
  buffer_load_dwordx4 v4, s[16:19], s31 offen offset:2048 nt lds
  v_max3_f32 v20, v20, v184, v185
  v_max3_f32 v20, v20, v186, v187
  s_waitcnt lgkmcnt(6)
  v_mfma_f32_32x32x16_bf16 v[64:79], a[16:19], v[200:203], v[64:79]
  ds_read_b64_tr_b16 a[4:5], v53 offset:40960
  ds_read_b64_tr_b16 a[6:7], v53 offset:41984
  v_max3_f32 v20, v20, v188, v189
  v_max3_f32 v20, v20, v190, v191
  v_mfma_f32_32x32x16_bf16 v[80:95], a[20:23], v[200:203], v[80:95]
  ds_read_b64_tr_b16 a[8:9], v54 offset:40960
  ds_read_b64_tr_b16 a[10:11], v54 offset:41984
  s_add_u32 m0, s28, 81920
  s_nop 0
  buffer_load_dwordx4 v5, s[16:19], s31 offen offset:3072 nt lds
  v_cmp_lt_f32 vcc, 1090519040, v20
  s_nop 0
  s_cmp_lg_u64 vcc, 0
  s_cbranch_scc1 L_rr7
L_rb8:
  s_waitcnt lgkmcnt(6)
  v_mfma_f32_32x32x16_bf16 v[96:111], a[24:27], v[200:203], v[96:111]
  ds_read_b64_tr_b16 a[12:13], v55 offset:40960
  ds_read_b64_tr_b16 a[14:15], v55 offset:41984
  v_exp_f32 v128, v128
  v_mfma_f32_32x32x16_bf16 v[112:127], a[28:31], v[200:203], v[112:127]
  v_exp_f32 v129, v129
  v_exp_f32 v130, v130
  v_mfma_f32_32x32x16_bf16 a[120:135], a[116:119], v[208:211], a[120:135]
  ds_read_b64_tr_b16 a[16:17], v52 offset:45056
  ds_read_b64_tr_b16 a[18:19], v52 offset:46080
  v_exp_f32 v131, v131
  s_waitcnt lgkmcnt(6)
  v_mfma_f32_32x32x16_bf16 v[64:79], a[0:3], v[208:211], v[64:79]
  ds_read_b64_tr_b16 a[20:21], v53 offset:45056
  ds_read_b64_tr_b16 a[22:23], v53 offset:46080
  v_exp_f32 v132, v132
  v_mfma_f32_32x32x16_bf16 v[80:95], a[4:7], v[208:211], v[80:95]
  ds_read_b64_tr_b16 a[24:25], v54 offset:45056
  ds_read_b64_tr_b16 a[26:27], v54 offset:46080
  v_exp_f32 v133, v133
  s_waitcnt lgkmcnt(6)
  v_mfma_f32_32x32x16_bf16 v[96:111], a[8:11], v[208:211], v[96:111]
  ds_read_b64_tr_b16 a[28:29], v55 offset:45056
  ds_read_b64_tr_b16 a[30:31], v55 offset:46080
  v_exp_f32 v134, v134
  v_mfma_f32_32x32x16_bf16 v[112:127], a[12:15], v[208:211], v[112:127]
  s_waitcnt vmcnt(9)
  s_barrier
  v_exp_f32 v135, v135
  v_cvt_pk_bf16_f32 v128, v128, v129
  v_cvt_pk_bf16_f32 v129, v130, v131
  v_cvt_pk_bf16_f32 v130, v132, v133
  v_mfma_f32_32x32x16_bf16 a[120:135], a[116:119], v[216:219], a[120:135]
  ds_read_b64_tr_b16 a[0:1], v52 offset:49152
  ds_read_b64_tr_b16 a[2:3], v52 offset:50176
  v_cvt_pk_bf16_f32 v131, v134, v135
  v_exp_f32 v136, v136
  s_waitcnt lgkmcnt(6)
  v_mfma_f32_32x32x16_bf16 v[64:79], a[16:19], v[216:219], v[64:79]
  ds_read_b64_tr_b16 a[4:5], v53 offset:49152
  ds_read_b64_tr_b16 a[6:7], v53 offset:50176
  v_exp_f32 v137, v137
  v_mfma_f32_32x32x16_bf16 v[80:95], a[20:23], v[216:219], v[80:95]
  ds_read_b64_tr_b16 a[8:9], v54 offset:49152
  ds_read_b64_tr_b16 a[10:11], v54 offset:50176
  v_exp_f32 v138, v138
  s_waitcnt lgkmcnt(6)
  v_mfma_f32_32x32x16_bf16 v[96:111], a[24:27], v[216:219], v[96:111]
  ds_read_b64_tr_b16 a[12:13], v55 offset:49152
  ds_read_b64_tr_b16 a[14:15], v55 offset:50176
  v_exp_f32 v139, v139
  v_mfma_f32_32x32x16_bf16 v[112:127], a[28:31], v[216:219], v[112:127]
  v_exp_f32 v140, v140
  v_exp_f32 v141, v141
  v_mfma_f32_32x32x16_bf16 a[120:135], a[116:119], v[224:227], a[120:135]
  ds_read_b64_tr_b16 a[16:17], v52 offset:53248
  ds_read_b64_tr_b16 a[18:19], v52 offset:54272
  v_exp_f32 v142, v142
  s_waitcnt lgkmcnt(6)
  v_mfma_f32_32x32x16_bf16 v[64:79], a[0:3], v[224:227], v[64:79]
  ds_read_b64_tr_b16 a[20:21], v53 offset:53248
  ds_read_b64_tr_b16 a[22:23], v53 offset:54272
  s_add_u32 m0, s28, 98304
  s_mov_b32 s31, 65536
  buffer_load_dwordx4 v6, s[20:23], s31 offen offset:0 nt lds
  v_mfma_f32_32x32x16_bf16 v[80:95], a[4:7], v[224:227], v[80:95]
  ds_read_b64_tr_b16 a[24:25], v54 offset:53248
  ds_read_b64_tr_b16 a[26:27], v54 offset:54272
  v_exp_f32 v143, v143
  v_cvt_pk_bf16_f32 v136, v136, v137
  s_waitcnt lgkmcnt(6)
  v_mfma_f32_32x32x16_bf16 v[96:111], a[8:11], v[224:227], v[96:111]
  ds_read_b64_tr_b16 a[28:29], v55 offset:53248
  ds_read_b64_tr_b16 a[30:31], v55 offset:54272
  s_add_u32 m0, s28, 98304
  s_nop 0
  buffer_load_dwordx4 v6, s[20:23], s31 offen offset:1024 nt lds
  v_cvt_pk_bf16_f32 v137, v138, v139
  v_mfma_f32_32x32x16_bf16 v[112:127], a[12:15], v[224:227], v[112:127]
  v_cvt_pk_bf16_f32 v138, v140, v141
  v_cvt_pk_bf16_f32 v139, v142, v143
  v_exp_f32 v144, v144
  v_mfma_f32_32x32x16_bf16 a[120:135], a[116:119], v[232:235], a[120:135]
  ds_read_b64_tr_b16 a[0:1], v52 offset:57344
  ds_read_b64_tr_b16 a[2:3], v52 offset:58368
  s_add_u32 m0, s28, 98304
  s_nop 0
  buffer_load_dwordx4 v6, s[20:23], s31 offen offset:2048 nt lds
  s_waitcnt lgkmcnt(6)
  v_mfma_f32_32x32x16_bf16 v[64:79], a[16:19], v[232:235], v[64:79]
  ds_read_b64_tr_b16 a[4:5], v53 offset:57344
  ds_read_b64_tr_b16 a[6:7], v53 offset:58368
  v_exp_f32 v145, v145
  v_mfma_f32_32x32x16_bf16 v[80:95], a[20:23], v[232:235], v[80:95]
  ds_read_b64_tr_b16 a[8:9], v54 offset:57344
  ds_read_b64_tr_b16 a[10:11], v54 offset:58368
  s_add_u32 m0, s28, 98304
  s_nop 0
  buffer_load_dwordx4 v6, s[20:23], s31 offen offset:3072 nt lds
  s_waitcnt lgkmcnt(6)
  v_mfma_f32_32x32x16_bf16 v[96:111], a[24:27], v[232:235], v[96:111]
  ds_read_b64_tr_b16 a[12:13], v55 offset:57344
  ds_read_b64_tr_b16 a[14:15], v55 offset:58368
  v_exp_f32 v146, v146
  v_mfma_f32_32x32x16_bf16 v[112:127], a[28:31], v[232:235], v[112:127]
  v_exp_f32 v147, v147
  v_exp_f32 v148, v148
  v_mfma_f32_32x32x16_bf16 a[120:135], a[116:119], v[240:243], a[120:135]
  ds_read_b64_tr_b16 a[16:17], v52 offset:61440
  ds_read_b64_tr_b16 a[18:19], v52 offset:62464
  v_exp_f32 v149, v149
  s_waitcnt lgkmcnt(6)
  v_mfma_f32_32x32x16_bf16 v[64:79], a[0:3], v[240:243], v[64:79]
  ds_read_b64_tr_b16 a[20:21], v53 offset:61440
  ds_read_b64_tr_b16 a[22:23], v53 offset:62464
  v_exp_f32 v150, v150
  v_mfma_f32_32x32x16_bf16 v[80:95], a[4:7], v[240:243], v[80:95]
  ds_read_b64_tr_b16 a[24:25], v54 offset:61440
  ds_read_b64_tr_b16 a[26:27], v54 offset:62464
  v_exp_f32 v151, v151
  v_cvt_pk_bf16_f32 v144, v144, v145
  s_waitcnt lgkmcnt(6)
  v_mfma_f32_32x32x16_bf16 v[96:111], a[8:11], v[240:243], v[96:111]
  ds_read_b64_tr_b16 a[28:29], v55 offset:61440
  ds_read_b64_tr_b16 a[30:31], v55 offset:62464
  v_cvt_pk_bf16_f32 v145, v146, v147
  v_cvt_pk_bf16_f32 v146, v148, v149
  v_cvt_pk_bf16_f32 v147, v150, v151
  v_mfma_f32_32x32x16_bf16 v[112:127], a[12:15], v[240:243], v[112:127]
  s_waitcnt vmcnt(8)
  s_barrier
  v_xor_b32 v12, 196608, v12
  v_xor_b32 v13, 196608, v13
  v_xor_b32 v14, 196608, v14
  v_xor_b32 v15, 196608, v15
  v_xor_b32 v16, 196608, v16
  v_xor_b32 v17, 196608, v17
  v_xor_b32 v18, 196608, v18
  v_xor_b32 v19, 196608, v19
  ds_read_b128 a[0:3], v12 offset:0
  v_exp_f32 v152, v152
  v_exp_f32 v153, v153
  v_mfma_f32_32x32x16_bf16 a[120:135], a[116:119], v[248:251], a[120:135]
  ds_read_b128 a[4:7], v13 offset:0
  v_exp_f32 v154, v154
  v_exp_f32 v155, v155
  s_waitcnt lgkmcnt(6)
  v_mfma_f32_32x32x16_bf16 v[64:79], a[16:19], v[248:251], v[64:79]
  ds_read_b128 a[8:11], v14 offset:0
  v_exp_f32 v156, v156
  v_exp_f32 v157, v157
  v_mfma_f32_32x32x16_bf16 v[80:95], a[20:23], v[248:251], v[80:95]
  ds_read_b128 a[12:15], v15 offset:0
  v_exp_f32 v158, v158
  v_exp_f32 v159, v159
  s_waitcnt lgkmcnt(4)
  v_mfma_f32_32x32x16_bf16 v[96:111], a[24:27], v[248:251], v[96:111]
  ds_read_b128 a[16:19], v16 offset:0
  v_cvt_pk_bf16_f32 v152, v152, v153
  v_cvt_pk_bf16_f32 v153, v154, v155
  v_cvt_pk_bf16_f32 v154, v156, v157
  v_cvt_pk_bf16_f32 v155, v158, v159
  v_mfma_f32_32x32x16_bf16 v[112:127], a[28:31], v[248:251], v[112:127]
  ds_read_b128 a[20:23], v17 offset:0
  v_exp_f32 v160, v160
  v_exp_f32 v161, v161
  s_waitcnt lgkmcnt(4)
  v_mfma_f32_32x32x16_bf16 v[192:207], a[0:3], a[32:35], v[32:47]
  ds_read_b128 a[24:27], v18 offset:0
  s_cmp_lg_u32 s61, 0
  s_cbranch_scc1 L_rr9
L_rb10:
  v_exp_f32 v162, v162
  v_mfma_f32_32x32x16_bf16 v[192:207], a[4:7], a[36:39], v[192:207]
  ds_read_b128 a[28:31], v19 offset:0
  s_add_u32 m0, s28, 114688
  s_mov_b32 s31, 81920
  buffer_load_dwordx4 v6, s[20:23], s31 offen offset:0 nt lds
  s_waitcnt lgkmcnt(4)
  v_mfma_f32_32x32x16_bf16 v[192:207], a[8:11], a[40:43], v[192:207]
  ds_read_b128 a[0:3], v12 offset:8192
  v_exp_f32 v163, v163
  v_exp_f32 v164, v164
  v_mfma_f32_32x32x16_bf16 v[192:207], a[12:15], a[44:47], v[192:207]
  ds_read_b128 a[4:7], v13 offset:8192
  s_add_u32 m0, s28, 114688
  s_nop 0
  buffer_load_dwordx4 v6, s[20:23], s31 offen offset:1024 nt lds
  v_exp_f32 v165, v165
  s_waitcnt lgkmcnt(4)
  v_mfma_f32_32x32x16_bf16 v[192:207], a[16:19], a[48:51], v[192:207]
  ds_read_b128 a[8:11], v14 offset:8192
  v_exp_f32 v166, v166
  v_exp_f32 v167, v167
  v_mfma_f32_32x32x16_bf16 v[192:207], a[20:23], a[52:55], v[192:207]
  ds_read_b128 a[12:15], v15 offset:8192
  s_add_u32 m0, s28, 114688
  s_nop 0
  buffer_load_dwordx4 v6, s[20:23], s31 offen offset:2048 nt lds
  v_cvt_pk_bf16_f32 v160, v160, v161
  v_cvt_pk_bf16_f32 v161, v162, v163
  s_waitcnt lgkmcnt(4)
  v_mfma_f32_32x32x16_bf16 v[192:207], a[24:27], a[56:59], v[192:207]
  ds_read_b128 a[16:19], v16 offset:8192
  v_cvt_pk_bf16_f32 v162, v164, v165
  v_cvt_pk_bf16_f32 v163, v166, v167
  v_exp_f32 v168, v168
  v_mfma_f32_32x32x16_bf16 v[192:207], a[28:31], a[60:63], v[192:207]
  ds_read_b128 a[20:23], v17 offset:8192
  s_add_u32 m0, s28, 114688
  s_nop 0
  buffer_load_dwordx4 v6, s[20:23], s31 offen offset:3072 nt lds
  v_exp_f32 v169, v169
  s_waitcnt lgkmcnt(4)
  v_mfma_f32_32x32x16_bf16 v[208:223], a[0:3], a[32:35], v[32:47]
  ds_read_b128 a[24:27], v18 offset:8192
  v_exp_f32 v170, v170
  v_exp_f32 v171, v171
  v_mfma_f32_32x32x16_bf16 v[208:223], a[4:7], a[36:39], v[208:223]
  ds_read_b128 a[28:31], v19 offset:8192
  v_exp_f32 v172, v172
  v_exp_f32 v173, v173
  s_waitcnt lgkmcnt(4)
  v_mfma_f32_32x32x16_bf16 v[208:223], a[8:11], a[40:43], v[208:223]
  s_waitcnt vmcnt(8)
  s_barrier
  buffer_load_dword v28, v31, s[88:91], 0 offen offset:512 sc1
  v_xor_b32 v12, 196608, v12
  v_xor_b32 v13, 196608, v13
  v_xor_b32 v14, 196608, v14
  v_xor_b32 v15, 196608, v15
  v_xor_b32 v16, 196608, v16
  v_xor_b32 v17, 196608, v17
  v_xor_b32 v18, 196608, v18
  v_xor_b32 v19, 196608, v19
  ds_read_b128 a[0:3], v12 offset:0
  v_exp_f32 v174, v174
  v_exp_f32 v175, v175
  v_mfma_f32_32x32x16_bf16 v[208:223], a[12:15], a[44:47], v[208:223]
  ds_read_b128 a[4:7], v13 offset:0
  v_cvt_pk_bf16_f32 v168, v168, v169
  v_cvt_pk_bf16_f32 v169, v170, v171
  v_cvt_pk_bf16_f32 v170, v172, v173
  v_cvt_pk_bf16_f32 v171, v174, v175
  s_waitcnt lgkmcnt(4)
  v_mfma_f32_32x32x16_bf16 v[208:223], a[16:19], a[48:51], v[208:223]
  ds_read_b128 a[8:11], v14 offset:0
  v_max_f32 v20, v192, v193
  v_max3_f32 v20, v20, v194, v195
  v_exp_f32 v176, v176
  v_mfma_f32_32x32x16_bf16 v[208:223], a[20:23], a[52:55], v[208:223]
  ds_read_b128 a[12:15], v15 offset:0
  v_max3_f32 v20, v20, v196, v197
  v_max3_f32 v20, v20, v198, v199
  v_exp_f32 v177, v177
  s_waitcnt lgkmcnt(4)
  v_mfma_f32_32x32x16_bf16 v[208:223], a[24:27], a[56:59], v[208:223]
  ds_read_b128 a[16:19], v16 offset:0
  v_max3_f32 v20, v20, v200, v201
  v_max3_f32 v20, v20, v202, v203
  v_exp_f32 v178, v178
  v_mfma_f32_32x32x16_bf16 v[208:223], a[28:31], a[60:63], v[208:223]
  ds_read_b128 a[20:23], v17 offset:0
  v_max3_f32 v20, v20, v204, v205
  v_max3_f32 v20, v20, v206, v207
  v_exp_f32 v179, v179
  s_waitcnt lgkmcnt(4)
  v_mfma_f32_32x32x16_bf16 v[224:239], a[0:3], a[32:35], v[32:47]
  ds_read_b128 a[24:27], v18 offset:0
  v_exp_f32 v180, v180
  v_exp_f32 v181, v181
  v_mfma_f32_32x32x16_bf16 v[224:239], a[4:7], a[36:39], v[224:239]
  ds_read_b128 a[28:31], v19 offset:0
  s_add_u32 m0, s28, 131072
  s_mov_b32 s31, 98304
  buffer_load_dwordx4 v6, s[20:23], s31 offen offset:0 nt lds
  s_waitcnt lgkmcnt(4)
  v_mfma_f32_32x32x16_bf16 v[224:239], a[8:11], a[40:43], v[224:239]
  ds_read_b128 a[0:3], v12 offset:8192
  v_exp_f32 v182, v182
  v_exp_f32 v183, v183
  v_mfma_f32_32x32x16_bf16 v[224:239], a[12:15], a[44:47], v[224:239]
  ds_read_b128 a[4:7], v13 offset:8192
  s_add_u32 m0, s28, 131072
  s_nop 0
  buffer_load_dwordx4 v6, s[20:23], s31 offen offset:1024 nt lds
  v_cvt_pk_bf16_f32 v176, v176, v177
  v_cvt_pk_bf16_f32 v177, v178, v179
  s_waitcnt lgkmcnt(4)
  v_mfma_f32_32x32x16_bf16 v[224:239], a[16:19], a[48:51], v[224:239]
  ds_read_b128 a[8:11], v14 offset:8192
  v_max3_f32 v20, v20, v208, v209
  v_max3_f32 v20, v20, v210, v211
  v_cvt_pk_bf16_f32 v178, v180, v181
  v_cvt_pk_bf16_f32 v179, v182, v183
  v_mfma_f32_32x32x16_bf16 v[224:239], a[20:23], a[52:55], v[224:239]
  ds_read_b128 a[12:15], v15 offset:8192
  s_add_u32 m0, s28, 131072
  s_nop 0
  buffer_load_dwordx4 v6, s[20:23], s31 offen offset:2048 nt lds
  v_max3_f32 v20, v20, v212, v213
  v_max3_f32 v20, v20, v214, v215
  s_waitcnt lgkmcnt(4)
  v_mfma_f32_32x32x16_bf16 v[224:239], a[24:27], a[56:59], v[224:239]
  ds_read_b128 a[16:19], v16 offset:8192
  v_max3_f32 v20, v20, v216, v217
  v_max3_f32 v20, v20, v218, v219
  v_exp_f32 v184, v184
  v_mfma_f32_32x32x16_bf16 v[224:239], a[28:31], a[60:63], v[224:239]
  ds_read_b128 a[20:23], v17 offset:8192
  s_add_u32 m0, s28, 131072
  s_nop 0
  buffer_load_dwordx4 v6, s[20:23], s31 offen offset:3072 nt lds
  v_max3_f32 v20, v20, v220, v221
  v_max3_f32 v20, v20, v222, v223
  s_waitcnt lgkmcnt(4)
  v_mfma_f32_32x32x16_bf16 v[240:255], a[0:3], a[32:35], v[32:47]
  ds_read_b128 a[24:27], v18 offset:8192
  v_exp_f32 v185, v185
  v_exp_f32 v186, v186
  v_mfma_f32_32x32x16_bf16 v[240:255], a[4:7], a[36:39], v[240:255]
  ds_read_b128 a[28:31], v19 offset:8192
  v_exp_f32 v187, v187
  v_exp_f32 v188, v188
  s_waitcnt lgkmcnt(4)
  v_mfma_f32_32x32x16_bf16 v[240:255], a[8:11], a[40:43], v[240:255]
  s_waitcnt vmcnt(9)
  s_barrier
  v_exp_f32 v189, v189
  v_exp_f32 v190, v190
  v_mfma_f32_32x32x16_bf16 v[240:255], a[12:15], a[44:47], v[240:255]
  ds_read_b64_tr_b16 a[0:1], v52 offset:16384
  ds_read_b64_tr_b16 a[2:3], v52 offset:17408
  v_exp_f32 v191, v191
  v_cvt_pk_bf16_f32 v184, v184, v185
  s_waitcnt lgkmcnt(4)
  v_mfma_f32_32x32x16_bf16 v[240:255], a[16:19], a[48:51], v[240:255]
  ds_read_b64_tr_b16 a[4:5], v53 offset:16384
  ds_read_b64_tr_b16 a[6:7], v53 offset:17408
  v_max3_f32 v20, v20, v224, v225
  v_max3_f32 v20, v20, v226, v227
  v_cvt_pk_bf16_f32 v185, v186, v187
  v_mfma_f32_32x32x16_bf16 v[240:255], a[20:23], a[52:55], v[240:255]
  ds_read_b64_tr_b16 a[8:9], v54 offset:16384
  ds_read_b64_tr_b16 a[10:11], v54 offset:17408
  v_max3_f32 v20, v20, v228, v229
  v_max3_f32 v20, v20, v230, v231
  v_cvt_pk_bf16_f32 v186, v188, v189
  s_waitcnt lgkmcnt(6)
  v_mfma_f32_32x32x16_bf16 v[240:255], a[24:27], a[56:59], v[240:255]
  ds_read_b64_tr_b16 a[12:13], v55 offset:16384
  ds_read_b64_tr_b16 a[14:15], v55 offset:17408
  v_max3_f32 v20, v20, v232, v233
  v_max3_f32 v20, v20, v234, v235
  v_cvt_pk_bf16_f32 v187, v190, v191
  v_mfma_f32_32x32x16_bf16 v[240:255], a[28:31], a[60:63], v[240:255]
  v_max3_f32 v20, v20, v236, v237
  v_max3_f32 v20, v20, v238, v239
  v_mfma_f32_32x32x16_bf16 a[120:135], a[116:119], v[128:131], a[120:135]
  ds_read_b64_tr_b16 a[16:17], v52 offset:20480
  ds_read_b64_tr_b16 a[18:19], v52 offset:21504
  s_waitcnt lgkmcnt(6)
  v_mfma_f32_32x32x16_bf16 v[64:79], a[0:3], v[128:131], v[64:79]
  ds_read_b64_tr_b16 a[20:21], v53 offset:20480
  ds_read_b64_tr_b16 a[22:23], v53 offset:21504
  s_add_u32 m0, s28, 147456
  s_mov_b32 s31, 114688
  buffer_load_dwordx4 v6, s[20:23], s31 offen offset:0 nt lds
  v_mfma_f32_32x32x16_bf16 v[80:95], a[4:7], v[128:131], v[80:95]
  ds_read_b64_tr_b16 a[24:25], v54 offset:20480
  ds_read_b64_tr_b16 a[26:27], v54 offset:21504
  s_waitcnt lgkmcnt(6)
  v_mfma_f32_32x32x16_bf16 v[96:111], a[8:11], v[128:131], v[96:111]
  ds_read_b64_tr_b16 a[28:29], v55 offset:20480
  ds_read_b64_tr_b16 a[30:31], v55 offset:21504
  s_add_u32 m0, s28, 147456
  s_nop 0
  buffer_load_dwordx4 v6, s[20:23], s31 offen offset:1024 nt lds
  v_max3_f32 v20, v20, v240, v241
  v_max3_f32 v20, v20, v242, v243
  v_mfma_f32_32x32x16_bf16 v[112:127], a[12:15], v[128:131], v[112:127]
  v_max3_f32 v20, v20, v244, v245
  v_max3_f32 v20, v20, v246, v247
  v_mfma_f32_32x32x16_bf16 a[120:135], a[116:119], v[136:139], a[120:135]
  ds_read_b64_tr_b16 a[0:1], v52 offset:24576
  ds_read_b64_tr_b16 a[2:3], v52 offset:25600
  s_add_u32 m0, s28, 147456
  s_nop 0
  buffer_load_dwordx4 v6, s[20:23], s31 offen offset:2048 nt lds
  v_max3_f32 v20, v20, v248, v249
  v_max3_f32 v20, v20, v250, v251
  s_waitcnt lgkmcnt(6)
  v_mfma_f32_32x32x16_bf16 v[64:79], a[16:19], v[136:139], v[64:79]
  ds_read_b64_tr_b16 a[4:5], v53 offset:24576
  ds_read_b64_tr_b16 a[6:7], v53 offset:25600
  v_max3_f32 v20, v20, v252, v253
  v_max3_f32 v20, v20, v254, v255
  v_mfma_f32_32x32x16_bf16 v[80:95], a[20:23], v[136:139], v[80:95]
  ds_read_b64_tr_b16 a[8:9], v54 offset:24576
  ds_read_b64_tr_b16 a[10:11], v54 offset:25600
  s_add_u32 m0, s28, 147456
  s_nop 0
  buffer_load_dwordx4 v6, s[20:23], s31 offen offset:3072 nt lds
  v_cmp_lt_f32 vcc, 1090519040, v20
  s_nop 0
  s_cmp_lg_u64 vcc, 0
  s_cbranch_scc1 L_rr11
L_rb12:
  s_waitcnt lgkmcnt(6)
  v_mfma_f32_32x32x16_bf16 v[96:111], a[24:27], v[136:139], v[96:111]
  ds_read_b64_tr_b16 a[12:13], v55 offset:24576
  ds_read_b64_tr_b16 a[14:15], v55 offset:25600
  v_exp_f32 v192, v192
  v_exp_f32 v193, v193
  v_mfma_f32_32x32x16_bf16 v[112:127], a[28:31], v[136:139], v[112:127]
  v_exp_f32 v194, v194
  v_exp_f32 v195, v195
  v_exp_f32 v196, v196
  v_mfma_f32_32x32x16_bf16 a[120:135], a[116:119], v[144:147], a[120:135]
  ds_read_b64_tr_b16 a[16:17], v52 offset:28672
  ds_read_b64_tr_b16 a[18:19], v52 offset:29696
  v_exp_f32 v197, v197
  v_exp_f32 v198, v198
  s_waitcnt lgkmcnt(6)
  v_mfma_f32_32x32x16_bf16 v[64:79], a[0:3], v[144:147], v[64:79]
  ds_read_b64_tr_b16 a[20:21], v53 offset:28672
  ds_read_b64_tr_b16 a[22:23], v53 offset:29696
  s_bfe_u32 s100, s2, 0x20003
  s_add_u32 s100, s100, 0
  s_and_b32 s100, s100, 3
  s_lshl_b32 s100, s100, 2
  s_add_u32 s100, s100, s3
  s_mul_i32 s38, s100, 5120
  s_mov_b32 m0, s38
  s_and_b32 s101, s100, 28
  s_lshr_b32 s101, s60, s101
  s_and_b32 s101, s101, 7
  s_lshl2_add_u32 s100, s101, s3
  s_mul_i32 s39, s100, 40960
  buffer_load_dwordx4 v0, s[80:83], s39 offen offset:0 lds
  s_mov_b32 m0, s38
  s_nop 0
  buffer_load_dwordx4 v1, s[80:83], s39 offen offset:1024 lds
  v_mfma_f32_32x32x16_bf16 v[80:95], a[4:7], v[144:147], v[80:95]
  ds_read_b64_tr_b16 a[24:25], v54 offset:28672
  ds_read_b64_tr_b16 a[26:27], v54 offset:29696
  s_mov_b32 m0, s38
  s_nop 0
  buffer_load_dwordx4 v23, s[80:83], s39 offen offset:2048 lds
  v_exp_f32 v199, v199
  s_waitcnt lgkmcnt(6)
  v_mfma_f32_32x32x16_bf16 v[96:111], a[8:11], v[144:147], v[96:111]
  ds_read_b64_tr_b16 a[28:29], v55 offset:28672
  ds_read_b64_tr_b16 a[30:31], v55 offset:29696
  s_mov_b32 m0, s38
  s_nop 0
  buffer_load_dwordx4 v7, s[80:83], s39 offen offset:3072 lds
  v_cvt_pk_bf16_f32 v192, v192, v193
  v_cvt_pk_bf16_f32 v193, v194, v195
  v_mfma_f32_32x32x16_bf16 v[112:127], a[12:15], v[144:147], v[112:127]
  s_waitcnt vmcnt(13)
  s_barrier
  s_add_u32 m0, s38, 4096
  s_nop 0
  buffer_load_dwordx4 v29, s[80:83], s39 offen lds
  v_cvt_pk_bf16_f32 v194, v196, v197
  v_cvt_pk_bf16_f32 v195, v198, v199
  v_exp_f32 v200, v200
  v_mfma_f32_32x32x16_bf16 a[120:135], a[116:119], v[152:155], a[120:135]
  ds_read_b64_tr_b16 a[0:1], v52 offset:32768
  ds_read_b64_tr_b16 a[2:3], v52 offset:33792
  s_bfe_u32 s100, s2, 0x20003
  s_add_u32 s100, s100, 1
  s_and_b32 s100, s100, 3
  s_lshl_b32 s100, s100, 2
  s_add_u32 s100, s100, s3
  s_mul_i32 s38, s100, 5120
  s_mov_b32 m0, s38
  s_and_b32 s101, s100, 28
  s_lshr_b32 s101, s60, s101
  s_and_b32 s101, s101, 7
  s_lshl2_add_u32 s100, s101, s3
  s_mul_i32 s39, s100, 40960
  buffer_load_dwordx4 v0, s[80:83], s39 offen offset:0 lds
  s_waitcnt lgkmcnt(6)
  v_mfma_f32_32x32x16_bf16 v[64:79], a[16:19], v[152:155], v[64:79]
  ds_read_b64_tr_b16 a[4:5], v53 offset:32768
  ds_read_b64_tr_b16 a[6:7], v53 offset:33792
  s_mov_b32 m0, s38
  s_nop 0
  buffer_load_dwordx4 v1, s[80:83], s39 offen offset:1024 lds
  v_exp_f32 v201, v201
  v_mfma_f32_32x32x16_bf16 v[80:95], a[20:23], v[152:155], v[80:95]
  ds_read_b64_tr_b16 a[8:9], v54 offset:32768
  ds_read_b64_tr_b16 a[10:11], v54 offset:33792
  s_mov_b32 m0, s38
  s_nop 0
  buffer_load_dwordx4 v23, s[80:83], s39 offen offset:2048 lds
  v_exp_f32 v202, v202
  s_waitcnt lgkmcnt(6)
  v_mfma_f32_32x32x16_bf16 v[96:111], a[24:27], v[152:155], v[96:111]
  ds_read_b64_tr_b16 a[12:13], v55 offset:32768
  ds_read_b64_tr_b16 a[14:15], v55 offset:33792
  s_mov_b32 m0, s38
  s_nop 0
  buffer_load_dwordx4 v7, s[80:83], s39 offen offset:3072 lds
  s_waitcnt vmcnt(17)
  s_mov_b32 s101, 0
L_dc13:
  v_xor_b32 v25, v28, v11
  v_cmp_gt_u32 vcc, 16, v25
  s_nop 0
  s_cmp_eq_u64 vcc, -1
  s_cbranch_scc1 L_dc14
  s_add_u32 s101, s101, 1
  s_cmp_ge_u32 s101, 262144
  s_cbranch_scc1 L_dc14
  s_sleep 8
  buffer_load_dword v28, v31, s[88:91], 0 offen offset:512 sc1
  s_waitcnt vmcnt(0)
  s_branch L_dc13
L_dc14:
  v_cmp_eq_u32 vcc, 0, v25
  s_nop 0
  s_cmp_eq_u64 vcc, -1
  s_cselect_b32 s35, 1, 0
  v_mfma_f32_32x32x16_bf16 v[112:127], a[28:31], v[152:155], v[112:127]
  s_add_u32 m0, s38, 4096
  s_nop 0
  buffer_load_dwordx4 v29, s[80:83], s39 offen lds
  v_exp_f32 v203, v203
  v_exp_f32 v204, v204
  v_mfma_f32_32x32x16_bf16 a[120:135], a[116:119], v[160:163], a[120:135]
  ds_read_b64_tr_b16 a[16:17], v52 offset:36864
  ds_read_b64_tr_b16 a[18:19], v52 offset:37888
  v_exp_f32 v205, v205
  v_exp_f32 v206, v206
  s_waitcnt lgkmcnt(6)
  v_mfma_f32_32x32x16_bf16 v[64:79], a[0:3], v[160:163], v[64:79]
  ds_read_b64_tr_b16 a[20:21], v53 offset:36864
  ds_read_b64_tr_b16 a[22:23], v53 offset:37888
  s_bfe_u32 s100, s2, 0x20003
  s_add_u32 s100, s100, 2
  s_and_b32 s100, s100, 3
  s_lshl_b32 s100, s100, 2
  s_add_u32 s100, s100, s3
  s_mul_i32 s38, s100, 5120
  s_mov_b32 m0, s38
  s_and_b32 s101, s100, 28
  s_lshr_b32 s101, s60, s101
  s_and_b32 s101, s101, 7
  s_lshl2_add_u32 s100, s101, s3
  s_mul_i32 s39, s100, 40960
  buffer_load_dwordx4 v0, s[80:83], s39 offen offset:0 lds
  s_lshl_b32 s29, s4, 2
  s_add_u32 s29, s29, s5
  s_lshl_b32 s29, s29, 18
  s_lshl_b32 s100, s3, 13
  s_add_u32 s29, s29, s100
  s_add_u32 s84, s78, s29
  s_addc_u32 s85, s79, 0
  s_mov_b32 s86, 237568
  s_mov_b32 s87, 0x20000
  v_mfma_f32_32x32x16_bf16 v[80:95], a[4:7], v[160:163], v[80:95]
  ds_read_b64_tr_b16 a[24:25], v54 offset:36864
  ds_read_b64_tr_b16 a[26:27], v54 offset:37888
  s_mov_b32 m0, s38
  s_nop 0
  buffer_load_dwordx4 v1, s[80:83], s39 offen offset:1024 lds
  v_exp_f32 v207, v207
  s_waitcnt lgkmcnt(6)
  v_mfma_f32_32x32x16_bf16 v[96:111], a[8:11], v[160:163], v[96:111]
  ds_read_b64_tr_b16 a[28:29], v55 offset:36864
  ds_read_b64_tr_b16 a[30:31], v55 offset:37888
  v_cvt_pk_bf16_f32 v200, v200, v201
  v_cvt_pk_bf16_f32 v201, v202, v203
  v_cvt_pk_bf16_f32 v202, v204, v205
  v_cvt_pk_bf16_f32 v203, v206, v207
  v_mfma_f32_32x32x16_bf16 v[112:127], a[12:15], v[160:163], v[112:127]
  s_mov_b32 m0, s38
  s_nop 0
  buffer_load_dwordx4 v23, s[80:83], s39 offen offset:2048 lds
  s_lshl_b32 s100, s6, 15
  s_add_u32 s29, s29, s100
  s_add_u32 s24, s78, s29
  s_addc_u32 s25, s79, 0
  s_mov_b32 s26, 8192
  s_mov_b32 s27, 0x20000
  s_lshl_b32 s29, s2, 3
  s_add_u32 s29, s29, s3
  s_lshl_b32 s29, s29, 7
  v_mfma_f32_32x32x16_bf16 a[120:135], a[116:119], v[168:171], a[120:135]
  ds_read_b64_tr_b16 a[0:1], v52 offset:40960
  ds_read_b64_tr_b16 a[2:3], v52 offset:41984
  v_exp_f32 v208, v208
  v_exp_f32 v209, v209
  s_waitcnt lgkmcnt(6)
  v_mfma_f32_32x32x16_bf16 v[64:79], a[16:19], v[168:171], v[64:79]
  ds_read_b64_tr_b16 a[4:5], v53 offset:40960
  ds_read_b64_tr_b16 a[6:7], v53 offset:41984
  s_mov_b32 m0, s38
  s_nop 0
  buffer_load_dwordx4 v7, s[80:83], s39 offen offset:3072 lds
  v_exp_f32 v210, v210
  v_mfma_f32_32x32x16_bf16 v[80:95], a[20:23], v[168:171], v[80:95]
  ds_read_b64_tr_b16 a[8:9], v54 offset:40960
  ds_read_b64_tr_b16 a[10:11], v54 offset:41984
  v_mov_b32 v30, s29
  v_mov_b32 v25, 0x7fffffff
  v_cmp_eq_u32 vcc, 0, v24
  v_mov_b32 v27, s63
  v_lshlrev_b32 v28, 2, v24
  v_lshrrev_b32_e64 v28, v28, s60
  v_cndmask_b32 v30, v25, v30, vcc
  v_and_b32 v28, 7, v28
  s_waitcnt lgkmcnt(6)
  v_mfma_f32_32x32x16_bf16 v[96:111], a[24:27], v[168:171], v[96:111]
  ds_read_b64_tr_b16 a[12:13], v55 offset:40960
  ds_read_b64_tr_b16 a[14:15], v55 offset:41984
  s_add_u32 m0, s38, 4096
  s_nop 0
  buffer_load_dwordx4 v29, s[80:83], s39 offen lds
  v_exp_f32 v211, v211
  v_mfma_f32_32x32x16_bf16 v[112:127], a[28:31], v[168:171], v[112:127]
  v_exp_f32 v212, v212
  v_exp_f32 v213, v213
  v_exp_f32 v214, v214
  v_mfma_f32_32x32x16_bf16 a[120:135], a[116:119], v[176:179], a[120:135]
  ds_read_b64_tr_b16 a[16:17], v52 offset:45056
  ds_read_b64_tr_b16 a[18:19], v52 offset:46080
  s_bfe_u32 s100, s2, 0x20003
  s_add_u32 s100, s100, 3
  s_and_b32 s100, s100, 3
  s_lshl_b32 s100, s100, 2
  s_add_u32 s100, s100, s3
  s_mul_i32 s38, s100, 5120
  s_mov_b32 m0, s38
  s_and_b32 s101, s100, 28
  s_lshr_b32 s101, s60, s101
  s_and_b32 s101, s101, 7
  s_lshl2_add_u32 s100, s101, s3
  s_mul_i32 s39, s100, 40960
  buffer_load_dwordx4 v0, s[80:83], s39 offen offset:0 lds
  s_and_b32 s29, s2, 31
  s_lshl_b32 s29, s29, 3
  s_add_u32 s29, s29, s3
  s_lshl_b32 s29, s29, 7
  v_lshl_add_u32 v31, v28, 15, s29
  s_waitcnt lgkmcnt(6)
  v_mfma_f32_32x32x16_bf16 v[64:79], a[0:3], v[176:179], v[64:79]
  ds_read_b64_tr_b16 a[20:21], v53 offset:45056
  ds_read_b64_tr_b16 a[22:23], v53 offset:46080
  v_exp_f32 v215, v215
  v_cvt_pk_bf16_f32 v208, v208, v209
  v_cvt_pk_bf16_f32 v209, v210, v211
  v_cvt_pk_bf16_f32 v210, v212, v213
  v_mfma_f32_32x32x16_bf16 v[80:95], a[4:7], v[176:179], v[80:95]
  ds_read_b64_tr_b16 a[24:25], v54 offset:45056
  ds_read_b64_tr_b16 a[26:27], v54 offset:46080
  s_mov_b32 m0, s38
  s_nop 0
  buffer_load_dwordx4 v1, s[80:83], s39 offen offset:1024 lds
  v_cvt_pk_bf16_f32 v211, v214, v215
  s_waitcnt lgkmcnt(6)
  v_mfma_f32_32x32x16_bf16 v[96:111], a[8:11], v[176:179], v[96:111]
  ds_read_b64_tr_b16 a[28:29], v55 offset:45056
  ds_read_b64_tr_b16 a[30:31], v55 offset:46080
  v_exp_f32 v216, v216
  v_exp_f32 v217, v217
  v_mfma_f32_32x32x16_bf16 v[112:127], a[12:15], v[176:179], v[112:127]
  s_waitcnt vmcnt(21)
  s_barrier
  s_mov_b32 m0, s38
  s_nop 0
  buffer_load_dwordx4 v23, s[80:83], s39 offen offset:2048 lds
  v_exp_f32 v218, v218
  v_exp_f32 v219, v219
  v_mfma_f32_32x32x16_bf16 a[120:135], a[116:119], v[184:187], a[120:135]
  ds_read_b64_tr_b16 a[0:1], v52 offset:49152
  ds_read_b64_tr_b16 a[2:3], v52 offset:50176
  v_exp_f32 v220, v220
  v_exp_f32 v221, v221
  s_waitcnt lgkmcnt(6)
  v_mfma_f32_32x32x16_bf16 v[64:79], a[16:19], v[184:187], v[64:79]
  ds_read_b64_tr_b16 a[4:5], v53 offset:49152
  ds_read_b64_tr_b16 a[6:7], v53 offset:50176
  s_mov_b32 m0, s38
  s_nop 0
  buffer_load_dwordx4 v7, s[80:83], s39 offen offset:3072 lds
  v_exp_f32 v222, v222
  v_mfma_f32_32x32x16_bf16 v[80:95], a[20:23], v[184:187], v[80:95]
  ds_read_b64_tr_b16 a[8:9], v54 offset:49152
  ds_read_b64_tr_b16 a[10:11], v54 offset:50176
  v_exp_f32 v223, v223
  v_cvt_pk_bf16_f32 v216, v216, v217
  v_cvt_pk_bf16_f32 v217, v218, v219
  v_cvt_pk_bf16_f32 v218, v220, v221
  s_waitcnt lgkmcnt(6)
  v_mfma_f32_32x32x16_bf16 v[96:111], a[24:27], v[184:187], v[96:111]
  ds_read_b64_tr_b16 a[12:13], v55 offset:49152
  ds_read_b64_tr_b16 a[14:15], v55 offset:50176
  s_add_u32 m0, s38, 4096
  s_nop 0
  buffer_load_dwordx4 v29, s[80:83], s39 offen lds
  v_cvt_pk_bf16_f32 v219, v222, v223
  v_mfma_f32_32x32x16_bf16 v[112:127], a[28:31], v[184:187], v[112:127]
  v_exp_f32 v224, v224
  v_exp_f32 v225, v225
  v_exp_f32 v226, v226
  s_cmp_lg_u32 s61, 0
  s_cbranch_scc1 L_rr15
L_rb16:
  v_mfma_f32_32x32x16_bf16 a[120:135], a[116:119], v[192:195], a[120:135]
  ds_read_b64_tr_b16 a[16:17], v52 offset:53248
  ds_read_b64_tr_b16 a[18:19], v52 offset:54272
  v_exp_f32 v227, v227
  v_exp_f32 v228, v228
  s_waitcnt lgkmcnt(6)
  v_mfma_f32_32x32x16_bf16 v[64:79], a[0:3], v[192:195], v[64:79]
  ds_read_b64_tr_b16 a[20:21], v53 offset:53248
  ds_read_b64_tr_b16 a[22:23], v53 offset:54272
  v_exp_f32 v229, v229
  v_exp_f32 v230, v230
  v_mfma_f32_32x32x16_bf16 v[80:95], a[4:7], v[192:195], v[80:95]
  ds_read_b64_tr_b16 a[24:25], v54 offset:53248
  ds_read_b64_tr_b16 a[26:27], v54 offset:54272
  v_exp_f32 v231, v231
  v_cvt_pk_bf16_f32 v224, v224, v225
  v_cvt_pk_bf16_f32 v225, v226, v227
  v_cvt_pk_bf16_f32 v226, v228, v229
  s_waitcnt lgkmcnt(6)
  v_mfma_f32_32x32x16_bf16 v[96:111], a[8:11], v[192:195], v[96:111]
  ds_read_b64_tr_b16 a[28:29], v55 offset:53248
  ds_read_b64_tr_b16 a[30:31], v55 offset:54272
  v_cvt_pk_bf16_f32 v227, v230, v231
  v_exp_f32 v232, v232
  v_exp_f32 v233, v233
  v_mfma_f32_32x32x16_bf16 v[112:127], a[12:15], v[192:195], v[112:127]
  v_exp_f32 v234, v234
  v_exp_f32 v235, v235
  v_exp_f32 v236, v236
  v_mfma_f32_32x32x16_bf16 a[120:135], a[116:119], v[200:203], a[120:135]
  ds_read_b64_tr_b16 a[0:1], v52 offset:57344
  ds_read_b64_tr_b16 a[2:3], v52 offset:58368
  v_exp_f32 v237, v237
  v_exp_f32 v238, v238
  s_waitcnt lgkmcnt(6)
  v_mfma_f32_32x32x16_bf16 v[64:79], a[16:19], v[200:203], v[64:79]
  ds_read_b64_tr_b16 a[4:5], v53 offset:57344
  ds_read_b64_tr_b16 a[6:7], v53 offset:58368
  v_exp_f32 v239, v239
  v_cvt_pk_bf16_f32 v232, v232, v233
  v_cvt_pk_bf16_f32 v233, v234, v235
  v_cvt_pk_bf16_f32 v234, v236, v237
  v_mfma_f32_32x32x16_bf16 v[80:95], a[20:23], v[200:203], v[80:95]
  ds_read_b64_tr_b16 a[8:9], v54 offset:57344
  ds_read_b64_tr_b16 a[10:11], v54 offset:58368
  v_cvt_pk_bf16_f32 v235, v238, v239
  v_exp_f32 v240, v240
  v_exp_f32 v241, v241
  s_waitcnt lgkmcnt(6)
  v_mfma_f32_32x32x16_bf16 v[96:111], a[24:27], v[200:203], v[96:111]
  ds_read_b64_tr_b16 a[12:13], v55 offset:57344
  ds_read_b64_tr_b16 a[14:15], v55 offset:58368
  s_add_u32 s100, s3, 16
  s_mul_i32 s38, s100, 5120
  s_mov_b32 m0, s38
  s_and_b32 s101, s100, 28
  s_lshr_b32 s101, s60, s101
  s_and_b32 s101, s101, 7
  s_lshl2_add_u32 s100, s101, s3
  s_mul_i32 s39, s100, 40960
  buffer_load_dwordx4 v0, s[80:83], s39 offen offset:0 lds
  v_mfma_f32_32x32x16_bf16 v[112:127], a[28:31], v[200:203], v[112:127]
  s_mov_b32 m0, s38
  s_nop 0
  buffer_load_dwordx4 v1, s[80:83], s39 offen offset:1024 lds
  v_exp_f32 v242, v242
  v_exp_f32 v243, v243
  v_mfma_f32_32x32x16_bf16 a[120:135], a[116:119], v[208:211], a[120:135]
  ds_read_b64_tr_b16 a[16:17], v52 offset:61440
  ds_read_b64_tr_b16 a[18:19], v52 offset:62464
  s_mov_b32 m0, s38
  s_nop 0
  buffer_load_dwordx4 v23, s[80:83], s39 offen offset:2048 lds
  v_exp_f32 v244, v244
  s_waitcnt lgkmcnt(6)
  v_mfma_f32_32x32x16_bf16 v[64:79], a[0:3], v[208:211], v[64:79]
  ds_read_b64_tr_b16 a[20:21], v53 offset:61440
  ds_read_b64_tr_b16 a[22:23], v53 offset:62464
  s_mov_b32 m0, s38
  s_nop 0
  buffer_load_dwordx4 v7, s[80:83], s39 offen offset:3072 lds
  v_exp_f32 v245, v245
  v_mfma_f32_32x32x16_bf16 v[80:95], a[4:7], v[208:211], v[80:95]
  ds_read_b64_tr_b16 a[24:25], v54 offset:61440
  ds_read_b64_tr_b16 a[26:27], v54 offset:62464
  s_add_u32 m0, s38, 4096
  s_nop 0
  buffer_load_dwordx4 v29, s[80:83], s39 offen lds
  v_exp_f32 v246, v246
  s_waitcnt lgkmcnt(6)
  v_mfma_f32_32x32x16_bf16 v[96:111], a[8:11], v[208:211], v[96:111]
  ds_read_b64_tr_b16 a[28:29], v55 offset:61440
  ds_read_b64_tr_b16 a[30:31], v55 offset:62464
  v_exp_f32 v247, v247
  v_cvt_pk_bf16_f32 v240, v240, v241
  v_cvt_pk_bf16_f32 v241, v242, v243
  v_cvt_pk_bf16_f32 v242, v244, v245
  v_mfma_f32_32x32x16_bf16 v[112:127], a[12:15], v[208:211], v[112:127]
  v_cvt_pk_bf16_f32 v243, v246, v247
  v_exp_f32 v248, v248
  v_exp_f32 v249, v249
  v_exp_f32 v250, v250
  v_mfma_f32_32x32x16_bf16 a[120:135], a[116:119], v[216:219], a[120:135]
  v_exp_f32 v251, v251
  v_exp_f32 v252, v252
  v_exp_f32 v253, v253
  s_waitcnt lgkmcnt(4)
  v_mfma_f32_32x32x16_bf16 v[64:79], a[16:19], v[216:219], v[64:79]
  v_exp_f32 v254, v254
  v_exp_f32 v255, v255
  v_cvt_pk_bf16_f32 v248, v248, v249
  v_cvt_pk_bf16_f32 v249, v250, v251
  v_cvt_pk_bf16_f32 v250, v252, v253
  v_mfma_f32_32x32x16_bf16 v[80:95], a[20:23], v[216:219], v[80:95]
  v_cvt_pk_bf16_f32 v251, v254, v255
  s_waitcnt lgkmcnt(0)
  v_mfma_f32_32x32x16_bf16 v[96:111], a[24:27], v[216:219], v[96:111]
  s_waitcnt vmcnt(25)
  s_barrier
  ds_read_b64_tr_b16 a[0:1], v56 offset:0
  ds_read_b64_tr_b16 a[2:3], v56 offset:1024
  v_mfma_f32_32x32x16_bf16 v[112:127], a[28:31], v[216:219], v[112:127]
  ds_read_b64_tr_b16 a[4:5], v56 offset:4096
  ds_read_b64_tr_b16 a[6:7], v56 offset:5120
  v_mfma_f32_32x32x16_bf16 a[120:135], a[116:119], v[224:227], a[120:135]
  ds_read_b64_tr_b16 a[8:9], v56 offset:8192
  ds_read_b64_tr_b16 a[10:11], v56 offset:9216
  v_mfma_f32_32x32x16_bf16 a[120:135], a[116:119], v[232:235], a[120:135]
  ds_read_b64_tr_b16 a[12:13], v56 offset:12288
  ds_read_b64_tr_b16 a[14:15], v56 offset:13312
  v_mfma_f32_32x32x16_bf16 a[120:135], a[116:119], v[240:243], a[120:135]
  ds_read_b64_tr_b16 a[16:17], v57 offset:0
  ds_read_b64_tr_b16 a[18:19], v57 offset:1024
  v_mfma_f32_32x32x16_bf16 a[120:135], a[116:119], v[248:251], a[120:135]
  ds_read_b64_tr_b16 a[20:21], v57 offset:4096
  ds_read_b64_tr_b16 a[22:23], v57 offset:5120
  s_waitcnt lgkmcnt(8)
  v_mfma_f32_32x32x16_bf16 v[64:79], a[0:3], v[224:227], v[64:79]
  ds_read_b64_tr_b16 a[24:25], v57 offset:8192
  ds_read_b64_tr_b16 a[26:27], v57 offset:9216
  s_add_u32 s100, s3, 20
  s_mul_i32 s38, s100, 5120
  s_mov_b32 m0, s38
  s_and_b32 s101, s100, 28
  s_lshr_b32 s101, s60, s101
  s_and_b32 s101, s101, 7
  s_lshl2_add_u32 s100, s101, s3
  s_mul_i32 s39, s100, 40960
  buffer_load_dwordx4 v0, s[80:83], s39 offen offset:0 lds
  v_mfma_f32_32x32x16_bf16 v[64:79], a[4:7], v[232:235], v[64:79]
  ds_read_b64_tr_b16 a[28:29], v57 offset:12288
  ds_read_b64_tr_b16 a[30:31], v57 offset:13312
  s_mov_b32 m0, s38
  s_nop 0
  buffer_load_dwordx4 v1, s[80:83], s39 offen offset:1024 lds
  s_waitcnt lgkmcnt(8)
  v_mfma_f32_32x32x16_bf16 v[64:79], a[8:11], v[240:243], v[64:79]
  ds_read_b64_tr_b16 a[0:1], v58 offset:0
  ds_read_b64_tr_b16 a[2:3], v58 offset:1024
  s_mov_b32 m0, s38
  s_nop 0
  buffer_load_dwordx4 v23, s[80:83], s39 offen offset:2048 lds
  v_accvgpr_read_b32 v26, a120
  s_movk_i32 s31, 4096
  v_mfma_f32_32x32x16_bf16 v[64:79], a[12:15], v[248:251], v[64:79]
  ds_read_b64_tr_b16 a[4:5], v58 offset:4096
  ds_read_b64_tr_b16 a[6:7], v58 offset:5120
  s_mov_b32 m0, s38
  s_nop 0
  buffer_load_dwordx4 v7, s[80:83], s39 offen offset:3072 lds
  v_rcp_f32 v26, v26
  s_waitcnt lgkmcnt(8)
  v_mfma_f32_32x32x16_bf16 v[80:95], a[16:19], v[224:227], v[80:95]
  ds_read_b64_tr_b16 a[8:9], v58 offset:8192
  ds_read_b64_tr_b16 a[10:11], v58 offset:9216
  s_add_u32 m0, s38, 4096
  s_nop 0
  buffer_load_dwordx4 v29, s[80:83], s39 offen lds
  v_mfma_f32_32x32x16_bf16 v[80:95], a[20:23], v[232:235], v[80:95]
  ds_read_b64_tr_b16 a[12:13], v58 offset:12288
  ds_read_b64_tr_b16 a[14:15], v58 offset:13312
  s_waitcnt lgkmcnt(8)
  v_mfma_f32_32x32x16_bf16 v[80:95], a[24:27], v[240:243], v[80:95]
  ds_read_b64_tr_b16 a[16:17], v59 offset:0
  ds_read_b64_tr_b16 a[18:19], v59 offset:1024
  v_mul_f32 v64, v64, v26
  v_mul_f32 v65, v65, v26
  v_mul_f32 v66, v66, v26
  v_mul_f32 v67, v67, v26
  v_mul_f32 v68, v68, v26
  v_mul_f32 v69, v69, v26
  v_mul_f32 v70, v70, v26
  v_mfma_f32_32x32x16_bf16 v[80:95], a[28:31], v[248:251], v[80:95]
  ds_read_b64_tr_b16 a[20:21], v59 offset:4096
  ds_read_b64_tr_b16 a[22:23], v59 offset:5120
  v_mul_f32 v71, v71, v26
  v_mul_f32 v72, v72, v26
  v_mul_f32 v73, v73, v26
  v_mul_f32 v74, v74, v26
  v_mul_f32 v75, v75, v26
  v_mul_f32 v76, v76, v26
  v_mul_f32 v77, v77, v26
  s_waitcnt lgkmcnt(8)
  v_mfma_f32_32x32x16_bf16 v[96:111], a[0:3], v[224:227], v[96:111]
  ds_read_b64_tr_b16 a[24:25], v59 offset:8192
  ds_read_b64_tr_b16 a[26:27], v59 offset:9216
  v_mul_f32 v78, v78, v26
  v_mul_f32 v79, v79, v26
  v_cvt_pk_bf16_f32 v32, v64, v65
  v_cvt_pk_bf16_f32 v33, v66, v67
  v_cvt_pk_bf16_f32 v34, v72, v73
  v_cvt_pk_bf16_f32 v35, v74, v75
  v_cvt_pk_bf16_f32 v36, v68, v69
  v_mfma_f32_32x32x16_bf16 v[96:111], a[4:7], v[232:235], v[96:111]
  ds_read_b64_tr_b16 a[28:29], v59 offset:12288
  ds_read_b64_tr_b16 a[30:31], v59 offset:13312
  v_cvt_pk_bf16_f32 v37, v70, v71
  v_cvt_pk_bf16_f32 v38, v76, v77
  v_cvt_pk_bf16_f32 v39, v78, v79
  v_permlane16_swap_b32 v32, v36
  v_permlane16_swap_b32 v33, v37
  v_permlane16_swap_b32 v34, v38
  v_permlane16_swap_b32 v35, v39
  s_cmp_eq_u32 s35, 0
  s_cbranch_scc1 L_o17
  buffer_store_dwordx4 v[32:35], v10, s[24:27], 0 offen offset:0 nt
  buffer_store_dwordx4 v[36:39], v10, s[24:27], 0 offen offset:1024 nt
  s_branch L_o18
L_o17:
  buffer_store_dwordx4 v[32:35], v10, s[24:27], 0 offen offset:0 sc1
  buffer_store_dwordx4 v[36:39], v10, s[24:27], 0 offen offset:1024 sc1
L_o18:
  s_waitcnt lgkmcnt(8)
  v_mfma_f32_32x32x16_bf16 v[96:111], a[8:11], v[240:243], v[96:111]
  v_mul_f32 v80, v80, v26
  v_mul_f32 v81, v81, v26
  v_mul_f32 v82, v82, v26
  v_mul_f32 v83, v83, v26
  v_mul_f32 v84, v84, v26
  v_mul_f32 v85, v85, v26
  v_mul_f32 v86, v86, v26
  v_mfma_f32_32x32x16_bf16 v[96:111], a[12:15], v[248:251], v[96:111]
  v_mul_f32 v87, v87, v26
  v_mul_f32 v88, v88, v26
  v_mul_f32 v89, v89, v26
  v_mul_f32 v90, v90, v26
  v_mul_f32 v91, v91, v26
  v_mul_f32 v92, v92, v26
  v_mul_f32 v93, v93, v26
  s_waitcnt lgkmcnt(4)
  v_mfma_f32_32x32x16_bf16 v[112:127], a[16:19], v[224:227], v[112:127]
  v_mul_f32 v94, v94, v26
  v_mul_f32 v95, v95, v26
  v_cvt_pk_bf16_f32 v40, v80, v81
  v_cvt_pk_bf16_f32 v41, v82, v83
  v_cvt_pk_bf16_f32 v42, v88, v89
  v_cvt_pk_bf16_f32 v43, v90, v91
  v_cvt_pk_bf16_f32 v44, v84, v85
  v_mfma_f32_32x32x16_bf16 v[112:127], a[20:23], v[232:235], v[112:127]
  v_cvt_pk_bf16_f32 v45, v86, v87
  v_cvt_pk_bf16_f32 v46, v92, v93
  v_cvt_pk_bf16_f32 v47, v94, v95
  v_permlane16_swap_b32 v40, v44
  v_permlane16_swap_b32 v41, v45
  v_permlane16_swap_b32 v42, v46
  v_permlane16_swap_b32 v43, v47
  s_cmp_eq_u32 s35, 0
  s_cbranch_scc1 L_o19
  buffer_store_dwordx4 v[40:43], v10, s[24:27], 0 offen offset:2048 nt
  buffer_store_dwordx4 v[44:47], v10, s[24:27], 0 offen offset:3072 nt
  s_branch L_o20
L_o19:
  buffer_store_dwordx4 v[40:43], v10, s[24:27], 0 offen offset:2048 sc1
  buffer_store_dwordx4 v[44:47], v10, s[24:27], 0 offen offset:3072 sc1
L_o20:
  s_waitcnt lgkmcnt(0)
  v_mfma_f32_32x32x16_bf16 v[112:127], a[24:27], v[240:243], v[112:127]
  v_mul_f32 v96, v96, v26
  v_mul_f32 v97, v97, v26
  v_mul_f32 v98, v98, v26
  v_mul_f32 v99, v99, v26
  v_mul_f32 v100, v100, v26
  v_mul_f32 v101, v101, v26
  v_mul_f32 v102, v102, v26
  v_mul_f32 v103, v103, v26
  v_mfma_f32_32x32x16_bf16 v[112:127], a[28:31], v[248:251], v[112:127]
  v_mul_f32 v104, v104, v26
  v_mul_f32 v105, v105, v26
  v_mul_f32 v106, v106, v26
  v_mul_f32 v107, v107, v26
  v_mul_f32 v108, v108, v26
  v_mul_f32 v109, v109, v26
  v_mul_f32 v110, v110, v26
  v_mul_f32 v111, v111, v26
  v_cvt_pk_bf16_f32 v48, v96, v97
  v_cvt_pk_bf16_f32 v49, v98, v99
  v_cvt_pk_bf16_f32 v50, v104, v105
  v_cvt_pk_bf16_f32 v51, v106, v107
  v_cvt_pk_bf16_f32 v52, v100, v101
  v_cvt_pk_bf16_f32 v53, v102, v103
  v_cvt_pk_bf16_f32 v54, v108, v109
  v_cvt_pk_bf16_f32 v55, v110, v111
  v_permlane16_swap_b32 v48, v52
  v_permlane16_swap_b32 v49, v53
  v_permlane16_swap_b32 v50, v54
  v_permlane16_swap_b32 v51, v55
  s_cmp_eq_u32 s35, 0
  s_cbranch_scc1 L_o21
  buffer_store_dwordx4 v[48:51], v10, s[24:27], s31 offen offset:0 nt
  buffer_store_dwordx4 v[52:55], v10, s[24:27], s31 offen offset:1024 nt
  s_branch L_o22
L_o21:
  buffer_store_dwordx4 v[48:51], v10, s[24:27], s31 offen offset:0 sc1
  buffer_store_dwordx4 v[52:55], v10, s[24:27], s31 offen offset:1024 sc1
L_o22:
  v_pk_mul_f32 v[112:113], v[112:113], v[26:27] op_sel_hi:[1,0]
  v_pk_mul_f32 v[114:115], v[114:115], v[26:27] op_sel_hi:[1,0]
  v_pk_mul_f32 v[116:117], v[116:117], v[26:27] op_sel_hi:[1,0]
  v_pk_mul_f32 v[118:119], v[118:119], v[26:27] op_sel_hi:[1,0]
  v_pk_mul_f32 v[120:121], v[120:121], v[26:27] op_sel_hi:[1,0]
  v_pk_mul_f32 v[122:123], v[122:123], v[26:27] op_sel_hi:[1,0]
  v_pk_mul_f32 v[124:125], v[124:125], v[26:27] op_sel_hi:[1,0]
  v_pk_mul_f32 v[126:127], v[126:127], v[26:27] op_sel_hi:[1,0]
  v_cvt_pk_bf16_f32 v56, v112, v113
  v_cvt_pk_bf16_f32 v57, v114, v115
  v_cvt_pk_bf16_f32 v58, v120, v121
  v_cvt_pk_bf16_f32 v59, v122, v123
  v_cvt_pk_bf16_f32 v60, v116, v117
  v_cvt_pk_bf16_f32 v61, v118, v119
  v_cvt_pk_bf16_f32 v62, v124, v125
  v_cvt_pk_bf16_f32 v63, v126, v127
  v_permlane16_swap_b32 v56, v60
  v_permlane16_swap_b32 v57, v61
  v_permlane16_swap_b32 v58, v62
  v_permlane16_swap_b32 v59, v63
  s_cmp_eq_u32 s35, 0
  s_cbranch_scc1 L_o23
  buffer_store_dwordx4 v[56:59], v10, s[24:27], s31 offen offset:2048 nt
  buffer_store_dwordx4 v[60:63], v10, s[24:27], s31 offen offset:3072 nt
  s_branch L_o24
L_o23:
  buffer_store_dwordx4 v[56:59], v10, s[24:27], s31 offen offset:2048 sc1
  buffer_store_dwordx4 v[60:63], v10, s[24:27], s31 offen offset:3072 sc1
L_o24:
  s_waitcnt vmcnt(18)
  s_branch L_tail
L_roleA:
  s_waitcnt vmcnt(9)
  s_barrier
  v_add_u32 v12, 49152, v8
  v_add_u32 v16, 0, v7
  v_xor_b32 v13, 64, v12
  v_xor_b32 v17, 32, v16
  v_xor_b32 v14, 128, v12
  v_xor_b32 v18, 64, v16
  v_xor_b32 v15, 192, v12
  v_xor_b32 v19, 96, v16
  ds_read_b128 a[32:35], v16
  ds_read_b64_tr_b16 a[0:1], v12 offset:0
  ds_read_b64_tr_b16 a[2:3], v12 offset:1024
  ds_read_b64_tr_b16 a[4:5], v13 offset:0
  ds_read_b64_tr_b16 a[6:7], v13 offset:1024
  ds_read_b64_tr_b16 a[8:9], v14 offset:0
  ds_read_b64_tr_b16 a[10:11], v14 offset:1024
  ds_read_b64_tr_b16 a[12:13], v15 offset:0
  ds_read_b64_tr_b16 a[14:15], v15 offset:1024
  ds_read_b128 a[36:39], v17
  ds_read_b64_tr_b16 a[16:17], v12 offset:4096
  ds_read_b64_tr_b16 a[18:19], v12 offset:5120
  ds_read_b64_tr_b16 a[20:21], v13 offset:4096
  ds_read_b64_tr_b16 a[22:23], v13 offset:5120
  s_waitcnt lgkmcnt(9)
  v_mfma_f32_32x32x16_bf16 v[64:79], a[0:3], a[32:35], 0
  ds_read_b64_tr_b16 a[24:25], v14 offset:4096
  ds_read_b64_tr_b16 a[26:27], v14 offset:5120
  s_add_u32 m0, s28, 32768
  s_lshl_b32 s36, s34, 7
  s_lshl_b32 s37, s34, 19
  s_add_u32 s34, s34, 1
  s_cmp_ge_u32 s34, 10
  s_cselect_b32 s34, 0, s34
  buffer_load_dwordx4 v128, s[8:11], s36 offen offset:0 lds
  v_mfma_f32_32x32x16_bf16 v[80:95], a[4:7], a[32:35], 0
  ds_read_b64_tr_b16 a[28:29], v15 offset:4096
  ds_read_b64_tr_b16 a[30:31], v15 offset:5120
  s_waitcnt lgkmcnt(9)
  v_mfma_f32_32x32x16_bf16 v[96:111], a[8:11], a[32:35], 0
  ds_read_b128 a[40:43], v18
  ds_read_b64_tr_b16 a[0:1], v12 offset:8192
  ds_read_b64_tr_b16 a[2:3], v12 offset:9216
  buffer_load_dwordx4 v129, s[8:11], s36 offen offset:1024 lds
  v_mfma_f32_32x32x16_bf16 v[112:127], a[12:15], a[32:35], 0
  ds_read_b64_tr_b16 a[4:5], v13 offset:8192
  ds_read_b64_tr_b16 a[6:7], v13 offset:9216
  s_waitcnt lgkmcnt(9)
  v_mfma_f32_32x32x16_bf16 v[64:79], a[16:19], a[36:39], v[64:79]
  ds_read_b64_tr_b16 a[8:9], v14 offset:8192
  ds_read_b64_tr_b16 a[10:11], v14 offset:9216
  buffer_load_dwordx4 v130, s[8:11], s36 offen offset:2048 lds
  v_mfma_f32_32x32x16_bf16 v[80:95], a[20:23], a[36:39], v[80:95]
  ds_read_b64_tr_b16 a[12:13], v15 offset:8192
  ds_read_b64_tr_b16 a[14:15], v15 offset:9216
  s_waitcnt lgkmcnt(9)
  v_mfma_f32_32x32x16_bf16 v[96:111], a[24:27], a[36:39], v[96:111]
  ds_read_b128 a[32:35], v19
  ds_read_b64_tr_b16 a[16:17], v12 offset:12288
  ds_read_b64_tr_b16 a[18:19], v12 offset:13312
  buffer_load_dwordx4 v131, s[8:11], s36 offen offset:3072 lds
  v_mfma_f32_32x32x16_bf16 v[112:127], a[28:31], a[36:39], v[112:127]
  ds_read_b64_tr_b16 a[20:21], v13 offset:12288
  ds_read_b64_tr_b16 a[22:23], v13 offset:13312
  s_waitcnt lgkmcnt(9)
  v_mfma_f32_32x32x16_bf16 v[64:79], a[0:3], a[40:43], v[64:79]
  ds_read_b64_tr_b16 a[24:25], v14 offset:12288
  ds_read_b64_tr_b16 a[26:27], v14 offset:13312
  s_add_u32 m0, s28, 131072
  s_nop 0
  buffer_load_dwordx4 v132, s[12:15], s37 offen offset:0 lds
  v_mfma_f32_32x32x16_bf16 v[80:95], a[4:7], a[40:43], v[80:95]
  ds_read_b64_tr_b16 a[28:29], v15 offset:12288
  ds_read_b64_tr_b16 a[30:31], v15 offset:13312
  s_waitcnt lgkmcnt(9)
  v_mfma_f32_32x32x16_bf16 v[96:111], a[8:11], a[40:43], v[96:111]
  s_waitcnt vmcnt(6)
  s_barrier
  v_add_u32 v12, 65536, v8
  v_add_u32 v16, 16384, v7
  v_xor_b32 v13, 64, v12
  v_xor_b32 v17, 32, v16
  v_xor_b32 v14, 128, v12
  v_xor_b32 v18, 64, v16
  v_xor_b32 v15, 192, v12
  v_xor_b32 v19, 96, v16
  ds_read_b128 a[36:39], v16
  ds_read_b64_tr_b16 a[0:1], v12 offset:0
  ds_read_b64_tr_b16 a[2:3], v12 offset:1024
  buffer_load_dwordx4 v133, s[12:15], s37 offen offset:1024 lds
  v_mfma_f32_32x32x16_bf16 v[112:127], a[12:15], a[40:43], v[112:127]
  ds_read_b64_tr_b16 a[4:5], v13 offset:0
  ds_read_b64_tr_b16 a[6:7], v13 offset:1024
  s_waitcnt lgkmcnt(9)
  v_mfma_f32_32x32x16_bf16 v[64:79], a[16:19], a[32:35], v[64:79]
  ds_read_b64_tr_b16 a[8:9], v14 offset:0
  ds_read_b64_tr_b16 a[10:11], v14 offset:1024
  buffer_load_dwordx4 v134, s[12:15], s37 offen offset:2048 lds
  v_mfma_f32_32x32x16_bf16 v[80:95], a[20:23], a[32:35], v[80:95]
  ds_read_b64_tr_b16 a[12:13], v15 offset:0
  ds_read_b64_tr_b16 a[14:15], v15 offset:1024
  s_waitcnt lgkmcnt(9)
  v_mfma_f32_32x32x16_bf16 v[96:111], a[24:27], a[32:35], v[96:111]
  ds_read_b128 a[40:43], v17
  ds_read_b64_tr_b16 a[16:17], v12 offset:4096
  ds_read_b64_tr_b16 a[18:19], v12 offset:5120
  buffer_load_dwordx4 v135, s[12:15], s37 offen offset:3072 lds
  v_mfma_f32_32x32x16_bf16 v[112:127], a[28:31], a[32:35], v[112:127]
  ds_read_b64_tr_b16 a[20:21], v13 offset:4096
  ds_read_b64_tr_b16 a[22:23], v13 offset:5120
  s_waitcnt lgkmcnt(9)
  v_mfma_f32_32x32x16_bf16 v[64:79], a[0:3], a[36:39], v[64:79]
  s_barrier
  ds_read_b64_tr_b16 a[24:25], v14 offset:4096
  ds_read_b64_tr_b16 a[26:27], v14 offset:5120
  s_add_u32 m0, s28, 0
  s_lshl_b32 s36, s34, 7
  s_lshl_b32 s37, s34, 19
  s_add_u32 s34, s34, 1
  s_cmp_ge_u32 s34, 10
  s_cselect_b32 s34, 0, s34
  buffer_load_dwordx4 v128, s[8:11], s36 offen offset:0 lds
  v_mfma_f32_32x32x16_bf16 v[80:95], a[4:7], a[36:39], v[80:95]
  ds_read_b64_tr_b16 a[28:29], v15 offset:4096
  ds_read_b64_tr_b16 a[30:31], v15 offset:5120
  s_waitcnt lgkmcnt(9)
  v_mfma_f32_32x32x16_bf16 v[96:111], a[8:11], a[36:39], v[96:111]
  ds_read_b128 a[32:35], v18
  ds_read_b64_tr_b16 a[0:1], v12 offset:8192
  ds_read_b64_tr_b16 a[2:3], v12 offset:9216
  buffer_load_dwordx4 v129, s[8:11], s36 offen offset:1024 lds
  v_mfma_f32_32x32x16_bf16 v[112:127], a[12:15], a[36:39], v[112:127]
  ds_read_b64_tr_b16 a[4:5], v13 offset:8192
  ds_read_b64_tr_b16 a[6:7], v13 offset:9216
  s_waitcnt lgkmcnt(9)
  v_mfma_f32_32x32x16_bf16 v[64:79], a[16:19], a[40:43], v[64:79]
  ds_read_b64_tr_b16 a[8:9], v14 offset:8192
  ds_read_b64_tr_b16 a[10:11], v14 offset:9216
  buffer_load_dwordx4 v130, s[8:11], s36 offen offset:2048 lds
  v_mfma_f32_32x32x16_bf16 v[80:95], a[20:23], a[40:43], v[80:95]
  ds_read_b64_tr_b16 a[12:13], v15 offset:8192
  ds_read_b64_tr_b16 a[14:15], v15 offset:9216
  s_waitcnt lgkmcnt(9)
  v_mfma_f32_32x32x16_bf16 v[96:111], a[24:27], a[40:43], v[96:111]
  ds_read_b128 a[36:39], v19
  ds_read_b64_tr_b16 a[16:17], v12 offset:12288
  ds_read_b64_tr_b16 a[18:19], v12 offset:13312
  buffer_load_dwordx4 v131, s[8:11], s36 offen offset:3072 lds
  v_mfma_f32_32x32x16_bf16 v[112:127], a[28:31], a[40:43], v[112:127]
  ds_read_b64_tr_b16 a[20:21], v13 offset:12288
  ds_read_b64_tr_b16 a[22:23], v13 offset:13312
  s_waitcnt lgkmcnt(9)
  v_mfma_f32_32x32x16_bf16 v[64:79], a[0:3], a[32:35], v[64:79]
  ds_read_b64_tr_b16 a[24:25], v14 offset:12288
  ds_read_b64_tr_b16 a[26:27], v14 offset:13312
  s_add_u32 m0, s28, 49152
  s_nop 0
  buffer_load_dwordx4 v132, s[12:15], s37 offen offset:0 lds
  v_mfma_f32_32x32x16_bf16 v[80:95], a[4:7], a[32:35], v[80:95]
  ds_read_b64_tr_b16 a[28:29], v15 offset:12288
  ds_read_b64_tr_b16 a[30:31], v15 offset:13312
  s_waitcnt lgkmcnt(9)
  v_mfma_f32_32x32x16_bf16 v[96:111], a[8:11], a[32:35], v[96:111]
  s_waitcnt vmcnt(5)
  s_barrier
  v_add_u32 v12, 131072, v8
  v_add_u32 v16, 32768, v7
  v_xor_b32 v13, 64, v12
  v_xor_b32 v17, 32, v16
  v_xor_b32 v14, 128, v12
  v_xor_b32 v18, 64, v16
  v_xor_b32 v15, 192, v12
  v_xor_b32 v19, 96, v16
  ds_read_b128 a[40:43], v16
  ds_read_b64_tr_b16 a[0:1], v12 offset:0
  ds_read_b64_tr_b16 a[2:3], v12 offset:1024
  buffer_load_dwordx4 v133, s[12:15], s37 offen offset:1024 lds
  v_mfma_f32_32x32x16_bf16 v[112:127], a[12:15], a[32:35], v[112:127]
  ds_read_b64_tr_b16 a[4:5], v13 offset:0
  ds_read_b64_tr_b16 a[6:7], v13 offset:1024
  s_waitcnt lgkmcnt(9)
  v_mfma_f32_32x32x16_bf16 v[64:79], a[16:19], a[36:39], v[64:79]
  ds_read_b64_tr_b16 a[8:9], v14 offset:0
  ds_read_b64_tr_b16 a[10:11], v14 offset:1024
  buffer_load_dwordx4 v134, s[12:15], s37 offen offset:2048 lds
  v_mfma_f32_32x32x16_bf16 v[80:95], a[20:23], a[36:39], v[80:95]
  ds_read_b64_tr_b16 a[12:13], v15 offset:0
  ds_read_b64_tr_b16 a[14:15], v15 offset:1024
  s_waitcnt lgkmcnt(9)
  v_mfma_f32_32x32x16_bf16 v[96:111], a[24:27], a[36:39], v[96:111]
  ds_read_b128 a[32:35], v17
  ds_read_b64_tr_b16 a[16:17], v12 offset:4096
  ds_read_b64_tr_b16 a[18:19], v12 offset:5120
  buffer_load_dwordx4 v135, s[12:15], s37 offen offset:3072 lds
  v_mfma_f32_32x32x16_bf16 v[112:127], a[28:31], a[36:39], v[112:127]
  ds_read_b64_tr_b16 a[20:21], v13 offset:4096
  ds_read_b64_tr_b16 a[22:23], v13 offset:5120
  s_waitcnt lgkmcnt(9)
  v_mfma_f32_32x32x16_bf16 v[64:79], a[0:3], a[40:43], v[64:79]
  s_barrier
  ds_read_b64_tr_b16 a[24:25], v14 offset:4096
  ds_read_b64_tr_b16 a[26:27], v14 offset:5120
  s_add_u32 m0, s28, 16384
  s_lshl_b32 s36, s34, 7
  s_lshl_b32 s37, s34, 19
  s_add_u32 s34, s34, 1
  s_cmp_ge_u32 s34, 10
  s_cselect_b32 s34, 0, s34
  buffer_load_dwordx4 v128, s[8:11], s36 offen offset:0 lds
  v_mfma_f32_32x32x16_bf16 v[80:95], a[4:7], a[40:43], v[80:95]
  ds_read_b64_tr_b16 a[28:29], v15 offset:4096
  ds_read_b64_tr_b16 a[30:31], v15 offset:5120
  s_waitcnt lgkmcnt(9)
  v_mfma_f32_32x32x16_bf16 v[96:111], a[8:11], a[40:43], v[96:111]
  ds_read_b128 a[36:39], v18
  ds_read_b64_tr_b16 a[0:1], v12 offset:8192
  ds_read_b64_tr_b16 a[2:3], v12 offset:9216
  buffer_load_dwordx4 v129, s[8:11], s36 offen offset:1024 lds
  v_mfma_f32_32x32x16_bf16 v[112:127], a[12:15], a[40:43], v[112:127]
  ds_read_b64_tr_b16 a[4:5], v13 offset:8192
  ds_read_b64_tr_b16 a[6:7], v13 offset:9216
  s_waitcnt lgkmcnt(9)
  v_mfma_f32_32x32x16_bf16 v[64:79], a[16:19], a[32:35], v[64:79]
  ds_read_b64_tr_b16 a[8:9], v14 offset:8192
  ds_read_b64_tr_b16 a[10:11], v14 offset:9216
  buffer_load_dwordx4 v130, s[8:11], s36 offen offset:2048 lds
  v_mfma_f32_32x32x16_bf16 v[80:95], a[20:23], a[32:35], v[80:95]
  ds_read_b64_tr_b16 a[12:13], v15 offset:8192
  ds_read_b64_tr_b16 a[14:15], v15 offset:9216
  s_waitcnt lgkmcnt(9)
  v_mfma_f32_32x32x16_bf16 v[96:111], a[24:27], a[32:35], v[96:111]
  ds_read_b128 a[40:43], v19
  ds_read_b64_tr_b16 a[16:17], v12 offset:12288
  ds_read_b64_tr_b16 a[18:19], v12 offset:13312
  buffer_load_dwordx4 v131, s[8:11], s36 offen offset:3072 lds
  v_mfma_f32_32x32x16_bf16 v[112:127], a[28:31], a[32:35], v[112:127]
  ds_read_b64_tr_b16 a[20:21], v13 offset:12288
  ds_read_b64_tr_b16 a[22:23], v13 offset:13312
  s_waitcnt lgkmcnt(9)
  v_mfma_f32_32x32x16_bf16 v[64:79], a[0:3], a[36:39], v[64:79]
  ds_read_b64_tr_b16 a[24:25], v14 offset:12288
  ds_read_b64_tr_b16 a[26:27], v14 offset:13312
  s_add_u32 m0, s28, 65536
  s_nop 0
  buffer_load_dwordx4 v132, s[12:15], s37 offen offset:0 lds
  v_mfma_f32_32x32x16_bf16 v[80:95], a[4:7], a[36:39], v[80:95]
  ds_read_b64_tr_b16 a[28:29], v15 offset:12288
  ds_read_b64_tr_b16 a[30:31], v15 offset:13312
  s_waitcnt lgkmcnt(9)
  v_mfma_f32_32x32x16_bf16 v[96:111], a[8:11], a[36:39], v[96:111]
  s_waitcnt vmcnt(5)
  s_barrier
  v_add_u32 v12, 49152, v8
  v_add_u32 v16, 0, v7
  v_xor_b32 v13, 64, v12
  v_xor_b32 v17, 32, v16
  v_xor_b32 v14, 128, v12
  v_xor_b32 v18, 64, v16
  v_xor_b32 v15, 192, v12
  v_xor_b32 v19, 96, v16
  ds_read_b128 a[32:35], v16
  ds_read_b64_tr_b16 a[0:1], v12 offset:0
  ds_read_b64_tr_b16 a[2:3], v12 offset:1024
  buffer_load_dwordx4 v133, s[12:15], s37 offen offset:1024 lds
  v_mfma_f32_32x32x16_bf16 v[112:127], a[12:15], a[36:39], v[112:127]
  ds_read_b64_tr_b16 a[4:5], v13 offset:0
  ds_read_b64_tr_b16 a[6:7], v13 offset:1024
  s_waitcnt lgkmcnt(9)
  v_mfma_f32_32x32x16_bf16 v[64:79], a[16:19], a[40:43], v[64:79]
  ds_read_b64_tr_b16 a[8:9], v14 offset:0
  ds_read_b64_tr_b16 a[10:11], v14 offset:1024
  buffer_load_dwordx4 v134, s[12:15], s37 offen offset:2048 lds
  v_mfma_f32_32x32x16_bf16 v[80:95], a[20:23], a[40:43], v[80:95]
  ds_read_b64_tr_b16 a[12:13], v15 offset:0
  ds_read_b64_tr_b16 a[14:15], v15 offset:1024
  s_waitcnt lgkmcnt(9)
  v_mfma_f32_32x32x16_bf16 v[96:111], a[24:27], a[40:43], v[96:111]
  ds_read_b128 a[36:39], v17
  ds_read_b64_tr_b16 a[16:17], v12 offset:4096
  ds_read_b64_tr_b16 a[18:19], v12 offset:5120
  buffer_load_dwordx4 v135, s[12:15], s37 offen offset:3072 lds
  v_mfma_f32_32x32x16_bf16 v[112:127], a[28:31], a[40:43], v[112:127]
  ds_read_b64_tr_b16 a[20:21], v13 offset:4096
  ds_read_b64_tr_b16 a[22:23], v13 offset:5120
  s_waitcnt lgkmcnt(9)
  v_mfma_f32_32x32x16_bf16 v[64:79], a[0:3], a[32:35], v[64:79]
  s_barrier
  ds_read_b64_tr_b16 a[24:25], v14 offset:4096
  ds_read_b64_tr_b16 a[26:27], v14 offset:5120
  s_add_u32 m0, s28, 32768
  s_lshl_b32 s36, s34, 7
  s_lshl_b32 s37, s34, 19
  s_add_u32 s34, s34, 1
  s_cmp_ge_u32 s34, 10
  s_cselect_b32 s34, 0, s34
  buffer_load_dwordx4 v128, s[8:11], s36 offen offset:0 lds
  v_mfma_f32_32x32x16_bf16 v[80:95], a[4:7], a[32:35], v[80:95]
  ds_read_b64_tr_b16 a[28:29], v15 offset:4096
  ds_read_b64_tr_b16 a[30:31], v15 offset:5120
  s_waitcnt lgkmcnt(9)
  v_mfma_f32_32x32x16_bf16 v[96:111], a[8:11], a[32:35], v[96:111]
  ds_read_b128 a[40:43], v18
  ds_read_b64_tr_b16 a[0:1], v12 offset:8192
  ds_read_b64_tr_b16 a[2:3], v12 offset:9216
  buffer_load_dwordx4 v129, s[8:11], s36 offen offset:1024 lds
  v_mfma_f32_32x32x16_bf16 v[112:127], a[12:15], a[32:35], v[112:127]
  ds_read_b64_tr_b16 a[4:5], v13 offset:8192
  ds_read_b64_tr_b16 a[6:7], v13 offset:9216
  s_waitcnt lgkmcnt(9)
  v_mfma_f32_32x32x16_bf16 v[64:79], a[16:19], a[36:39], v[64:79]
  ds_read_b64_tr_b16 a[8:9], v14 offset:8192
  ds_read_b64_tr_b16 a[10:11], v14 offset:9216
  buffer_load_dwordx4 v130, s[8:11], s36 offen offset:2048 lds
  v_mfma_f32_32x32x16_bf16 v[80:95], a[20:23], a[36:39], v[80:95]
  ds_read_b64_tr_b16 a[12:13], v15 offset:8192
  ds_read_b64_tr_b16 a[14:15], v15 offset:9216
  s_waitcnt lgkmcnt(9)
  v_mfma_f32_32x32x16_bf16 v[96:111], a[24:27], a[36:39], v[96:111]
  ds_read_b128 a[32:35], v19
  ds_read_b64_tr_b16 a[16:17], v12 offset:12288
  ds_read_b64_tr_b16 a[18:19], v12 offset:13312
  buffer_load_dwordx4 v131, s[8:11], s36 offen offset:3072 lds
  v_mfma_f32_32x32x16_bf16 v[112:127], a[28:31], a[36:39], v[112:127]
  ds_read_b64_tr_b16 a[20:21], v13 offset:12288
  ds_read_b64_tr_b16 a[22:23], v13 offset:13312
  s_waitcnt lgkmcnt(9)
  v_mfma_f32_32x32x16_bf16 v[64:79], a[0:3], a[40:43], v[64:79]
  ds_read_b64_tr_b16 a[24:25], v14 offset:12288
  ds_read_b64_tr_b16 a[26:27], v14 offset:13312
  s_add_u32 m0, s28, 131072
  s_nop 0
  buffer_load_dwordx4 v132, s[12:15], s37 offen offset:0 lds
  v_mfma_f32_32x32x16_bf16 v[80:95], a[4:7], a[40:43], v[80:95]
  ds_read_b64_tr_b16 a[28:29], v15 offset:12288
  ds_read_b64_tr_b16 a[30:31], v15 offset:13312
  s_waitcnt lgkmcnt(9)
  v_mfma_f32_32x32x16_bf16 v[96:111], a[8:11], a[40:43], v[96:111]
  s_waitcnt vmcnt(5)
  s_barrier
  v_add_u32 v12, 65536, v8
  v_add_u32 v16, 16384, v7
  v_xor_b32 v13, 64, v12
  v_xor_b32 v17, 32, v16
  v_xor_b32 v14, 128, v12
  v_xor_b32 v18, 64, v16
  v_xor_b32 v15, 192, v12
  v_xor_b32 v19, 96, v16
  ds_read_b128 a[36:39], v16
  ds_read_b64_tr_b16 a[0:1], v12 offset:0
  ds_read_b64_tr_b16 a[2:3], v12 offset:1024
  buffer_load_dwordx4 v133, s[12:15], s37 offen offset:1024 lds
  v_mfma_f32_32x32x16_bf16 v[112:127], a[12:15], a[40:43], v[112:127]
  ds_read_b64_tr_b16 a[4:5], v13 offset:0
  ds_read_b64_tr_b16 a[6:7], v13 offset:1024
  s_waitcnt lgkmcnt(9)
  v_mfma_f32_32x32x16_bf16 v[64:79], a[16:19], a[32:35], v[64:79]
  ds_read_b64_tr_b16 a[8:9], v14 offset:0
  ds_read_b64_tr_b16 a[10:11], v14 offset:1024
  buffer_load_dwordx4 v134, s[12:15], s37 offen offset:2048 lds
  v_mfma_f32_32x32x16_bf16 v[80:95], a[20:23], a[32:35], v[80:95]
  ds_read_b64_tr_b16 a[12:13], v15 offset:0
  ds_read_b64_tr_b16 a[14:15], v15 offset:1024
  s_waitcnt lgkmcnt(9)
  v_mfma_f32_32x32x16_bf16 v[96:111], a[24:27], a[32:35], v[96:111]
  ds_read_b128 a[40:43], v17
  ds_read_b64_tr_b16 a[16:17], v12 offset:4096
  ds_read_b64_tr_b16 a[18:19], v12 offset:5120
  buffer_load_dwordx4 v135, s[12:15], s37 offen offset:3072 lds
  v_mfma_f32_32x32x16_bf16 v[112:127], a[28:31], a[32:35], v[112:127]
  ds_read_b64_tr_b16 a[20:21], v13 offset:4096
  ds_read_b64_tr_b16 a[22:23], v13 offset:5120
  s_waitcnt lgkmcnt(9)
  v_mfma_f32_32x32x16_bf16 v[64:79], a[0:3], a[36:39], v[64:79]
  s_barrier
  ds_read_b64_tr_b16 a[24:25], v14 offset:4096
  ds_read_b64_tr_b16 a[26:27], v14 offset:5120
  s_add_u32 m0, s28, 0
  s_lshl_b32 s36, s34, 7
  s_lshl_b32 s37, s34, 19
  s_add_u32 s34, s34, 1
  s_cmp_ge_u32 s34, 10
  s_cselect_b32 s34, 0, s34
  buffer_load_dwordx4 v128, s[8:11], s36 offen offset:0 lds
  v_mfma_f32_32x32x16_bf16 v[80:95], a[4:7], a[36:39], v[80:95]
  ds_read_b64_tr_b16 a[28:29], v15 offset:4096
  ds_read_b64_tr_b16 a[30:31], v15 offset:5120
  s_waitcnt lgkmcnt(9)
  v_mfma_f32_32x32x16_bf16 v[96:111], a[8:11], a[36:39], v[96:111]
  ds_read_b128 a[32:35], v18
  ds_read_b64_tr_b16 a[0:1], v12 offset:8192
  ds_read_b64_tr_b16 a[2:3], v12 offset:9216
  buffer_load_dwordx4 v129, s[8:11], s36 offen offset:1024 lds
  v_mfma_f32_32x32x16_bf16 v[112:127], a[12:15], a[36:39], v[112:127]
  ds_read_b64_tr_b16 a[4:5], v13 offset:8192
  ds_read_b64_tr_b16 a[6:7], v13 offset:9216
  s_waitcnt lgkmcnt(9)
  v_mfma_f32_32x32x16_bf16 v[64:79], a[16:19], a[40:43], v[64:79]
  ds_read_b64_tr_b16 a[8:9], v14 offset:8192
  ds_read_b64_tr_b16 a[10:11], v14 offset:9216
  buffer_load_dwordx4 v130, s[8:11], s36 offen offset:2048 lds
  v_mfma_f32_32x32x16_bf16 v[80:95], a[20:23], a[40:43], v[80:95]
  ds_read_b64_tr_b16 a[12:13], v15 offset:8192
  ds_read_b64_tr_b16 a[14:15], v15 offset:9216
  s_waitcnt lgkmcnt(9)
  v_mfma_f32_32x32x16_bf16 v[96:111], a[24:27], a[40:43], v[96:111]
  ds_read_b128 a[36:39], v19
  ds_read_b64_tr_b16 a[16:17], v12 offset:12288
  ds_read_b64_tr_b16 a[18:19], v12 offset:13312
  buffer_load_dwordx4 v131, s[8:11], s36 offen offset:3072 lds
  v_mfma_f32_32x32x16_bf16 v[112:127], a[28:31], a[40:43], v[112:127]
  ds_read_b64_tr_b16 a[20:21], v13 offset:12288
  ds_read_b64_tr_b16 a[22:23], v13 offset:13312
  s_waitcnt lgkmcnt(9)
  v_mfma_f32_32x32x16_bf16 v[64:79], a[0:3], a[32:35], v[64:79]
  ds_read_b64_tr_b16 a[24:25], v14 offset:12288
  ds_read_b64_tr_b16 a[26:27], v14 offset:13312
  s_add_u32 m0, s28, 49152
  s_nop 0
  buffer_load_dwordx4 v132, s[12:15], s37 offen offset:0 lds
  v_mfma_f32_32x32x16_bf16 v[80:95], a[4:7], a[32:35], v[80:95]
  ds_read_b64_tr_b16 a[28:29], v15 offset:12288
  ds_read_b64_tr_b16 a[30:31], v15 offset:13312
  s_waitcnt lgkmcnt(9)
  v_mfma_f32_32x32x16_bf16 v[96:111], a[8:11], a[32:35], v[96:111]
  s_waitcnt vmcnt(5)
  s_barrier
  v_add_u32 v12, 131072, v8
  v_add_u32 v16, 32768, v7
  v_xor_b32 v13, 64, v12
  v_xor_b32 v17, 32, v16
  v_xor_b32 v14, 128, v12
  v_xor_b32 v18, 64, v16
  v_xor_b32 v15, 192, v12
  v_xor_b32 v19, 96, v16
  ds_read_b128 a[40:43], v16
  ds_read_b64_tr_b16 a[0:1], v12 offset:0
  ds_read_b64_tr_b16 a[2:3], v12 offset:1024
  buffer_load_dwordx4 v133, s[12:15], s37 offen offset:1024 lds
  v_mfma_f32_32x32x16_bf16 v[112:127], a[12:15], a[32:35], v[112:127]
  ds_read_b64_tr_b16 a[4:5], v13 offset:0
  ds_read_b64_tr_b16 a[6:7], v13 offset:1024
  s_waitcnt lgkmcnt(9)
  v_mfma_f32_32x32x16_bf16 v[64:79], a[16:19], a[36:39], v[64:79]
  ds_read_b64_tr_b16 a[8:9], v14 offset:0
  ds_read_b64_tr_b16 a[10:11], v14 offset:1024
  buffer_load_dwordx4 v134, s[12:15], s37 offen offset:2048 lds
  v_mfma_f32_32x32x16_bf16 v[80:95], a[20:23], a[36:39], v[80:95]
  ds_read_b64_tr_b16 a[12:13], v15 offset:0
  ds_read_b64_tr_b16 a[14:15], v15 offset:1024
  s_waitcnt lgkmcnt(9)
  v_mfma_f32_32x32x16_bf16 v[96:111], a[24:27], a[36:39], v[96:111]
  ds_read_b128 a[32:35], v17
  ds_read_b64_tr_b16 a[16:17], v12 offset:4096
  ds_read_b64_tr_b16 a[18:19], v12 offset:5120
  buffer_load_dwordx4 v135, s[12:15], s37 offen offset:3072 lds
  v_mfma_f32_32x32x16_bf16 v[112:127], a[28:31], a[36:39], v[112:127]
  ds_read_b64_tr_b16 a[20:21], v13 offset:4096
  ds_read_b64_tr_b16 a[22:23], v13 offset:5120
  s_waitcnt lgkmcnt(9)
  v_mfma_f32_32x32x16_bf16 v[64:79], a[0:3], a[40:43], v[64:79]
  s_barrier
  ds_read_b64_tr_b16 a[24:25], v14 offset:4096
  ds_read_b64_tr_b16 a[26:27], v14 offset:5120
  s_add_u32 m0, s28, 16384
  s_lshl_b32 s36, s34, 7
  s_lshl_b32 s37, s34, 19
  s_add_u32 s34, s34, 1
  s_cmp_ge_u32 s34, 10
  s_cselect_b32 s34, 0, s34
  buffer_load_dwordx4 v128, s[8:11], s36 offen offset:0 lds
  v_mfma_f32_32x32x16_bf16 v[80:95], a[4:7], a[40:43], v[80:95]
  ds_read_b64_tr_b16 a[28:29], v15 offset:4096
  ds_read_b64_tr_b16 a[30:31], v15 offset:5120
  s_waitcnt lgkmcnt(9)
  v_mfma_f32_32x32x16_bf16 v[96:111], a[8:11], a[40:43], v[96:111]
  ds_read_b128 a[36:39], v18
  ds_read_b64_tr_b16 a[0:1], v12 offset:8192
  ds_read_b64_tr_b16 a[2:3], v12 offset:9216
  buffer_load_dwordx4 v129, s[8:11], s36 offen offset:1024 lds
  v_mfma_f32_32x32x16_bf16 v[112:127], a[12:15], a[40:43], v[112:127]
  ds_read_b64_tr_b16 a[4:5], v13 offset:8192
  ds_read_b64_tr_b16 a[6:7], v13 offset:9216
  s_waitcnt lgkmcnt(9)
  v_mfma_f32_32x32x16_bf16 v[64:79], a[16:19], a[32:35], v[64:79]
  ds_read_b64_tr_b16 a[8:9], v14 offset:8192
  ds_read_b64_tr_b16 a[10:11], v14 offset:9216
  buffer_load_dwordx4 v130, s[8:11], s36 offen offset:2048 lds
  v_mfma_f32_32x32x16_bf16 v[80:95], a[20:23], a[32:35], v[80:95]
  ds_read_b64_tr_b16 a[12:13], v15 offset:8192
  ds_read_b64_tr_b16 a[14:15], v15 offset:9216
  s_waitcnt lgkmcnt(9)
  v_mfma_f32_32x32x16_bf16 v[96:111], a[24:27], a[32:35], v[96:111]
  ds_read_b128 a[40:43], v19
  ds_read_b64_tr_b16 a[16:17], v12 offset:12288
  ds_read_b64_tr_b16 a[18:19], v12 offset:13312
  buffer_load_dwordx4 v131, s[8:11], s36 offen offset:3072 lds
  v_mfma_f32_32x32x16_bf16 v[112:127], a[28:31], a[32:35], v[112:127]
  ds_read_b64_tr_b16 a[20:21], v13 offset:12288
  ds_read_b64_tr_b16 a[22:23], v13 offset:13312
  s_waitcnt lgkmcnt(9)
  v_mfma_f32_32x32x16_bf16 v[64:79], a[0:3], a[36:39], v[64:79]
  ds_read_b64_tr_b16 a[24:25], v14 offset:12288
  ds_read_b64_tr_b16 a[26:27], v14 offset:13312
  s_add_u32 m0, s28, 65536
  s_nop 0
  buffer_load_dwordx4 v132, s[12:15], s37 offen offset:0 lds
  v_mfma_f32_32x32x16_bf16 v[80:95], a[4:7], a[36:39], v[80:95]
  ds_read_b64_tr_b16 a[28:29], v15 offset:12288
  ds_read_b64_tr_b16 a[30:31], v15 offset:13312
  s_waitcnt lgkmcnt(9)
  v_mfma_f32_32x32x16_bf16 v[96:111], a[8:11], a[36:39], v[96:111]
  s_waitcnt vmcnt(5)
  s_barrier
  v_add_u32 v12, 49152, v8
  v_add_u32 v16, 0, v7
  v_xor_b32 v13, 64, v12
  v_xor_b32 v17, 32, v16
  v_xor_b32 v14, 128, v12
  v_xor_b32 v18, 64, v16
  v_xor_b32 v15, 192, v12
  v_xor_b32 v19, 96, v16
  ds_read_b128 a[32:35], v16
  ds_read_b64_tr_b16 a[0:1], v12 offset:0
  ds_read_b64_tr_b16 a[2:3], v12 offset:1024
  buffer_load_dwordx4 v133, s[12:15], s37 offen offset:1024 lds
  v_mfma_f32_32x32x16_bf16 v[112:127], a[12:15], a[36:39], v[112:127]
  ds_read_b64_tr_b16 a[4:5], v13 offset:0
  ds_read_b64_tr_b16 a[6:7], v13 offset:1024
  s_waitcnt lgkmcnt(9)
  v_mfma_f32_32x32x16_bf16 v[64:79], a[16:19], a[40:43], v[64:79]
  ds_read_b64_tr_b16 a[8:9], v14 offset:0
  ds_read_b64_tr_b16 a[10:11], v14 offset:1024
  buffer_load_dwordx4 v134, s[12:15], s37 offen offset:2048 lds
  v_mfma_f32_32x32x16_bf16 v[80:95], a[20:23], a[40:43], v[80:95]
  ds_read_b64_tr_b16 a[12:13], v15 offset:0
  ds_read_b64_tr_b16 a[14:15], v15 offset:1024
  s_waitcnt lgkmcnt(9)
  v_mfma_f32_32x32x16_bf16 v[96:111], a[24:27], a[40:43], v[96:111]
  ds_read_b128 a[36:39], v17
  ds_read_b64_tr_b16 a[16:17], v12 offset:4096
  ds_read_b64_tr_b16 a[18:19], v12 offset:5120
  buffer_load_dwordx4 v135, s[12:15], s37 offen offset:3072 lds
  v_mfma_f32_32x32x16_bf16 v[112:127], a[28:31], a[40:43], v[112:127]
  ds_read_b64_tr_b16 a[20:21], v13 offset:4096
  ds_read_b64_tr_b16 a[22:23], v13 offset:5120
  s_waitcnt lgkmcnt(9)
  v_mfma_f32_32x32x16_bf16 v[64:79], a[0:3], a[32:35], v[64:79]
  s_barrier
  ds_read_b64_tr_b16 a[24:25], v14 offset:4096
  ds_read_b64_tr_b16 a[26:27], v14 offset:5120
  s_add_u32 m0, s28, 32768
  s_lshl_b32 s36, s34, 7
  s_lshl_b32 s37, s34, 19
  s_add_u32 s34, s34, 1
  s_cmp_ge_u32 s34, 10
  s_cselect_b32 s34, 0, s34
  buffer_load_dwordx4 v128, s[8:11], s36 offen offset:0 lds
  v_mfma_f32_32x32x16_bf16 v[80:95], a[4:7], a[32:35], v[80:95]
  ds_read_b64_tr_b16 a[28:29], v15 offset:4096
  ds_read_b64_tr_b16 a[30:31], v15 offset:5120
  s_waitcnt lgkmcnt(9)
  v_mfma_f32_32x32x16_bf16 v[96:111], a[8:11], a[32:35], v[96:111]
  ds_read_b128 a[40:43], v18
  ds_read_b64_tr_b16 a[0:1], v12 offset:8192
  ds_read_b64_tr_b16 a[2:3], v12 offset:9216
  buffer_load_dwordx4 v129, s[8:11], s36 offen offset:1024 lds
  v_mfma_f32_32x32x16_bf16 v[112:127], a[12:15], a[32:35], v[112:127]
  ds_read_b64_tr_b16 a[4:5], v13 offset:8192
  ds_read_b64_tr_b16 a[6:7], v13 offset:9216
  s_waitcnt lgkmcnt(9)
  v_mfma_f32_32x32x16_bf16 v[64:79], a[16:19], a[36:39], v[64:79]
  ds_read_b64_tr_b16 a[8:9], v14 offset:8192
  ds_read_b64_tr_b16 a[10:11], v14 offset:9216
  buffer_load_dwordx4 v130, s[8:11], s36 offen offset:2048 lds
  v_mfma_f32_32x32x16_bf16 v[80:95], a[20:23], a[36:39], v[80:95]
  ds_read_b64_tr_b16 a[12:13], v15 offset:8192
  ds_read_b64_tr_b16 a[14:15], v15 offset:9216
  s_waitcnt lgkmcnt(9)
  v_mfma_f32_32x32x16_bf16 v[96:111], a[24:27], a[36:39], v[96:111]
  ds_read_b128 a[32:35], v19
  ds_read_b64_tr_b16 a[16:17], v12 offset:12288
  ds_read_b64_tr_b16 a[18:19], v12 offset:13312
  buffer_load_dwordx4 v131, s[8:11], s36 offen offset:3072 lds
  v_mfma_f32_32x32x16_bf16 v[112:127], a[28:31], a[36:39], v[112:127]
  ds_read_b64_tr_b16 a[20:21], v13 offset:12288
  ds_read_b64_tr_b16 a[22:23], v13 offset:13312
  s_waitcnt lgkmcnt(9)
  v_mfma_f32_32x32x16_bf16 v[64:79], a[0:3], a[40:43], v[64:79]
  ds_read_b64_tr_b16 a[24:25], v14 offset:12288
  ds_read_b64_tr_b16 a[26:27], v14 offset:13312
  s_add_u32 m0, s28, 131072
  s_nop 0
  buffer_load_dwordx4 v132, s[12:15], s37 offen offset:0 lds
  v_mfma_f32_32x32x16_bf16 v[80:95], a[4:7], a[40:43], v[80:95]
  ds_read_b64_tr_b16 a[28:29], v15 offset:12288
  ds_read_b64_tr_b16 a[30:31], v15 offset:13312
  s_waitcnt lgkmcnt(9)
  v_mfma_f32_32x32x16_bf16 v[96:111], a[8:11], a[40:43], v[96:111]
  s_waitcnt vmcnt(5)
  s_barrier
  v_add_u32 v12, 65536, v8
  v_add_u32 v16, 16384, v7
  v_xor_b32 v13, 64, v12
  v_xor_b32 v17, 32, v16
  v_xor_b32 v14, 128, v12
  v_xor_b32 v18, 64, v16
  v_xor_b32 v15, 192, v12
  v_xor_b32 v19, 96, v16
  ds_read_b128 a[36:39], v16
  ds_read_b64_tr_b16 a[0:1], v12 offset:0
  ds_read_b64_tr_b16 a[2:3], v12 offset:1024
  buffer_load_dwordx4 v133, s[12:15], s37 offen offset:1024 lds
  v_mfma_f32_32x32x16_bf16 v[112:127], a[12:15], a[40:43], v[112:127]
  ds_read_b64_tr_b16 a[4:5], v13 offset:0
  ds_read_b64_tr_b16 a[6:7], v13 offset:1024
  s_waitcnt lgkmcnt(9)
  v_mfma_f32_32x32x16_bf16 v[64:79], a[16:19], a[32:35], v[64:79]
  ds_read_b64_tr_b16 a[8:9], v14 offset:0
  ds_read_b64_tr_b16 a[10:11], v14 offset:1024
  buffer_load_dwordx4 v134, s[12:15], s37 offen offset:2048 lds
  v_mfma_f32_32x32x16_bf16 v[80:95], a[20:23], a[32:35], v[80:95]
  ds_read_b64_tr_b16 a[12:13], v15 offset:0
  ds_read_b64_tr_b16 a[14:15], v15 offset:1024
  s_waitcnt lgkmcnt(9)
  v_mfma_f32_32x32x16_bf16 v[96:111], a[24:27], a[32:35], v[96:111]
  ds_read_b128 a[40:43], v17
  ds_read_b64_tr_b16 a[16:17], v12 offset:4096
  ds_read_b64_tr_b16 a[18:19], v12 offset:5120
  buffer_load_dwordx4 v135, s[12:15], s37 offen offset:3072 lds
  v_mfma_f32_32x32x16_bf16 v[112:127], a[28:31], a[32:35], v[112:127]
  ds_read_b64_tr_b16 a[20:21], v13 offset:4096
  ds_read_b64_tr_b16 a[22:23], v13 offset:5120
  s_waitcnt lgkmcnt(9)
  v_mfma_f32_32x32x16_bf16 v[64:79], a[0:3], a[36:39], v[64:79]
  s_barrier
  ds_read_b64_tr_b16 a[24:25], v14 offset:4096
  ds_read_b64_tr_b16 a[26:27], v14 offset:5120
  s_add_u32 m0, s28, 0
  s_lshl_b32 s36, s34, 7
  s_lshl_b32 s37, s34, 19
  s_add_u32 s34, s34, 1
  s_cmp_ge_u32 s34, 10
  s_cselect_b32 s34, 0, s34
  buffer_load_dwordx4 v128, s[8:11], s36 offen offset:0 lds
  v_mfma_f32_32x32x16_bf16 v[80:95], a[4:7], a[36:39], v[80:95]
  ds_read_b64_tr_b16 a[28:29], v15 offset:4096
  ds_read_b64_tr_b16 a[30:31], v15 offset:5120
  s_waitcnt lgkmcnt(9)
  v_mfma_f32_32x32x16_bf16 v[96:111], a[8:11], a[36:39], v[96:111]
  ds_read_b128 a[32:35], v18
  ds_read_b64_tr_b16 a[0:1], v12 offset:8192
  ds_read_b64_tr_b16 a[2:3], v12 offset:9216
  buffer_load_dwordx4 v129, s[8:11], s36 offen offset:1024 lds
  v_mfma_f32_32x32x16_bf16 v[112:127], a[12:15], a[36:39], v[112:127]
  ds_read_b64_tr_b16 a[4:5], v13 offset:8192
  ds_read_b64_tr_b16 a[6:7], v13 offset:9216
  s_waitcnt lgkmcnt(9)
  v_mfma_f32_32x32x16_bf16 v[64:79], a[16:19], a[40:43], v[64:79]
  ds_read_b64_tr_b16 a[8:9], v14 offset:8192
  ds_read_b64_tr_b16 a[10:11], v14 offset:9216
  buffer_load_dwordx4 v130, s[8:11], s36 offen offset:2048 lds
  v_mfma_f32_32x32x16_bf16 v[80:95], a[20:23], a[40:43], v[80:95]
  ds_read_b64_tr_b16 a[12:13], v15 offset:8192
  ds_read_b64_tr_b16 a[14:15], v15 offset:9216
  s_waitcnt lgkmcnt(9)
  v_mfma_f32_32x32x16_bf16 v[96:111], a[24:27], a[40:43], v[96:111]
  ds_read_b128 a[36:39], v19
  ds_read_b64_tr_b16 a[16:17], v12 offset:12288
  ds_read_b64_tr_b16 a[18:19], v12 offset:13312
  buffer_load_dwordx4 v131, s[8:11], s36 offen offset:3072 lds
  v_mfma_f32_32x32x16_bf16 v[112:127], a[28:31], a[40:43], v[112:127]
  ds_read_b64_tr_b16 a[20:21], v13 offset:12288
  ds_read_b64_tr_b16 a[22:23], v13 offset:13312
  s_waitcnt lgkmcnt(9)
  v_mfma_f32_32x32x16_bf16 v[64:79], a[0:3], a[32:35], v[64:79]
  ds_read_b64_tr_b16 a[24:25], v14 offset:12288
  ds_read_b64_tr_b16 a[26:27], v14 offset:13312
  s_add_u32 m0, s28, 49152
  s_nop 0
  buffer_load_dwordx4 v132, s[12:15], s37 offen offset:0 lds
  v_mfma_f32_32x32x16_bf16 v[80:95], a[4:7], a[32:35], v[80:95]
  ds_read_b64_tr_b16 a[28:29], v15 offset:12288
  ds_read_b64_tr_b16 a[30:31], v15 offset:13312
  s_waitcnt lgkmcnt(9)
  v_mfma_f32_32x32x16_bf16 v[96:111], a[8:11], a[32:35], v[96:111]
  s_waitcnt vmcnt(5)
  s_barrier
  v_add_u32 v12, 131072, v8
  v_add_u32 v16, 32768, v7
  v_xor_b32 v13, 64, v12
  v_xor_b32 v17, 32, v16
  v_xor_b32 v14, 128, v12
  v_xor_b32 v18, 64, v16
  v_xor_b32 v15, 192, v12
  v_xor_b32 v19, 96, v16
  ds_read_b128 a[40:43], v16
  ds_read_b64_tr_b16 a[0:1], v12 offset:0
  ds_read_b64_tr_b16 a[2:3], v12 offset:1024
  buffer_load_dwordx4 v133, s[12:15], s37 offen offset:1024 lds
  v_mfma_f32_32x32x16_bf16 v[112:127], a[12:15], a[32:35], v[112:127]
  ds_read_b64_tr_b16 a[4:5], v13 offset:0
  ds_read_b64_tr_b16 a[6:7], v13 offset:1024
  s_waitcnt lgkmcnt(9)
  v_mfma_f32_32x32x16_bf16 v[64:79], a[16:19], a[36:39], v[64:79]
  ds_read_b64_tr_b16 a[8:9], v14 offset:0
  ds_read_b64_tr_b16 a[10:11], v14 offset:1024
  buffer_load_dwordx4 v134, s[12:15], s37 offen offset:2048 lds
  v_mfma_f32_32x32x16_bf16 v[80:95], a[20:23], a[36:39], v[80:95]
  ds_read_b64_tr_b16 a[12:13], v15 offset:0
  ds_read_b64_tr_b16 a[14:15], v15 offset:1024
  s_waitcnt lgkmcnt(9)
  v_mfma_f32_32x32x16_bf16 v[96:111], a[24:27], a[36:39], v[96:111]
  ds_read_b128 a[32:35], v17
  ds_read_b64_tr_b16 a[16:17], v12 offset:4096
  ds_read_b64_tr_b16 a[18:19], v12 offset:5120
  buffer_load_dwordx4 v135, s[12:15], s37 offen offset:3072 lds
  v_mfma_f32_32x32x16_bf16 v[112:127], a[28:31], a[36:39], v[112:127]
  ds_read_b64_tr_b16 a[20:21], v13 offset:4096
  ds_read_b64_tr_b16 a[22:23], v13 offset:5120
  s_waitcnt lgkmcnt(9)
  v_mfma_f32_32x32x16_bf16 v[64:79], a[0:3], a[40:43], v[64:79]
  ds_read_b64_tr_b16 a[24:25], v14 offset:4096
  ds_read_b64_tr_b16 a[26:27], v14 offset:5120
  v_mfma_f32_32x32x16_bf16 v[80:95], a[4:7], a[40:43], v[80:95]
  ds_read_b64_tr_b16 a[28:29], v15 offset:4096
  ds_read_b64_tr_b16 a[30:31], v15 offset:5120
  s_add_u32 m0, s28, 147456
  s_mov_b32 s31, 0
  buffer_load_dwordx4 v2, s[16:19], s31 offen offset:0 nt lds
  s_waitcnt lgkmcnt(9)
  v_mfma_f32_32x32x16_bf16 v[96:111], a[8:11], a[40:43], v[96:111]
  ds_read_b128 a[36:39], v18
  ds_read_b64_tr_b16 a[0:1], v12 offset:8192
  ds_read_b64_tr_b16 a[2:3], v12 offset:9216
  v_mfma_f32_32x32x16_bf16 v[112:127], a[12:15], a[40:43], v[112:127]
  ds_read_b64_tr_b16 a[4:5], v13 offset:8192
  ds_read_b64_tr_b16 a[6:7], v13 offset:9216
  s_add_u32 m0, s28, 147456
  s_nop 0
  buffer_load_dwordx4 v3, s[16:19], s31 offen offset:1024 nt lds
  s_waitcnt lgkmcnt(9)
  v_mfma_f32_32x32x16_bf16 v[64:79], a[16:19], a[32:35], v[64:79]
  ds_read_b64_tr_b16 a[8:9], v14 offset:8192
  ds_read_b64_tr_b16 a[10:11], v14 offset:9216
  v_mfma_f32_32x32x16_bf16 v[80:95], a[20:23], a[32:35], v[80:95]
  ds_read_b64_tr_b16 a[12:13], v15 offset:8192
  ds_read_b64_tr_b16 a[14:15], v15 offset:9216
  s_add_u32 m0, s28, 147456
  s_nop 0
  buffer_load_dwordx4 v4, s[16:19], s31 offen offset:2048 nt lds
  s_waitcnt lgkmcnt(9)
  v_mfma_f32_32x32x16_bf16 v[96:111], a[24:27], a[32:35], v[96:111]
  ds_read_b128 a[40:43], v19
  ds_read_b64_tr_b16 a[16:17], v12 offset:12288
  ds_read_b64_tr_b16 a[18:19], v12 offset:13312
  v_mfma_f32_32x32x16_bf16 v[112:127], a[28:31], a[32:35], v[112:127]
  ds_read_b64_tr_b16 a[20:21], v13 offset:12288
  ds_read_b64_tr_b16 a[22:23], v13 offset:13312
  s_add_u32 m0, s28, 147456
  s_nop 0
  buffer_load_dwordx4 v5, s[16:19], s31 offen offset:3072 nt lds
  s_waitcnt lgkmcnt(9)
  v_mfma_f32_32x32x16_bf16 v[64:79], a[0:3], a[36:39], v[64:79]
  ds_read_b64_tr_b16 a[24:25], v14 offset:12288
  ds_read_b64_tr_b16 a[26:27], v14 offset:13312
  v_mfma_f32_32x32x16_bf16 v[80:95], a[4:7], a[36:39], v[80:95]
  ds_read_b64_tr_b16 a[28:29], v15 offset:12288
  ds_read_b64_tr_b16 a[30:31], v15 offset:13312
  s_add_u32 m0, s28, 81920
  s_mov_b32 s31, 16384
  buffer_load_dwordx4 v2, s[16:19], s31 offen offset:0 nt lds
  s_waitcnt lgkmcnt(9)
  v_mfma_f32_32x32x16_bf16 v[96:111], a[8:11], a[36:39], v[96:111]
  s_waitcnt vmcnt(5)
  s_barrier
  v_add_u32 v11, 1, v11
  v_cmp_eq_u32 vcc, 0, v11
  s_mov_b32 s100, 262144
  s_nop 0
  v_cndmask_b32 v11, v11, 1, vcc
  buffer_store_dword v11, v30, s[84:87], 0 offen sc1
  buffer_store_dword v11, v30, s[88:91], s100 offen sc1
  v_add_u32 v12, 49152, v8
  v_add_u32 v16, 0, v7
  v_xor_b32 v13, 64, v12
  v_xor_b32 v17, 32, v16
  v_xor_b32 v14, 128, v12
  v_xor_b32 v18, 64, v16
  v_xor_b32 v15, 192, v12
  v_xor_b32 v19, 96, v16
  ds_read_b128 a[32:35], v16
  ds_read_b64_tr_b16 a[0:1], v12 offset:0
  ds_read_b64_tr_b16 a[2:3], v12 offset:1024
  v_mfma_f32_32x32x16_bf16 v[112:127], a[12:15], a[36:39], v[112:127]
  ds_read_b64_tr_b16 a[4:5], v13 offset:0
  ds_read_b64_tr_b16 a[6:7], v13 offset:1024
  s_add_u32 m0, s28, 81920
  s_nop 0
  buffer_load_dwordx4 v3, s[16:19], s31 offen offset:1024 nt lds
  s_waitcnt lgkmcnt(9)
  v_mfma_f32_32x32x16_bf16 v[64:79], a[16:19], a[40:43], v[64:79]
  ds_read_b64_tr_b16 a[8:9], v14 offset:0
  ds_read_b64_tr_b16 a[10:11], v14 offset:1024
  v_mfma_f32_32x32x16_bf16 v[80:95], a[20:23], a[40:43], v[80:95]
  ds_read_b64_tr_b16 a[12:13], v15 offset:0
  ds_read_b64_tr_b16 a[14:15], v15 offset:1024
  s_add_u32 m0, s28, 81920
  s_nop 0
  buffer_load_dwordx4 v4, s[16:19], s31 offen offset:2048 nt lds
  s_waitcnt lgkmcnt(9)
  v_mfma_f32_32x32x16_bf16 v[96:111], a[24:27], a[40:43], v[96:111]
  ds_read_b128 a[36:39], v17
  ds_read_b64_tr_b16 a[16:17], v12 offset:4096
  ds_read_b64_tr_b16 a[18:19], v12 offset:5120
  v_mfma_f32_32x32x16_bf16 v[112:127], a[28:31], a[40:43], v[112:127]
  ds_read_b64_tr_b16 a[20:21], v13 offset:4096
  ds_read_b64_tr_b16 a[22:23], v13 offset:5120
  s_add_u32 m0, s28, 81920
  s_nop 0
  buffer_load_dwordx4 v5, s[16:19], s31 offen offset:3072 nt lds
  s_waitcnt lgkmcnt(9)
  v_mfma_f32_32x32x16_bf16 v[64:79], a[0:3], a[32:35], v[64:79]
  ds_read_b64_tr_b16 a[24:25], v14 offset:4096
  ds_read_b64_tr_b16 a[26:27], v14 offset:5120
  v_mfma_f32_32x32x16_bf16 v[80:95], a[4:7], a[32:35], v[80:95]
  ds_read_b64_tr_b16 a[28:29], v15 offset:4096
  ds_read_b64_tr_b16 a[30:31], v15 offset:5120
  s_add_u32 m0, s28, 98304
  s_mov_b32 s31, 32768
  buffer_load_dwordx4 v2, s[16:19], s31 offen offset:0 nt lds
  s_waitcnt lgkmcnt(9)
  v_mfma_f32_32x32x16_bf16 v[96:111], a[8:11], a[32:35], v[96:111]
  ds_read_b128 a[40:43], v18
  ds_read_b64_tr_b16 a[0:1], v12 offset:8192
  ds_read_b64_tr_b16 a[2:3], v12 offset:9216
  v_mfma_f32_32x32x16_bf16 v[112:127], a[12:15], a[32:35], v[112:127]
  ds_read_b64_tr_b16 a[4:5], v13 offset:8192
  ds_read_b64_tr_b16 a[6:7], v13 offset:9216
  s_add_u32 m0, s28, 98304
  s_nop 0
  buffer_load_dwordx4 v3, s[16:19], s31 offen offset:1024 nt lds
  s_waitcnt lgkmcnt(9)
  v_mfma_f32_32x32x16_bf16 v[64:79], a[16:19], a[36:39], v[64:79]
  ds_read_b64_tr_b16 a[8:9], v14 offset:8192
  ds_read_b64_tr_b16 a[10:11], v14 offset:9216
  v_mfma_f32_32x32x16_bf16 v[80:95], a[20:23], a[36:39], v[80:95]
  ds_read_b64_tr_b16 a[12:13], v15 offset:8192
  ds_read_b64_tr_b16 a[14:15], v15 offset:9216
  s_add_u32 m0, s28, 98304
  s_nop 0
  buffer_load_dwordx4 v4, s[16:19], s31 offen offset:2048 nt lds
  s_waitcnt lgkmcnt(9)
  v_mfma_f32_32x32x16_bf16 v[96:111], a[24:27], a[36:39], v[96:111]
  ds_read_b128 a[32:35], v19
  ds_read_b64_tr_b16 a[16:17], v12 offset:12288
  ds_read_b64_tr_b16 a[18:19], v12 offset:13312
  v_mfma_f32_32x32x16_bf16 v[112:127], a[28:31], a[36:39], v[112:127]
  ds_read_b64_tr_b16 a[20:21], v13 offset:12288
  ds_read_b64_tr_b16 a[22:23], v13 offset:13312
  s_add_u32 m0, s28, 98304
  s_nop 0
  buffer_load_dwordx4 v5, s[16:19], s31 offen offset:3072 nt lds
  s_waitcnt lgkmcnt(9)
  v_mfma_f32_32x32x16_bf16 v[64:79], a[0:3], a[40:43], v[64:79]
  ds_read_b64_tr_b16 a[24:25], v14 offset:12288
  ds_read_b64_tr_b16 a[26:27], v14 offset:13312
  v_mfma_f32_32x32x16_bf16 v[80:95], a[4:7], a[40:43], v[80:95]
  ds_read_b64_tr_b16 a[28:29], v15 offset:12288
  ds_read_b64_tr_b16 a[30:31], v15 offset:13312
  s_add_u32 m0, s28, 114688
  s_mov_b32 s31, 49152
  buffer_load_dwordx4 v2, s[16:19], s31 offen offset:0 nt lds
  s_waitcnt lgkmcnt(9)
  v_mfma_f32_32x32x16_bf16 v[96:111], a[8:11], a[40:43], v[96:111]
  v_mfma_f32_32x32x16_bf16 v[112:127], a[12:15], a[40:43], v[112:127]
  s_add_u32 m0, s28, 114688
  s_nop 0
  buffer_load_dwordx4 v3, s[16:19], s31 offen offset:1024 nt lds
  s_waitcnt lgkmcnt(4)
  v_mfma_f32_32x32x16_bf16 v[64:79], a[16:19], a[32:35], v[64:79]
  v_mfma_f32_32x32x16_bf16 v[80:95], a[20:23], a[32:35], v[80:95]
  s_add_u32 m0, s28, 114688
  s_nop 0
  buffer_load_dwordx4 v4, s[16:19], s31 offen offset:2048 nt lds
  s_waitcnt lgkmcnt(0)
  v_mfma_f32_32x32x16_bf16 v[96:111], a[24:27], a[32:35], v[96:111]
  v_mfma_f32_32x32x16_bf16 v[112:127], a[28:31], a[32:35], v[112:127]
  s_add_u32 m0, s28, 114688
  s_nop 0
  buffer_load_dwordx4 v5, s[16:19], s31 offen offset:3072 nt lds
  s_waitcnt vmcnt(14)
  s_barrier
  v_add_u32 v12, 147456, v9
  v_xor_b32 v13, 32, v12
  v_xor_b32 v14, 64, v12
  v_xor_b32 v15, 96, v12
  v_xor_b32 v16, 128, v12
  v_xor_b32 v17, 160, v12
  v_xor_b32 v18, 192, v12
  v_xor_b32 v19, 224, v12
  ds_read_b128 a[0:3], v12 offset:0
  ds_read_b128 a[4:7], v13 offset:0
  ds_read_b128 a[8:11], v14 offset:0
  ds_read_b128 a[12:15], v15 offset:0
  ds_read_b128 a[16:19], v16 offset:0
  ds_read_b128 a[20:23], v17 offset:0
  v_mov_b32 v26, s32
  v_accvgpr_read_b32 v7, a64
  s_mov_b32 s61, 0
  v_mov_b32 v25, 0x3f803f80
  v_accvgpr_write_b32 a116, v25
  v_accvgpr_write_b32 a117, v25
  v_accvgpr_write_b32 a118, v25
  v_accvgpr_write_b32 a119, v25
  v_pk_mul_f32 v[64:65], v[64:65], v[26:27] op_sel_hi:[1,0]
  v_pk_mul_f32 v[66:67], v[66:67], v[26:27] op_sel_hi:[1,0]
  v_pk_mul_f32 v[68:69], v[68:69], v[26:27] op_sel_hi:[1,0]
  v_pk_mul_f32 v[70:71], v[70:71], v[26:27] op_sel_hi:[1,0]
  v_pk_mul_f32 v[72:73], v[72:73], v[26:27] op_sel_hi:[1,0]
  v_pk_mul_f32 v[74:75], v[74:75], v[26:27] op_sel_hi:[1,0]
  v_pk_mul_f32 v[76:77], v[76:77], v[26:27] op_sel_hi:[1,0]
  v_pk_mul_f32 v[78:79], v[78:79], v[26:27] op_sel_hi:[1,0]
  v_cvt_pk_bf16_f32 v64, v64, v65
  v_cvt_pk_bf16_f32 v65, v66, v67
  v_cvt_pk_bf16_f32 v66, v68, v69
  v_cvt_pk_bf16_f32 v67, v70, v71
  v_cvt_pk_bf16_f32 v68, v72, v73
  v_cvt_pk_bf16_f32 v69, v74, v75
  v_cvt_pk_bf16_f32 v70, v76, v77
  v_cvt_pk_bf16_f32 v71, v78, v79
  v_accvgpr_write_b32 a32, v64
  v_accvgpr_write_b32 a33, v65
  v_accvgpr_write_b32 a34, v66
  v_accvgpr_write_b32 a35, v67
  v_accvgpr_write_b32 a36, v68
  v_accvgpr_write_b32 a37, v69
  v_accvgpr_write_b32 a38, v70
  v_accvgpr_write_b32 a39, v71
  v_pk_mul_f32 v[80:81], v[80:81], v[26:27] op_sel_hi:[1,0]
  v_pk_mul_f32 v[82:83], v[82:83], v[26:27] op_sel_hi:[1,0]
  v_pk_mul_f32 v[84:85], v[84:85], v[26:27] op_sel_hi:[1,0]
  v_pk_mul_f32 v[86:87], v[86:87], v[26:27] op_sel_hi:[1,0]
  v_pk_mul_f32 v[88:89], v[88:89], v[26:27] op_sel_hi:[1,0]
  v_pk_mul_f32 v[90:91], v[90:91], v[26:27] op_sel_hi:[1,0]
  v_pk_mul_f32 v[92:93], v[92:93], v[26:27] op_sel_hi:[1,0]
  v_pk_mul_f32 v[94:95], v[94:95], v[26:27] op_sel_hi:[1,0]
  v_cvt_pk_bf16_f32 v80, v80, v81
  v_cvt_pk_bf16_f32 v81, v82, v83
  v_cvt_pk_bf16_f32 v82, v84, v85
  v_cvt_pk_bf16_f32 v83, v86, v87
  v_cvt_pk_bf16_f32 v84, v88, v89
  v_cvt_pk_bf16_f32 v85, v90, v91
  v_cvt_pk_bf16_f32 v86, v92, v93
  v_cvt_pk_bf16_f32 v87, v94, v95
  v_accvgpr_write_b32 a40, v80
  v_accvgpr_write_b32 a41, v81
  v_accvgpr_write_b32 a42, v82
  v_accvgpr_write_b32 a43, v83
  v_accvgpr_write_b32 a44, v84
  v_accvgpr_write_b32 a45, v85
  v_accvgpr_write_b32 a46, v86
  v_accvgpr_write_b32 a47, v87
  s_waitcnt lgkmcnt(4)
  v_mfma_f32_32x32x16_bf16 v[128:143], a[0:3], a[32:35], 0
  ds_read_b128 a[24:27], v18 offset:0
  v_mul_f32 v96, v96, v26
  v_mul_f32 v97, v97, v26
  v_mul_f32 v98, v98, v26
  v_mul_f32 v99, v99, v26
  v_mul_f32 v100, v100, v26
  v_mul_f32 v101, v101, v26
  v_mul_f32 v102, v102, v26
  v_mul_f32 v103, v103, v26
  v_mul_f32 v104, v104, v26
  v_mul_f32 v105, v105, v26
  v_mul_f32 v106, v106, v26
  v_mfma_f32_32x32x16_bf16 v[128:143], a[4:7], a[36:39], v[128:143]
  ds_read_b128 a[28:31], v19 offset:0
  v_mul_f32 v107, v107, v26
  v_mul_f32 v108, v108, v26
  v_mul_f32 v109, v109, v26
  v_mul_f32 v110, v110, v26
  v_mul_f32 v111, v111, v26
  v_cvt_pk_bf16_f32 v96, v96, v97
  v_cvt_pk_bf16_f32 v97, v98, v99
  v_cvt_pk_bf16_f32 v98, v100, v101
  v_cvt_pk_bf16_f32 v99, v102, v103
  v_cvt_pk_bf16_f32 v100, v104, v105
  v_cvt_pk_bf16_f32 v101, v106, v107
  s_waitcnt lgkmcnt(4)
  v_mfma_f32_32x32x16_bf16 v[128:143], a[8:11], a[40:43], v[128:143]
  ds_read_b128 a[0:3], v12 offset:8192
  v_cvt_pk_bf16_f32 v102, v108, v109
  v_cvt_pk_bf16_f32 v103, v110, v111
  v_accvgpr_write_b32 a48, v96
  v_accvgpr_write_b32 a49, v97
  v_accvgpr_write_b32 a50, v98
  v_accvgpr_write_b32 a51, v99
  v_accvgpr_write_b32 a52, v100
  v_accvgpr_write_b32 a53, v101
  v_accvgpr_write_b32 a54, v102
  v_accvgpr_write_b32 a55, v103
  v_mul_f32 v112, v112, v26
  v_mfma_f32_32x32x16_bf16 v[128:143], a[12:15], a[44:47], v[128:143]
  ds_read_b128 a[4:7], v13 offset:8192
  v_mul_f32 v113, v113, v26
  v_mul_f32 v114, v114, v26
  v_mul_f32 v115, v115, v26
  v_mul_f32 v116, v116, v26
  v_mul_f32 v117, v117, v26
  v_mul_f32 v118, v118, v26
  v_mul_f32 v119, v119, v26
  v_mul_f32 v120, v120, v26
  v_mul_f32 v121, v121, v26
  v_mul_f32 v122, v122, v26
  v_mul_f32 v123, v123, v26
  s_waitcnt lgkmcnt(4)
  v_mfma_f32_32x32x16_bf16 v[128:143], a[16:19], a[48:51], v[128:143]
  ds_read_b128 a[8:11], v14 offset:8192
  v_mul_f32 v124, v124, v26
  v_mul_f32 v125, v125, v26
  v_mul_f32 v126, v126, v26
  v_mul_f32 v127, v127, v26
  v_cvt_pk_bf16_f32 v112, v112, v113
  v_cvt_pk_bf16_f32 v113, v114, v115
  v_cvt_pk_bf16_f32 v114, v116, v117
  v_cvt_pk_bf16_f32 v115, v118, v119
  v_cvt_pk_bf16_f32 v116, v120, v121
  v_cvt_pk_bf16_f32 v117, v122, v123
  v_cvt_pk_bf16_f32 v118, v124, v125
  v_mfma_f32_32x32x16_bf16 v[128:143], a[20:23], a[52:55], v[128:143]
  ds_read_b128 a[12:15], v15 offset:8192
  v_cvt_pk_bf16_f32 v119, v126, v127
  v_accvgpr_write_b32 a56, v112
  v_accvgpr_write_b32 a57, v113
  v_accvgpr_write_b32 a58, v114
  v_accvgpr_write_b32 a59, v115
  v_accvgpr_write_b32 a60, v116
  v_accvgpr_write_b32 a61, v117
  v_accvgpr_write_b32 a62, v118
  v_accvgpr_write_b32 a63, v119
  s_waitcnt lgkmcnt(4)
  v_mfma_f32_32x32x16_bf16 v[128:143], a[24:27], a[56:59], v[128:143]
  ds_read_b128 a[16:19], v16 offset:8192
  v_mfma_f32_32x32x16_bf16 v[128:143], a[28:31], a[60:63], v[128:143]
  ds_read_b128 a[20:23], v17 offset:8192
  s_waitcnt lgkmcnt(4)
  v_mfma_f32_32x32x16_bf16 v[144:159], a[0:3], a[32:35], 0
  ds_read_b128 a[24:27], v18 offset:8192
  v_add_u32 v52, 81920, v8
  v_xor_b32 v53, 64, v52
  v_mfma_f32_32x32x16_bf16 v[144:159], a[4:7], a[36:39], v[144:159]
  ds_read_b128 a[28:31], v19 offset:8192
  v_xor_b32 v54, 128, v52
  v_xor_b32 v55, 192, v52
  s_waitcnt lgkmcnt(4)
  v_mfma_f32_32x32x16_bf16 v[144:159], a[8:11], a[40:43], v[144:159]
  s_waitcnt vmcnt(8)
  s_barrier
  v_xor_b32 v12, 196608, v12
  v_xor_b32 v13, 196608, v13
  v_xor_b32 v14, 196608, v14
  v_xor_b32 v15, 196608, v15
  v_xor_b32 v16, 196608, v16
  v_xor_b32 v17, 196608, v17
  v_xor_b32 v18, 196608, v18
  v_xor_b32 v19, 196608, v19
  ds_read_b128 a[0:3], v12 offset:0
  v_add_u32 v56, 65536, v52
  v_add_u32 v57, 65536, v53
  v_mfma_f32_32x32x16_bf16 v[144:159], a[12:15], a[44:47], v[144:159]
  ds_read_b128 a[4:7], v13 offset:0
  v_add_u32 v58, 65536, v54
  v_add_u32 v59, 65536, v55
  s_waitcnt lgkmcnt(4)
  v_mfma_f32_32x32x16_bf16 v[144:159], a[16:19], a[48:51], v[144:159]
  ds_read_b128 a[8:11], v14 offset:0
  v_max_f32 v20, v128, v129
  v_max3_f32 v20, v20, v130, v131
  v_mfma_f32_32x32x16_bf16 v[144:159], a[20:23], a[52:55], v[144:159]
  ds_read_b128 a[12:15], v15 offset:0
  v_max3_f32 v20, v20, v132, v133
  v_max3_f32 v20, v20, v134, v135
  s_waitcnt lgkmcnt(4)
  v_mfma_f32_32x32x16_bf16 v[144:159], a[24:27], a[56:59], v[144:159]
  ds_read_b128 a[16:19], v16 offset:0
  v_max3_f32 v20, v20, v136, v137
  v_max3_f32 v20, v20, v138, v139
  v_mfma_f32_32x32x16_bf16 v[144:159], a[28:31], a[60:63], v[144:159]
  ds_read_b128 a[20:23], v17 offset:0
  v_max3_f32 v20, v20, v140, v141
  v_max3_f32 v20, v20, v142, v143
  s_waitcnt lgkmcnt(4)
  v_mfma_f32_32x32x16_bf16 v[160:175], a[0:3], a[32:35], 0
  ds_read_b128 a[24:27], v18 offset:0
  v_mfma_f32_32x32x16_bf16 v[160:175], a[4:7], a[36:39], v[160:175]
  ds_read_b128 a[28:31], v19 offset:0
  s_add_u32 m0, s28, 131072
  s_mov_b32 s31, 0
  buffer_load_dwordx4 v6, s[20:23], s31 offen offset:0 nt lds
  s_waitcnt lgkmcnt(4)
  v_mfma_f32_32x32x16_bf16 v[160:175], a[8:11], a[40:43], v[160:175]
  ds_read_b128 a[0:3], v12 offset:8192
  v_mfma_f32_32x32x16_bf16 v[160:175], a[12:15], a[44:47], v[160:175]
  ds_read_b128 a[4:7], v13 offset:8192
  s_add_u32 m0, s28, 131072
  s_nop 0
  buffer_load_dwordx4 v6, s[20:23], s31 offen offset:1024 nt lds
  s_waitcnt lgkmcnt(4)
  v_mfma_f32_32x32x16_bf16 v[160:175], a[16:19], a[48:51], v[160:175]
  ds_read_b128 a[8:11], v14 offset:8192
  v_max3_f32 v20, v20, v144, v145
  v_max3_f32 v20, v20, v146, v147
  v_mfma_f32_32x32x16_bf16 v[160:175], a[20:23], a[52:55], v[160:175]
  ds_read_b128 a[12:15], v15 offset:8192
  s_add_u32 m0, s28, 131072
  s_nop 0
  buffer_load_dwordx4 v6, s[20:23], s31 offen offset:2048 nt lds
  v_max3_f32 v20, v20, v148, v149
  v_max3_f32 v20, v20, v150, v151
  s_waitcnt lgkmcnt(4)
  v_mfma_f32_32x32x16_bf16 v[160:175], a[24:27], a[56:59], v[160:175]
  ds_read_b128 a[16:19], v16 offset:8192
  v_max3_f32 v20, v20, v152, v153
  v_max3_f32 v20, v20, v154, v155
  v_mfma_f32_32x32x16_bf16 v[160:175], a[28:31], a[60:63], v[160:175]
  ds_read_b128 a[20:23], v17 offset:8192
  s_add_u32 m0, s28, 131072
  s_nop 0
  buffer_load_dwordx4 v6, s[20:23], s31 offen offset:3072 nt lds
  v_max3_f32 v20, v20, v156, v157
  v_max3_f32 v20, v20, v158, v159
  s_waitcnt lgkmcnt(4)
  v_mfma_f32_32x32x16_bf16 v[176:191], a[0:3], a[32:35], 0
  ds_read_b128 a[24:27], v18 offset:8192
  v_mfma_f32_32x32x16_bf16 v[176:191], a[4:7], a[36:39], v[176:191]
  ds_read_b128 a[28:31], v19 offset:8192
  s_and_b32 s100, s2, 1
  s_cmp_eq_u32 s100, 0
  s_cselect_b32 s29, 0, 2
  s_lshl_b32 s29, s29, 12
  buffer_load_dwordx4 a[252:255], v10, s[24:27], s29 offen offset:0
  s_waitcnt lgkmcnt(4)
  v_mfma_f32_32x32x16_bf16 v[176:191], a[8:11], a[40:43], v[176:191]
  s_waitcnt vmcnt(9)
  s_barrier
  ds_read_b128 a[0:3], v12 offset:16384
  v_mfma_f32_32x32x16_bf16 v[176:191], a[12:15], a[44:47], v[176:191]
  ds_read_b128 a[4:7], v13 offset:16384
  buffer_load_dwordx4 a[252:255], v10, s[24:27], s29 offen offset:1024
  s_waitcnt lgkmcnt(4)
  v_mfma_f32_32x32x16_bf16 v[176:191], a[16:19], a[48:51], v[176:191]
  ds_read_b128 a[8:11], v14 offset:16384
  v_max3_f32 v20, v20, v160, v161
  v_max3_f32 v20, v20, v162, v163
  v_mfma_f32_32x32x16_bf16 v[176:191], a[20:23], a[52:55], v[176:191]
  ds_read_b128 a[12:15], v15 offset:16384
  buffer_load_dwordx4 a[252:255], v10, s[24:27], s29 offen offset:2048
  v_max3_f32 v20, v20, v164, v165
  v_max3_f32 v20, v20, v166, v167
  s_waitcnt lgkmcnt(4)
  v_mfma_f32_32x32x16_bf16 v[176:191], a[24:27], a[56:59], v[176:191]
  ds_read_b128 a[16:19], v16 offset:16384
  v_max3_f32 v20, v20, v168, v169
  v_max3_f32 v20, v20, v170, v171
  v_mfma_f32_32x32x16_bf16 v[176:191], a[28:31], a[60:63], v[176:191]
  ds_read_b128 a[20:23], v17 offset:16384
  v_max3_f32 v20, v20, v172, v173
  v_max3_f32 v20, v20, v174, v175
  s_nop 8
  v_max3_f32 v20, v20, v176, v177
  v_max3_f32 v20, v20, v178, v179
  v_max3_f32 v20, v20, v180, v181
  v_max3_f32 v20, v20, v182, v183
  v_max3_f32 v20, v20, v184, v185
  v_max3_f32 v20, v20, v186, v187
  v_max3_f32 v20, v20, v188, v189
  v_max3_f32 v20, v20, v190, v191
  v_mov_b32 v25, v20
  s_nop 1
  v_permlane32_swap_b32 v25, v20
  v_max_f32 v20, v25, v20
  v_sub_f32 v32, 0, v20
  v_sub_f32 v33, 0, v20
  v_sub_f32 v34, 0, v20
  v_sub_f32 v35, 0, v20
  v_sub_f32 v36, 0, v20
  v_sub_f32 v37, 0, v20
  v_sub_f32 v38, 0, v20
  v_sub_f32 v39, 0, v20
  v_sub_f32 v40, 0, v20
  v_sub_f32 v41, 0, v20
  v_sub_f32 v42, 0, v20
  v_sub_f32 v43, 0, v20
  v_sub_f32 v44, 0, v20
  v_sub_f32 v45, 0, v20
  v_sub_f32 v46, 0, v20
  v_sub_f32 v47, 0, v20
  s_waitcnt lgkmcnt(4)
  s_nop 0
  v_mfma_f32_32x32x16_bf16 v[192:207], a[0:3], a[32:35], v[32:47]
  ds_read_b128 a[24:27], v18 offset:16384
  v_add_f32 v128, v128, v32
  v_add_f32 v129, v129, v32
  v_add_f32 v130, v130, v32
  v_add_f32 v131, v131, v32
  v_add_f32 v132, v132, v32
  v_add_f32 v133, v133, v32
  v_add_f32 v134, v134, v32
  v_mfma_f32_32x32x16_bf16 v[192:207], a[4:7], a[36:39], v[192:207]
  ds_read_b128 a[28:31], v19 offset:16384
  s_add_u32 m0, s28, 147456
  s_mov_b32 s31, 16384
  buffer_load_dwordx4 v6, s[20:23], s31 offen offset:0 nt lds
  v_add_f32 v135, v135, v32
  v_exp_f32 v128, v128
  s_waitcnt lgkmcnt(4)
  v_mfma_f32_32x32x16_bf16 v[192:207], a[8:11], a[40:43], v[192:207]
  ds_read_b128 a[0:3], v12 offset:24576
  v_exp_f32 v129, v129
  v_exp_f32 v130, v130
  v_exp_f32 v131, v131
  v_mfma_f32_32x32x16_bf16 v[192:207], a[12:15], a[44:47], v[192:207]
  ds_read_b128 a[4:7], v13 offset:24576
  s_add_u32 m0, s28, 147456
  s_nop 0
  buffer_load_dwordx4 v6, s[20:23], s31 offen offset:1024 nt lds
  v_exp_f32 v132, v132
  v_exp_f32 v133, v133
  s_waitcnt lgkmcnt(4)
  v_mfma_f32_32x32x16_bf16 v[192:207], a[16:19], a[48:51], v[192:207]
  ds_read_b128 a[8:11], v14 offset:24576
  v_exp_f32 v134, v134
  v_exp_f32 v135, v135
  v_cvt_pk_bf16_f32 v128, v128, v129
  v_cvt_pk_bf16_f32 v129, v130, v131
  v_cvt_pk_bf16_f32 v130, v132, v133
  v_mfma_f32_32x32x16_bf16 v[192:207], a[20:23], a[52:55], v[192:207]
  ds_read_b128 a[12:15], v15 offset:24576
  s_add_u32 m0, s28, 147456
  s_nop 0
  buffer_load_dwordx4 v6, s[20:23], s31 offen offset:2048 nt lds
  v_cvt_pk_bf16_f32 v131, v134, v135
  v_add_f32 v136, v136, v32
  v_add_f32 v137, v137, v32
  v_add_f32 v138, v138, v32
  v_add_f32 v139, v139, v32
  s_waitcnt lgkmcnt(4)
  v_mfma_f32_32x32x16_bf16 v[192:207], a[24:27], a[56:59], v[192:207]
  ds_read_b128 a[16:19], v16 offset:24576
  v_add_f32 v140, v140, v32
  v_add_f32 v141, v141, v32
  v_add_f32 v142, v142, v32
  v_add_f32 v143, v143, v32
  v_exp_f32 v136, v136
  v_mfma_f32_32x32x16_bf16 v[192:207], a[28:31], a[60:63], v[192:207]
  ds_read_b128 a[20:23], v17 offset:24576
  s_add_u32 m0, s28, 147456
  s_nop 0
  buffer_load_dwordx4 v6, s[20:23], s31 offen offset:3072 nt lds
  v_exp_f32 v137, v137
  v_exp_f32 v138, v138
  s_waitcnt lgkmcnt(4)
  v_mfma_f32_32x32x16_bf16 v[208:223], a[0:3], a[32:35], v[32:47]
  ds_read_b128 a[24:27], v18 offset:24576
  v_exp_f32 v139, v139
  v_exp_f32 v140, v140
  v_exp_f32 v141, v141
  v_mfma_f32_32x32x16_bf16 v[208:223], a[4:7], a[36:39], v[208:223]
  ds_read_b128 a[28:31], v19 offset:24576
  buffer_load_dwordx4 a[252:255], v10, s[24:27], s29 offen offset:3072
  v_exp_f32 v142, v142
  v_exp_f32 v143, v143
  v_cvt_pk_bf16_f32 v136, v136, v137
  v_cvt_pk_bf16_f32 v137, v138, v139
  s_waitcnt lgkmcnt(4)
  v_mfma_f32_32x32x16_bf16 v[208:223], a[8:11], a[40:43], v[208:223]
  s_waitcnt vmcnt(12)
  s_barrier
  ds_read_b128 a[0:3], v12 offset:32768
  v_cvt_pk_bf16_f32 v138, v140, v141
  v_cvt_pk_bf16_f32 v139, v142, v143
  v_add_f32 v144, v144, v32
  v_add_f32 v145, v145, v32
  v_add_f32 v146, v146, v32
  v_add_f32 v147, v147, v32
  v_add_f32 v148, v148, v32
  v_mfma_f32_32x32x16_bf16 v[208:223], a[12:15], a[44:47], v[208:223]
  ds_read_b128 a[4:7], v13 offset:32768
  s_and_b32 s100, s2, 1
  s_cmp_eq_u32 s100, 0
  s_cselect_b32 s29, 1, 3
  s_lshl_b32 s29, s29, 12
  buffer_load_dwordx4 a[252:255], v10, s[24:27], s29 offen offset:0
  v_add_f32 v149, v149, v32
  v_add_f32 v150, v150, v32
  s_waitcnt lgkmcnt(4)
  v_mfma_f32_32x32x16_bf16 v[208:223], a[16:19], a[48:51], v[208:223]
  ds_read_b128 a[8:11], v14 offset:32768
  v_max_f32 v20, v192, v193
  v_max3_f32 v20, v20, v194, v195
  v_add_f32 v151, v151, v32
  v_exp_f32 v144, v144
  v_exp_f32 v145, v145
  v_mfma_f32_32x32x16_bf16 v[208:223], a[20:23], a[52:55], v[208:223]
  ds_read_b128 a[12:15], v15 offset:32768
  v_max3_f32 v20, v20, v196, v197
  v_max3_f32 v20, v20, v198, v199
  v_exp_f32 v146, v146
  v_exp_f32 v147, v147
  s_waitcnt lgkmcnt(4)
  v_mfma_f32_32x32x16_bf16 v[208:223], a[24:27], a[56:59], v[208:223]
  ds_read_b128 a[16:19], v16 offset:32768
  v_max3_f32 v20, v20, v200, v201
  v_max3_f32 v20, v20, v202, v203
  v_exp_f32 v148, v148
  v_exp_f32 v149, v149
  v_mfma_f32_32x32x16_bf16 v[208:223], a[28:31], a[60:63], v[208:223]
  ds_read_b128 a[20:23], v17 offset:32768
  v_max3_f32 v20, v20, v204, v205
  v_max3_f32 v20, v20, v206, v207
  v_exp_f32 v150, v150
  v_exp_f32 v151, v151
  v_cvt_pk_bf16_f32 v144, v144, v145
  s_waitcnt lgkmcnt(4)
  v_mfma_f32_32x32x16_bf16 v[224:239], a[0:3], a[32:35], v[32:47]
  ds_read_b128 a[24:27], v18 offset:32768
  v_cvt_pk_bf16_f32 v145, v146, v147
  v_cvt_pk_bf16_f32 v146, v148, v149
  v_cvt_pk_bf16_f32 v147, v150, v151
  v_add_f32 v152, v152, v32
  v_add_f32 v153, v153, v32
  v_add_f32 v154, v154, v32
  v_add_f32 v155, v155, v32
  v_mfma_f32_32x32x16_bf16 v[224:239], a[4:7], a[36:39], v[224:239]
  ds_read_b128 a[28:31], v19 offset:32768
  s_add_u32 m0, s28, 81920
  s_mov_b32 s31, 65536
  buffer_load_dwordx4 v2, s[16:19], s31 offen offset:0 nt lds
  v_add_f32 v156, v156, v32
  v_add_f32 v157, v157, v32
  v_add_f32 v158, v158, v32
  v_add_f32 v159, v159, v32
  s_waitcnt lgkmcnt(4)
  v_mfma_f32_32x32x16_bf16 v[224:239], a[8:11], a[40:43], v[224:239]
  ds_read_b128 a[0:3], v12 offset:40960
  v_exp_f32 v152, v152
  v_exp_f32 v153, v153
  v_exp_f32 v154, v154
  v_mfma_f32_32x32x16_bf16 v[224:239], a[12:15], a[44:47], v[224:239]
  ds_read_b128 a[4:7], v13 offset:40960
  s_add_u32 m0, s28, 81920
  s_nop 0
  buffer_load_dwordx4 v3, s[16:19], s31 offen offset:1024 nt lds
  v_exp_f32 v155, v155
  v_exp_f32 v156, v156
  s_waitcnt lgkmcnt(4)
  v_mfma_f32_32x32x16_bf16 v[224:239], a[16:19], a[48:51], v[224:239]
  ds_read_b128 a[8:11], v14 offset:40960
  v_max3_f32 v20, v20, v208, v209
  v_max3_f32 v20, v20, v210, v211
  v_exp_f32 v157, v157
  v_exp_f32 v158, v158
  v_mfma_f32_32x32x16_bf16 v[224:239], a[20:23], a[52:55], v[224:239]
  ds_read_b128 a[12:15], v15 offset:40960
  s_add_u32 m0, s28, 81920
  s_nop 0
  buffer_load_dwordx4 v4, s[16:19], s31 offen offset:2048 nt lds
  v_max3_f32 v20, v20, v212, v213
  v_max3_f32 v20, v20, v214, v215
  v_exp_f32 v159, v159
  v_cvt_pk_bf16_f32 v152, v152, v153
  s_waitcnt lgkmcnt(4)
  v_mfma_f32_32x32x16_bf16 v[224:239], a[24:27], a[56:59], v[224:239]
  ds_read_b128 a[16:19], v16 offset:40960
  v_max3_f32 v20, v20, v216, v217
  v_max3_f32 v20, v20, v218, v219
  v_cvt_pk_bf16_f32 v153, v154, v155
  v_cvt_pk_bf16_f32 v154, v156, v157
  v_cvt_pk_bf16_f32 v155, v158, v159
  v_add_f32 v160, v160, v32
  v_add_f32 v161, v161, v32
  v_mfma_f32_32x32x16_bf16 v[224:239], a[28:31], a[60:63], v[224:239]
  ds_read_b128 a[20:23], v17 offset:40960
  s_add_u32 m0, s28, 81920
  s_nop 0
  buffer_load_dwordx4 v5, s[16:19], s31 offen offset:3072 nt lds
  v_max3_f32 v20, v20, v220, v221
  v_max3_f32 v20, v20, v222, v223
  v_add_f32 v162, v162, v32
  v_add_f32 v163, v163, v32
  v_add_f32 v164, v164, v32
  s_waitcnt lgkmcnt(4)
  v_mfma_f32_32x32x16_bf16 v[240:255], a[0:3], a[32:35], v[32:47]
  ds_read_b128 a[24:27], v18 offset:40960
  v_add_f32 v165, v165, v32
  v_add_f32 v166, v166, v32
  v_add_f32 v167, v167, v32
  v_exp_f32 v160, v160
  v_exp_f32 v161, v161
  v_mfma_f32_32x32x16_bf16 v[240:255], a[4:7], a[36:39], v[240:255]
  ds_read_b128 a[28:31], v19 offset:40960
  buffer_load_dwordx4 a[252:255], v10, s[24:27], s29 offen offset:1024
  v_exp_f32 v162, v162
  v_exp_f32 v163, v163
  v_exp_f32 v164, v164
  s_waitcnt lgkmcnt(4)
  v_mfma_f32_32x32x16_bf16 v[240:255], a[8:11], a[40:43], v[240:255]
  s_waitcnt vmcnt(14)
  s_barrier
  buffer_load_dword v28, off, s[84:87], 0 sc1
  v_exp_f32 v165, v165
  v_exp_f32 v166, v166
  v_exp_f32 v167, v167
  v_cvt_pk_bf16_f32 v160, v160, v161
  v_cvt_pk_bf16_f32 v161, v162, v163
  v_mfma_f32_32x32x16_bf16 v[240:255], a[12:15], a[44:47], v[240:255]
  ds_read_b64_tr_b16 a[0:1], v52 offset:49152
  ds_read_b64_tr_b16 a[2:3], v52 offset:50176
  buffer_load_dwordx4 a[252:255], v10, s[24:27], s29 offen offset:2048
  v_cvt_pk_bf16_f32 v162, v164, v165
  v_cvt_pk_bf16_f32 v163, v166, v167
  v_add_f32 v168, v168, v32
  v_add_f32 v169, v169, v32
  v_add_f32 v170, v170, v32
  s_waitcnt lgkmcnt(4)
  v_mfma_f32_32x32x16_bf16 v[240:255], a[16:19], a[48:51], v[240:255]
  ds_read_b64_tr_b16 a[4:5], v53 offset:49152
  ds_read_b64_tr_b16 a[6:7], v53 offset:50176
  v_max3_f32 v20, v20, v224, v225
  v_max3_f32 v20, v20, v226, v227
  v_add_f32 v171, v171, v32
  v_add_f32 v172, v172, v32
  v_add_f32 v173, v173, v32
  v_add_f32 v174, v174, v32
  v_mfma_f32_32x32x16_bf16 v[240:255], a[20:23], a[52:55], v[240:255]
  ds_read_b64_tr_b16 a[8:9], v54 offset:49152
  ds_read_b64_tr_b16 a[10:11], v54 offset:50176
  buffer_load_dwordx4 a[252:255], v10, s[24:27], s29 offen offset:3072
  v_max3_f32 v20, v20, v228, v229
  v_max3_f32 v20, v20, v230, v231
  v_add_f32 v175, v175, v32
  v_exp_f32 v168, v168
  s_waitcnt lgkmcnt(6)
  v_mfma_f32_32x32x16_bf16 v[240:255], a[24:27], a[56:59], v[240:255]
  ds_read_b64_tr_b16 a[12:13], v55 offset:49152
  ds_read_b64_tr_b16 a[14:15], v55 offset:50176
  v_max3_f32 v20, v20, v232, v233
  v_max3_f32 v20, v20, v234, v235
  v_exp_f32 v169, v169
  v_exp_f32 v170, v170
  v_mfma_f32_32x32x16_bf16 v[240:255], a[28:31], a[60:63], v[240:255]
  v_max3_f32 v20, v20, v236, v237
  v_max3_f32 v20, v20, v238, v239
  v_exp_f32 v171, v171
  v_exp_f32 v172, v172
  v_exp_f32 v173, v173
  v_mfma_f32_32x32x16_bf16 a[120:135], a[116:119], v[128:131], 0
  ds_read_b64_tr_b16 a[16:17], v52 offset:53248
  ds_read_b64_tr_b16 a[18:19], v52 offset:54272
  v_exp_f32 v174, v174
  v_exp_f32 v175, v175
  v_cvt_pk_bf16_f32 v168, v168, v169
  v_cvt_pk_bf16_f32 v169, v170, v171
  s_waitcnt lgkmcnt(6)
  v_mfma_f32_32x32x16_bf16 v[64:79], a[0:3], v[128:131], 0
  ds_read_b64_tr_b16 a[20:21], v53 offset:53248
  ds_read_b64_tr_b16 a[22:23], v53 offset:54272
  v_cvt_pk_bf16_f32 v170, v172, v173
  v_cvt_pk_bf16_f32 v171, v174, v175
  v_add_f32 v176, v176, v32
  v_add_f32 v177, v177, v32
  v_add_f32 v178, v178, v32
  v_add_f32 v179, v179, v32
  v_mfma_f32_32x32x16_bf16 v[80:95], a[4:7], v[128:131], 0
  ds_read_b64_tr_b16 a[24:25], v54 offset:53248
  ds_read_b64_tr_b16 a[26:27], v54 offset:54272
  v_add_f32 v180, v180, v32
  v_add_f32 v181, v181, v32
  v_add_f32 v182, v182, v32
  v_add_f32 v183, v183, v32
  v_exp_f32 v176, v176
  s_waitcnt lgkmcnt(6)
  v_mfma_f32_32x32x16_bf16 v[96:111], a[8:11], v[128:131], 0
  ds_read_b64_tr_b16 a[28:29], v55 offset:53248
  ds_read_b64_tr_b16 a[30:31], v55 offset:54272
  v_max3_f32 v20, v20, v240, v241
  v_max3_f32 v20, v20, v242, v243
  v_exp_f32 v177, v177
  v_exp_f32 v178, v178
  v_mfma_f32_32x32x16_bf16 v[112:127], a[12:15], v[128:131], 0
  v_max3_f32 v20, v20, v244, v245
  v_max3_f32 v20, v20, v246, v247
  v_exp_f32 v179, v179
  v_exp_f32 v180, v180
  v_exp_f32 v181, v181
  v_mfma_f32_32x32x16_bf16 a[120:135], a[116:119], v[136:139], a[120:135]
  ds_read_b64_tr_b16 a[0:1], v52 offset:57344
  ds_read_b64_tr_b16 a[2:3], v52 offset:58368
  v_max3_f32 v20, v20, v248, v249
  v_max3_f32 v20, v20, v250, v251
  v_exp_f32 v182, v182
  v_exp_f32 v183, v183
  s_waitcnt lgkmcnt(6)
  v_mfma_f32_32x32x16_bf16 v[64:79], a[16:19], v[136:139], v[64:79]
  ds_read_b64_tr_b16 a[4:5], v53 offset:57344
  ds_read_b64_tr_b16 a[6:7], v53 offset:58368
  v_max3_f32 v20, v20, v252, v253
  v_max3_f32 v20, v20, v254, v255
  v_cvt_pk_bf16_f32 v176, v176, v177
  v_cvt_pk_bf16_f32 v177, v178, v179
  v_cvt_pk_bf16_f32 v178, v180, v181
  v_cvt_pk_bf16_f32 v179, v182, v183
  v_mfma_f32_32x32x16_bf16 v[80:95], a[20:23], v[136:139], v[80:95]
  ds_read_b64_tr_b16 a[8:9], v54 offset:57344
  ds_read_b64_tr_b16 a[10:11], v54 offset:58368
  v_add_f32 v184, v184, v32
  v_add_f32 v185, v185, v32
  v_add_f32 v186, v186, v32
  v_add_f32 v187, v187, v32
  v_add_f32 v188, v188, v32
  v_add_f32 v189, v189, v32
  s_waitcnt lgkmcnt(6)
  v_mfma_f32_32x32x16_bf16 v[96:111], a[24:27], v[136:139], v[96:111]
  ds_read_b64_tr_b16 a[12:13], v55 offset:57344
  ds_read_b64_tr_b16 a[14:15], v55 offset:58368
  v_add_f32 v190, v190, v32
  v_add_f32 v191, v191, v32
  v_exp_f32 v184, v184
  v_exp_f32 v185, v185
  v_mfma_f32_32x32x16_bf16 v[112:127], a[28:31], v[136:139], v[112:127]
  s_and_b32 s100, s2, 1
  s_cmp_eq_u32 s100, 0
  s_cselect_b32 s29, 2, 4
  s_lshl_b32 s29, s29, 12
  buffer_load_dwordx4 a[252:255], v10, s[24:27], s29 offen offset:0
  v_exp_f32 v186, v186
  v_mfma_f32_32x32x16_bf16 a[120:135], a[116:119], v[144:147], a[120:135]
  ds_read_b64_tr_b16 a[16:17], v52 offset:61440
  ds_read_b64_tr_b16 a[18:19], v52 offset:62464
  v_exp_f32 v187, v187
  v_exp_f32 v188, v188
  v_exp_f32 v189, v189
  s_waitcnt lgkmcnt(6)
  v_mfma_f32_32x32x16_bf16 v[64:79], a[0:3], v[144:147], v[64:79]
  ds_read_b64_tr_b16 a[20:21], v53 offset:61440
  ds_read_b64_tr_b16 a[22:23], v53 offset:62464
  buffer_load_dwordx4 a[252:255], v10, s[24:27], s29 offen offset:1024
  v_exp_f32 v190, v190
  v_exp_f32 v191, v191
  v_cvt_pk_bf16_f32 v184, v184, v185
  v_mfma_f32_32x32x16_bf16 v[80:95], a[4:7], v[144:147], v[80:95]
  ds_read_b64_tr_b16 a[24:25], v54 offset:61440
  ds_read_b64_tr_b16 a[26:27], v54 offset:62464
  v_cvt_pk_bf16_f32 v185, v186, v187
  v_cvt_pk_bf16_f32 v186, v188, v189
  v_cvt_pk_bf16_f32 v187, v190, v191
  s_waitcnt lgkmcnt(6)
  v_mfma_f32_32x32x16_bf16 v[96:111], a[8:11], v[144:147], v[96:111]
  ds_read_b64_tr_b16 a[28:29], v55 offset:61440
  ds_read_b64_tr_b16 a[30:31], v55 offset:62464
  v_cmp_lt_f32 vcc, 1090519040, v20
  s_nop 0
  s_cmp_lg_u64 vcc, 0
  s_cbranch_scc1 L_rr25
L_rb26:
  v_mfma_f32_32x32x16_bf16 v[112:127], a[12:15], v[144:147], v[112:127]
  s_waitcnt vmcnt(12)
  s_barrier
  v_exp_f32 v192, v192
  v_exp_f32 v193, v193
  v_exp_f32 v194, v194
  v_mfma_f32_32x32x16_bf16 a[120:135], a[116:119], v[152:155], a[120:135]
  ds_read_b64_tr_b16 a[0:1], v56 offset:0
  ds_read_b64_tr_b16 a[2:3], v56 offset:1024
  v_exp_f32 v195, v195
  v_exp_f32 v196, v196
  s_waitcnt lgkmcnt(6)
  v_mfma_f32_32x32x16_bf16 v[64:79], a[16:19], v[152:155], v[64:79]
  ds_read_b64_tr_b16 a[4:5], v57 offset:0
  ds_read_b64_tr_b16 a[6:7], v57 offset:1024
  v_exp_f32 v197, v197
  v_exp_f32 v198, v198
  v_mfma_f32_32x32x16_bf16 v[80:95], a[20:23], v[152:155], v[80:95]
  ds_read_b64_tr_b16 a[8:9], v58 offset:0
  ds_read_b64_tr_b16 a[10:11], v58 offset:1024
  s_add_u32 m0, s28, 98304
  s_mov_b32 s31, 81920
  buffer_load_dwordx4 v2, s[16:19], s31 offen offset:0 nt lds
  s_waitcnt lgkmcnt(6)
  v_mfma_f32_32x32x16_bf16 v[96:111], a[24:27], v[152:155], v[96:111]
  ds_read_b64_tr_b16 a[12:13], v59 offset:0
  ds_read_b64_tr_b16 a[14:15], v59 offset:1024
  v_exp_f32 v199, v199
  v_cvt_pk_bf16_f32 v192, v192, v193
  v_cvt_pk_bf16_f32 v193, v194, v195
  v_mfma_f32_32x32x16_bf16 v[112:127], a[28:31], v[152:155], v[112:127]
  s_add_u32 m0, s28, 98304
  s_nop 0
  buffer_load_dwordx4 v3, s[16:19], s31 offen offset:1024 nt lds
  v_cvt_pk_bf16_f32 v194, v196, v197
  v_cvt_pk_bf16_f32 v195, v198, v199
  v_exp_f32 v200, v200
  v_mfma_f32_32x32x16_bf16 a[120:135], a[116:119], v[160:163], a[120:135]
  ds_read_b64_tr_b16 a[16:17], v56 offset:4096
  ds_read_b64_tr_b16 a[18:19], v56 offset:5120
  v_exp_f32 v201, v201
  v_exp_f32 v202, v202
  s_waitcnt lgkmcnt(6)
  v_mfma_f32_32x32x16_bf16 v[64:79], a[0:3], v[160:163], v[64:79]
  ds_read_b64_tr_b16 a[20:21], v57 offset:4096
  ds_read_b64_tr_b16 a[22:23], v57 offset:5120
  s_add_u32 m0, s28, 98304
  s_nop 0
  buffer_load_dwordx4 v4, s[16:19], s31 offen offset:2048 nt lds
  v_exp_f32 v203, v203
  v_mfma_f32_32x32x16_bf16 v[80:95], a[4:7], v[160:163], v[80:95]
  ds_read_b64_tr_b16 a[24:25], v58 offset:4096
  ds_read_b64_tr_b16 a[26:27], v58 offset:5120
  v_exp_f32 v204, v204
  v_exp_f32 v205, v205
  s_waitcnt lgkmcnt(6)
  v_mfma_f32_32x32x16_bf16 v[96:111], a[8:11], v[160:163], v[96:111]
  ds_read_b64_tr_b16 a[28:29], v59 offset:4096
  ds_read_b64_tr_b16 a[30:31], v59 offset:5120
  s_add_u32 m0, s28, 98304
  s_nop 0
  buffer_load_dwordx4 v5, s[16:19], s31 offen offset:3072 nt lds
  v_exp_f32 v206, v206
  v_mfma_f32_32x32x16_bf16 v[112:127], a[12:15], v[160:163], v[112:127]
  v_exp_f32 v207, v207
  v_cvt_pk_bf16_f32 v200, v200, v201
  v_cvt_pk_bf16_f32 v201, v202, v203
  v_cvt_pk_bf16_f32 v202, v204, v205
  v_cvt_pk_bf16_f32 v203, v206, v207
  v_mfma_f32_32x32x16_bf16 a[120:135], a[116:119], v[168:171], a[120:135]
  ds_read_b64_tr_b16 a[0:1], v56 offset:8192
  ds_read_b64_tr_b16 a[2:3], v56 offset:9216
  v_exp_f32 v208, v208
  v_exp_f32 v209, v209
  s_waitcnt lgkmcnt(6)
  v_mfma_f32_32x32x16_bf16 v[64:79], a[16:19], v[168:171], v[64:79]
  ds_read_b64_tr_b16 a[4:5], v57 offset:8192
  ds_read_b64_tr_b16 a[6:7], v57 offset:9216
  v_exp_f32 v210, v210
  v_exp_f32 v211, v211
  v_mfma_f32_32x32x16_bf16 v[80:95], a[20:23], v[168:171], v[80:95]
  ds_read_b64_tr_b16 a[8:9], v58 offset:8192
  ds_read_b64_tr_b16 a[10:11], v58 offset:9216
  v_exp_f32 v212, v212
  v_exp_f32 v213, v213
  s_waitcnt lgkmcnt(6)
  v_mfma_f32_32x32x16_bf16 v[96:111], a[24:27], v[168:171], v[96:111]
  ds_read_b64_tr_b16 a[12:13], v59 offset:8192
  ds_read_b64_tr_b16 a[14:15], v59 offset:9216
  v_exp_f32 v214, v214
  v_exp_f32 v215, v215
  v_mfma_f32_32x32x16_bf16 v[112:127], a[28:31], v[168:171], v[112:127]
  buffer_load_dwordx4 a[252:255], v10, s[24:27], s29 offen offset:2048
  v_cvt_pk_bf16_f32 v208, v208, v209
  v_cvt_pk_bf16_f32 v209, v210, v211
  v_cvt_pk_bf16_f32 v210, v212, v213
  v_cvt_pk_bf16_f32 v211, v214, v215
  v_mfma_f32_32x32x16_bf16 a[120:135], a[116:119], v[176:179], a[120:135]
  ds_read_b64_tr_b16 a[16:17], v56 offset:12288
  ds_read_b64_tr_b16 a[18:19], v56 offset:13312
  v_exp_f32 v216, v216
  v_exp_f32 v217, v217
  s_waitcnt lgkmcnt(6)
  v_mfma_f32_32x32x16_bf16 v[64:79], a[0:3], v[176:179], v[64:79]
  ds_read_b64_tr_b16 a[20:21], v57 offset:12288
  ds_read_b64_tr_b16 a[22:23], v57 offset:13312
  buffer_load_dwordx4 a[252:255], v10, s[24:27], s29 offen offset:3072
  v_exp_f32 v218, v218
  v_mfma_f32_32x32x16_bf16 v[80:95], a[4:7], v[176:179], v[80:95]
  ds_read_b64_tr_b16 a[24:25], v58 offset:12288
  ds_read_b64_tr_b16 a[26:27], v58 offset:13312
  v_exp_f32 v219, v219
  v_exp_f32 v220, v220
  s_waitcnt lgkmcnt(6)
  v_mfma_f32_32x32x16_bf16 v[96:111], a[8:11], v[176:179], v[96:111]
  ds_read_b64_tr_b16 a[28:29], v59 offset:12288
  ds_read_b64_tr_b16 a[30:31], v59 offset:13312
  s_and_b32 s100, s2, 1
  s_cmp_eq_u32 s100, 0
  s_cselect_b32 s29, 3, 0
  s_lshl_b32 s29, s29, 12
  buffer_load_dwordx4 a[252:255], v10, s[24:27], s29 offen offset:0
  v_mfma_f32_32x32x16_bf16 v[112:127], a[12:15], v[176:179], v[112:127]
  s_waitcnt vmcnt(13)
  s_barrier
  ds_read_b128 a[0:3], v12 offset:0
  v_exp_f32 v221, v221
  v_exp_f32 v222, v222
  v_mfma_f32_32x32x16_bf16 a[120:135], a[116:119], v[184:187], a[120:135]
  ds_read_b128 a[4:7], v13 offset:0
  v_exp_f32 v223, v223
  v_cvt_pk_bf16_f32 v216, v216, v217
  v_cvt_pk_bf16_f32 v217, v218, v219
  v_cvt_pk_bf16_f32 v218, v220, v221
  s_waitcnt lgkmcnt(6)
  v_mfma_f32_32x32x16_bf16 v[64:79], a[16:19], v[184:187], v[64:79]
  ds_read_b128 a[8:11], v14 offset:0
  v_cvt_pk_bf16_f32 v219, v222, v223
  v_exp_f32 v224, v224
  v_exp_f32 v225, v225
  v_mfma_f32_32x32x16_bf16 v[80:95], a[20:23], v[184:187], v[80:95]
  ds_read_b128 a[12:15], v15 offset:0
  s_add_u32 m0, s28, 114688
  s_mov_b32 s31, 32768
  buffer_load_dwordx4 v6, s[20:23], s31 offen offset:0 nt lds
  v_exp_f32 v226, v226
  s_waitcnt lgkmcnt(4)
  v_mfma_f32_32x32x16_bf16 v[96:111], a[24:27], v[184:187], v[96:111]
  ds_read_b128 a[16:19], v16 offset:0
  v_exp_f32 v227, v227
  v_exp_f32 v228, v228
  v_mfma_f32_32x32x16_bf16 v[112:127], a[28:31], v[184:187], v[112:127]
  ds_read_b128 a[20:23], v17 offset:0
  s_add_u32 m0, s28, 114688
  s_nop 0
  buffer_load_dwordx4 v6, s[20:23], s31 offen offset:1024 nt lds
  v_exp_f32 v229, v229
  s_waitcnt lgkmcnt(4)
  v_mfma_f32_32x32x16_bf16 v[128:143], a[0:3], a[32:35], v[32:47]
  ds_read_b128 a[24:27], v18 offset:0
  s_cmp_lg_u32 s61, 0
  s_cbranch_scc1 L_rr27
L_rb28:
  v_exp_f32 v230, v230
  v_mfma_f32_32x32x16_bf16 v[128:143], a[4:7], a[36:39], v[128:143]
  ds_read_b128 a[28:31], v19 offset:0
  s_add_u32 m0, s28, 114688
  s_nop 0
  buffer_load_dwordx4 v6, s[20:23], s31 offen offset:2048 nt lds
  v_exp_f32 v231, v231
  v_cvt_pk_bf16_f32 v224, v224, v225
  s_waitcnt lgkmcnt(4)
  v_mfma_f32_32x32x16_bf16 v[128:143], a[8:11], a[40:43], v[128:143]
  ds_read_b128 a[0:3], v12 offset:8192
  v_cvt_pk_bf16_f32 v225, v226, v227
  v_cvt_pk_bf16_f32 v226, v228, v229
  v_cvt_pk_bf16_f32 v227, v230, v231
  v_exp_f32 v232, v232
  v_mfma_f32_32x32x16_bf16 v[128:143], a[12:15], a[44:47], v[128:143]
  ds_read_b128 a[4:7], v13 offset:8192
  s_add_u32 m0, s28, 114688
  s_nop 0
  buffer_load_dwordx4 v6, s[20:23], s31 offen offset:3072 nt lds
  v_exp_f32 v233, v233
  s_waitcnt lgkmcnt(4)
  v_mfma_f32_32x32x16_bf16 v[128:143], a[16:19], a[48:51], v[128:143]
  ds_read_b128 a[8:11], v14 offset:8192
  v_exp_f32 v234, v234
  v_exp_f32 v235, v235
  v_mfma_f32_32x32x16_bf16 v[128:143], a[20:23], a[52:55], v[128:143]
  ds_read_b128 a[12:15], v15 offset:8192
  v_exp_f32 v236, v236
  v_exp_f32 v237, v237
  s_waitcnt lgkmcnt(4)
  v_mfma_f32_32x32x16_bf16 v[128:143], a[24:27], a[56:59], v[128:143]
  ds_read_b128 a[16:19], v16 offset:8192
  v_exp_f32 v238, v238
  v_exp_f32 v239, v239
  v_cvt_pk_bf16_f32 v232, v232, v233
  v_mfma_f32_32x32x16_bf16 v[128:143], a[28:31], a[60:63], v[128:143]
  ds_read_b128 a[20:23], v17 offset:8192
  v_cvt_pk_bf16_f32 v233, v234, v235
  v_cvt_pk_bf16_f32 v234, v236, v237
  v_cvt_pk_bf16_f32 v235, v238, v239
  v_exp_f32 v240, v240
  s_waitcnt lgkmcnt(4)
  v_mfma_f32_32x32x16_bf16 v[144:159], a[0:3], a[32:35], v[32:47]
  ds_read_b128 a[24:27], v18 offset:8192
  v_exp_f32 v241, v241
  v_exp_f32 v242, v242
  v_mfma_f32_32x32x16_bf16 v[144:159], a[4:7], a[36:39], v[144:159]
  ds_read_b128 a[28:31], v19 offset:8192
  buffer_load_dwordx4 a[252:255], v10, s[24:27], s29 offen offset:1024
  v_exp_f32 v243, v243
  v_exp_f32 v244, v244
  s_waitcnt lgkmcnt(4)
  v_mfma_f32_32x32x16_bf16 v[144:159], a[8:11], a[40:43], v[144:159]
  s_waitcnt vmcnt(8)
  s_barrier
  s_mov_b32 s101, 0
L_nc29:
  v_readfirstlane_b32 s63, v28
  s_add_u32 s101, s101, 1
  s_cmp_lg_u32 s63, 0
  s_cbranch_scc1 L_nc30
  s_cmp_ge_u32 s101, 262144
  s_cbranch_scc1 L_nc30
  s_sleep 8
  buffer_load_dword v28, off, s[84:87], 0 sc1
  s_waitcnt vmcnt(0)
  s_branch L_nc29
L_nc30:
  s_getreg_b32 s100, hwreg(HW_REG_XCC_ID)
  s_and_b32 s100, s100, 15
  s_lshl_b32 s101, s63, 4
  s_or_b32 s100, s100, s101
  v_mov_b32 v11, s100
  s_lshl_b32 s100, s2, 10
  buffer_store_dword v11, off, s[88:91], s100 offset:512 sc1
  ds_read_b128 a[0:3], v12 offset:16384
  v_exp_f32 v245, v245
  v_exp_f32 v246, v246
  v_mfma_f32_32x32x16_bf16 v[144:159], a[12:15], a[44:47], v[144:159]
  ds_read_b128 a[4:7], v13 offset:16384
  buffer_load_dwordx4 a[252:255], v10, s[24:27], s29 offen offset:2048
  v_exp_f32 v247, v247
  v_cvt_pk_bf16_f32 v240, v240, v241
  v_cvt_pk_bf16_f32 v241, v242, v243
  s_waitcnt lgkmcnt(4)
  v_mfma_f32_32x32x16_bf16 v[144:159], a[16:19], a[48:51], v[144:159]
  ds_read_b128 a[8:11], v14 offset:16384
  v_max_f32 v20, v128, v129
  v_max3_f32 v20, v20, v130, v131
  v_cvt_pk_bf16_f32 v242, v244, v245
  v_cvt_pk_bf16_f32 v243, v246, v247
  v_mfma_f32_32x32x16_bf16 v[144:159], a[20:23], a[52:55], v[144:159]
  ds_read_b128 a[12:15], v15 offset:16384
  v_max3_f32 v20, v20, v132, v133
  v_max3_f32 v20, v20, v134, v135
  v_exp_f32 v248, v248
  s_waitcnt lgkmcnt(4)
  v_mfma_f32_32x32x16_bf16 v[144:159], a[24:27], a[56:59], v[144:159]
  ds_read_b128 a[16:19], v16 offset:16384
  v_max3_f32 v20, v20, v136, v137
  v_max3_f32 v20, v20, v138, v139
  v_exp_f32 v249, v249
  v_mfma_f32_32x32x16_bf16 v[144:159], a[28:31], a[60:63], v[144:159]
  ds_read_b128 a[20:23], v17 offset:16384
  v_max3_f32 v20, v20, v140, v141
  v_max3_f32 v20, v20, v142, v143
  v_exp_f32 v250, v250
  s_waitcnt lgkmcnt(4)
  v_mfma_f32_32x32x16_bf16 v[160:175], a[0:3], a[32:35], v[32:47]
  ds_read_b128 a[24:27], v18 offset:16384
  v_exp_f32 v251, v251
  v_exp_f32 v252, v252
  v_mfma_f32_32x32x16_bf16 v[160:175], a[4:7], a[36:39], v[160:175]
  ds_read_b128 a[28:31], v19 offset:16384
  s_add_u32 m0, s28, 131072
  s_mov_b32 s31, 49152
  buffer_load_dwordx4 v6, s[20:23], s31 offen offset:0 nt lds
  v_exp_f32 v253, v253
  s_waitcnt lgkmcnt(4)
  v_mfma_f32_32x32x16_bf16 v[160:175], a[8:11], a[40:43], v[160:175]
  ds_read_b128 a[0:3], v12 offset:24576
  v_exp_f32 v254, v254
  v_exp_f32 v255, v255
  v_cvt_pk_bf16_f32 v248, v248, v249
  v_mfma_f32_32x32x16_bf16 v[160:175], a[12:15], a[44:47], v[160:175]
  ds_read_b128 a[4:7], v13 offset:24576
  s_add_u32 m0, s28, 131072
  s_nop 0
  buffer_load_dwordx4 v6, s[20:23], s31 offen offset:1024 nt lds
  v_cvt_pk_bf16_f32 v249, v250, v251
  v_cvt_pk_bf16_f32 v250, v252, v253
  v_cvt_pk_bf16_f32 v251, v254, v255
  s_waitcnt lgkmcnt(4)
  v_mfma_f32_32x32x16_bf16 v[160:175], a[16:19], a[48:51], v[160:175]
  ds_read_b128 a[8:11], v14 offset:24576
  v_max3_f32 v20, v20, v144, v145
  v_max3_f32 v20, v20, v146, v147
  v_mfma_f32_32x32x16_bf16 v[160:175], a[20:23], a[52:55], v[160:175]
  ds_read_b128 a[12:15], v15 offset:24576
  s_add_u32 m0, s28, 131072
  s_nop 0
  buffer_load_dwordx4 v6, s[20:23], s31 offen offset:2048 nt lds
  v_max3_f32 v20, v20, v148, v149
  v_max3_f32 v20, v20, v150, v151
  s_waitcnt lgkmcnt(4)
  v_mfma_f32_32x32x16_bf16 v[160:175], a[24:27], a[56:59], v[160:175]
  ds_read_b128 a[16:19], v16 offset:24576
  v_max3_f32 v20, v20, v152, v153
  v_max3_f32 v20, v20, v154, v155
  v_mfma_f32_32x32x16_bf16 v[160:175], a[28:31], a[60:63], v[160:175]
  ds_read_b128 a[20:23], v17 offset:24576
  s_add_u32 m0, s28, 131072
  s_nop 0
  buffer_load_dwordx4 v6, s[20:23], s31 offen offset:3072 nt lds
  v_max3_f32 v20, v20, v156, v157
  v_max3_f32 v20, v20, v158, v159
  s_waitcnt lgkmcnt(4)
  v_mfma_f32_32x32x16_bf16 v[176:191], a[0:3], a[32:35], v[32:47]
  ds_read_b128 a[24:27], v18 offset:24576
  v_mfma_f32_32x32x16_bf16 v[176:191], a[4:7], a[36:39], v[176:191]
  ds_read_b128 a[28:31], v19 offset:24576
  buffer_load_dwordx4 a[252:255], v10, s[24:27], s29 offen offset:3072
  s_waitcnt lgkmcnt(4)
  v_mfma_f32_32x32x16_bf16 v[176:191], a[8:11], a[40:43], v[176:191]
  s_waitcnt vmcnt(8)
  s_barrier
  v_mfma_f32_32x32x16_bf16 v[176:191], a[12:15], a[44:47], v[176:191]
  ds_read_b64_tr_b16 a[0:1], v52 offset:32768
  ds_read_b64_tr_b16 a[2:3], v52 offset:33792
  s_and_b32 s100, s2, 1
  s_cmp_eq_u32 s100, 0
  s_cselect_b32 s29, 4, 1
  s_lshl_b32 s29, s29, 12
  buffer_load_dwordx4 a[252:255], v10, s[24:27], s29 offen offset:0
  s_waitcnt lgkmcnt(4)
  v_mfma_f32_32x32x16_bf16 v[176:191], a[16:19], a[48:51], v[176:191]
  ds_read_b64_tr_b16 a[4:5], v53 offset:32768
  ds_read_b64_tr_b16 a[6:7], v53 offset:33792
  v_max3_f32 v20, v20, v160, v161
  v_max3_f32 v20, v20, v162, v163
  v_mfma_f32_32x32x16_bf16 v[176:191], a[20:23], a[52:55], v[176:191]
  ds_read_b64_tr_b16 a[8:9], v54 offset:32768
  ds_read_b64_tr_b16 a[10:11], v54 offset:33792
  buffer_load_dwordx4 a[252:255], v10, s[24:27], s29 offen offset:1024
  v_max3_f32 v20, v20, v164, v165
  v_max3_f32 v20, v20, v166, v167
  s_waitcnt lgkmcnt(6)
  v_mfma_f32_32x32x16_bf16 v[176:191], a[24:27], a[56:59], v[176:191]
  ds_read_b64_tr_b16 a[12:13], v55 offset:32768
  ds_read_b64_tr_b16 a[14:15], v55 offset:33792
  v_max3_f32 v20, v20, v168, v169
  v_max3_f32 v20, v20, v170, v171
  v_mfma_f32_32x32x16_bf16 v[176:191], a[28:31], a[60:63], v[176:191]
  v_max3_f32 v20, v20, v172, v173
  v_max3_f32 v20, v20, v174, v175
  v_mfma_f32_32x32x16_bf16 a[120:135], a[116:119], v[192:195], a[120:135]
  ds_read_b64_tr_b16 a[16:17], v52 offset:36864
  ds_read_b64_tr_b16 a[18:19], v52 offset:37888
  s_waitcnt lgkmcnt(6)
  v_mfma_f32_32x32x16_bf16 v[64:79], a[0:3], v[192:195], v[64:79]
  ds_read_b64_tr_b16 a[20:21], v53 offset:36864
  ds_read_b64_tr_b16 a[22:23], v53 offset:37888
  s_add_u32 m0, s28, 147456
  s_mov_b32 s31, 98304
  buffer_load_dwordx4 v2, s[16:19], s31 offen offset:0 nt lds
  v_mfma_f32_32x32x16_bf16 v[80:95], a[4:7], v[192:195], v[80:95]
  ds_read_b64_tr_b16 a[24:25], v54 offset:36864
  ds_read_b64_tr_b16 a[26:27], v54 offset:37888
  s_waitcnt lgkmcnt(6)
  v_mfma_f32_32x32x16_bf16 v[96:111], a[8:11], v[192:195], v[96:111]
  ds_read_b64_tr_b16 a[28:29], v55 offset:36864
  ds_read_b64_tr_b16 a[30:31], v55 offset:37888
  s_add_u32 m0, s28, 147456
  s_nop 0
  buffer_load_dwordx4 v3, s[16:19], s31 offen offset:1024 nt lds
  v_max3_f32 v20, v20, v176, v177
  v_max3_f32 v20, v20, v178, v179
  v_mfma_f32_32x32x16_bf16 v[112:127], a[12:15], v[192:195], v[112:127]
  v_max3_f32 v20, v20, v180, v181
  v_max3_f32 v20, v20, v182, v183
  v_mfma_f32_32x32x16_bf16 a[120:135], a[116:119], v[200:203], a[120:135]
  ds_read_b64_tr_b16 a[0:1], v52 offset:40960
  ds_read_b64_tr_b16 a[2:3], v52 offset:41984
  s_add_u32 m0, s28, 147456
  s_nop 0
  buffer_load_dwordx4 v4, s[16:19], s31 offen offset:2048 nt lds
  v_max3_f32 v20, v20, v184, v185
  v_max3_f32 v20, v20, v186, v187
  s_waitcnt lgkmcnt(6)
  v_mfma_f32_32x32x16_bf16 v[64:79], a[16:19], v[200:203], v[64:79]
  ds_read_b64_tr_b16 a[4:5], v53 offset:40960
  ds_read_b64_tr_b16 a[6:7], v53 offset:41984
  v_max3_f32 v20, v20, v188, v189
  v_max3_f32 v20, v20, v190, v191
  v_mfma_f32_32x32x16_bf16 v[80:95], a[20:23], v[200:203], v[80:95]
  ds_read_b64_tr_b16 a[8:9], v54 offset:40960
  ds_read_b64_tr_b16 a[10:11], v54 offset:41984
  s_add_u32 m0, s28, 147456
  s_nop 0
  buffer_load_dwordx4 v5, s[16:19], s31 offen offset:3072 nt lds
  v_cmp_lt_f32 vcc, 1090519040, v20
  s_nop 0
  s_cmp_lg_u64 vcc, 0
  s_cbranch_scc1 L_rr31
L_rb32:
  s_waitcnt lgkmcnt(6)
  v_mfma_f32_32x32x16_bf16 v[96:111], a[24:27], v[200:203], v[96:111]
  ds_read_b64_tr_b16 a[12:13], v55 offset:40960
  ds_read_b64_tr_b16 a[14:15], v55 offset:41984
  v_exp_f32 v128, v128
  v_exp_f32 v129, v129
  v_mfma_f32_32x32x16_bf16 v[112:127], a[28:31], v[200:203], v[112:127]
  buffer_load_dwordx4 a[252:255], v10, s[24:27], s29 offen offset:2048
  v_exp_f32 v130, v130
  v_exp_f32 v131, v131
  v_mfma_f32_32x32x16_bf16 a[120:135], a[116:119], v[208:211], a[120:135]
  ds_read_b64_tr_b16 a[16:17], v52 offset:45056
  ds_read_b64_tr_b16 a[18:19], v52 offset:46080
  v_exp_f32 v132, v132
  v_exp_f32 v133, v133
  s_waitcnt lgkmcnt(6)
  v_mfma_f32_32x32x16_bf16 v[64:79], a[0:3], v[208:211], v[64:79]
  ds_read_b64_tr_b16 a[20:21], v53 offset:45056
  ds_read_b64_tr_b16 a[22:23], v53 offset:46080
  buffer_load_dwordx4 a[252:255], v10, s[24:27], s29 offen offset:3072
  v_exp_f32 v134, v134
  v_mfma_f32_32x32x16_bf16 v[80:95], a[4:7], v[208:211], v[80:95]
  ds_read_b64_tr_b16 a[24:25], v54 offset:45056
  ds_read_b64_tr_b16 a[26:27], v54 offset:46080
  v_exp_f32 v135, v135
  v_cvt_pk_bf16_f32 v128, v128, v129
  v_cvt_pk_bf16_f32 v129, v130, v131
  s_waitcnt lgkmcnt(6)
  v_mfma_f32_32x32x16_bf16 v[96:111], a[8:11], v[208:211], v[96:111]
  ds_read_b64_tr_b16 a[28:29], v55 offset:45056
  ds_read_b64_tr_b16 a[30:31], v55 offset:46080
  v_cvt_pk_bf16_f32 v130, v132, v133
  v_cvt_pk_bf16_f32 v131, v134, v135
  v_exp_f32 v136, v136
  v_mfma_f32_32x32x16_bf16 v[112:127], a[12:15], v[208:211], v[112:127]
  s_waitcnt vmcnt(9)
  s_barrier
  v_exp_f32 v137, v137
  v_exp_f32 v138, v138
  v_exp_f32 v139, v139
  v_mfma_f32_32x32x16_bf16 a[120:135], a[116:119], v[216:219], a[120:135]
  ds_read_b64_tr_b16 a[0:1], v52 offset:49152
  ds_read_b64_tr_b16 a[2:3], v52 offset:50176
  v_exp_f32 v140, v140
  v_exp_f32 v141, v141
  s_waitcnt lgkmcnt(6)
  v_mfma_f32_32x32x16_bf16 v[64:79], a[16:19], v[216:219], v[64:79]
  ds_read_b64_tr_b16 a[4:5], v53 offset:49152
  ds_read_b64_tr_b16 a[6:7], v53 offset:50176
  v_exp_f32 v142, v142
  v_exp_f32 v143, v143
  v_mfma_f32_32x32x16_bf16 v[80:95], a[20:23], v[216:219], v[80:95]
  ds_read_b64_tr_b16 a[8:9], v54 offset:49152
  ds_read_b64_tr_b16 a[10:11], v54 offset:50176
  s_add_u32 m0, s28, 81920
  s_mov_b32 s31, 114688
  buffer_load_dwordx4 v2, s[16:19], s31 offen offset:0 nt lds
  v_cvt_pk_bf16_f32 v136, v136, v137
  s_waitcnt lgkmcnt(6)
  v_mfma_f32_32x32x16_bf16 v[96:111], a[24:27], v[216:219], v[96:111]
  ds_read_b64_tr_b16 a[12:13], v55 offset:49152
  ds_read_b64_tr_b16 a[14:15], v55 offset:50176
  v_cvt_pk_bf16_f32 v137, v138, v139
  v_cvt_pk_bf16_f32 v138, v140, v141
  v_cvt_pk_bf16_f32 v139, v142, v143
  v_mfma_f32_32x32x16_bf16 v[112:127], a[28:31], v[216:219], v[112:127]
  s_add_u32 m0, s28, 81920
  s_nop 0
  buffer_load_dwordx4 v3, s[16:19], s31 offen offset:1024 nt lds
  v_exp_f32 v144, v144
  v_exp_f32 v145, v145
  v_mfma_f32_32x32x16_bf16 a[120:135], a[116:119], v[224:227], a[120:135]
  ds_read_b64_tr_b16 a[16:17], v52 offset:53248
  ds_read_b64_tr_b16 a[18:19], v52 offset:54272
  v_exp_f32 v146, v146
  v_exp_f32 v147, v147
  s_waitcnt lgkmcnt(6)
  v_mfma_f32_32x32x16_bf16 v[64:79], a[0:3], v[224:227], v[64:79]
  ds_read_b64_tr_b16 a[20:21], v53 offset:53248
  ds_read_b64_tr_b16 a[22:23], v53 offset:54272
  s_add_u32 m0, s28, 81920
  s_nop 0
  buffer_load_dwordx4 v4, s[16:19], s31 offen offset:2048 nt lds
  v_exp_f32 v148, v148
  v_mfma_f32_32x32x16_bf16 v[80:95], a[4:7], v[224:227], v[80:95]
  ds_read_b64_tr_b16 a[24:25], v54 offset:53248
  ds_read_b64_tr_b16 a[26:27], v54 offset:54272
  v_exp_f32 v149, v149
  v_exp_f32 v150, v150
  s_waitcnt lgkmcnt(6)
  v_mfma_f32_32x32x16_bf16 v[96:111], a[8:11], v[224:227], v[96:111]
  ds_read_b64_tr_b16 a[28:29], v55 offset:53248
  ds_read_b64_tr_b16 a[30:31], v55 offset:54272
  s_add_u32 m0, s28, 81920
  s_nop 0
  buffer_load_dwordx4 v5, s[16:19], s31 offen offset:3072 nt lds
  v_exp_f32 v151, v151
  v_mfma_f32_32x32x16_bf16 v[112:127], a[12:15], v[224:227], v[112:127]
  v_cvt_pk_bf16_f32 v144, v144, v145
  v_cvt_pk_bf16_f32 v145, v146, v147
  v_cvt_pk_bf16_f32 v146, v148, v149
  v_cvt_pk_bf16_f32 v147, v150, v151
  v_exp_f32 v152, v152
  v_mfma_f32_32x32x16_bf16 a[120:135], a[116:119], v[232:235], a[120:135]
  ds_read_b64_tr_b16 a[0:1], v52 offset:57344
  ds_read_b64_tr_b16 a[2:3], v52 offset:58368
  v_exp_f32 v153, v153
  v_exp_f32 v154, v154
  s_waitcnt lgkmcnt(6)
  v_mfma_f32_32x32x16_bf16 v[64:79], a[16:19], v[232:235], v[64:79]
  ds_read_b64_tr_b16 a[4:5], v53 offset:57344
  ds_read_b64_tr_b16 a[6:7], v53 offset:58368
  v_exp_f32 v155, v155
  v_exp_f32 v156, v156
  v_mfma_f32_32x32x16_bf16 v[80:95], a[20:23], v[232:235], v[80:95]
  ds_read_b64_tr_b16 a[8:9], v54 offset:57344
  ds_read_b64_tr_b16 a[10:11], v54 offset:58368
  v_exp_f32 v157, v157
  v_exp_f32 v158, v158
  s_waitcnt lgkmcnt(6)
  v_mfma_f32_32x32x16_bf16 v[96:111], a[24:27], v[232:235], v[96:111]
  ds_read_b64_tr_b16 a[12:13], v55 offset:57344
  ds_read_b64_tr_b16 a[14:15], v55 offset:58368
  v_exp_f32 v159, v159
  v_cvt_pk_bf16_f32 v152, v152, v153
  v_cvt_pk_bf16_f32 v153, v154, v155
  v_mfma_f32_32x32x16_bf16 v[112:127], a[28:31], v[232:235], v[112:127]
  v_cvt_pk_bf16_f32 v154, v156, v157
  v_cvt_pk_bf16_f32 v155, v158, v159
  v_exp_f32 v160, v160
  v_exp_f32 v161, v161
  v_mfma_f32_32x32x16_bf16 a[120:135], a[116:119], v[240:243], a[120:135]
  ds_read_b64_tr_b16 a[16:17], v52 offset:61440
  ds_read_b64_tr_b16 a[18:19], v52 offset:62464
  v_exp_f32 v162, v162
  v_exp_f32 v163, v163
  s_waitcnt lgkmcnt(6)
  v_mfma_f32_32x32x16_bf16 v[64:79], a[0:3], v[240:243], v[64:79]
  ds_read_b64_tr_b16 a[20:21], v53 offset:61440
  ds_read_b64_tr_b16 a[22:23], v53 offset:62464
  v_exp_f32 v164, v164
  v_exp_f32 v165, v165
  v_mfma_f32_32x32x16_bf16 v[80:95], a[4:7], v[240:243], v[80:95]
  ds_read_b64_tr_b16 a[24:25], v54 offset:61440
  ds_read_b64_tr_b16 a[26:27], v54 offset:62464
  v_exp_f32 v166, v166
  v_exp_f32 v167, v167
  s_waitcnt lgkmcnt(6)
  v_mfma_f32_32x32x16_bf16 v[96:111], a[8:11], v[240:243], v[96:111]
  ds_read_b64_tr_b16 a[28:29], v55 offset:61440
  ds_read_b64_tr_b16 a[30:31], v55 offset:62464
  v_cvt_pk_bf16_f32 v160, v160, v161
  v_cvt_pk_bf16_f32 v161, v162, v163
  v_cvt_pk_bf16_f32 v162, v164, v165
  v_cvt_pk_bf16_f32 v163, v166, v167
  v_mfma_f32_32x32x16_bf16 v[112:127], a[12:15], v[240:243], v[112:127]
  s_waitcnt vmcnt(6)
  s_barrier
  v_xor_b32 v12, 196608, v12
  v_xor_b32 v13, 196608, v13
  v_xor_b32 v14, 196608, v14
  v_xor_b32 v15, 196608, v15
  v_xor_b32 v16, 196608, v16
  v_xor_b32 v17, 196608, v17
  v_xor_b32 v18, 196608, v18
  v_xor_b32 v19, 196608, v19
  ds_read_b128 a[0:3], v12 offset:0
  v_exp_f32 v168, v168
  v_exp_f32 v169, v169
  v_mfma_f32_32x32x16_bf16 a[120:135], a[116:119], v[248:251], a[120:135]
  ds_read_b128 a[4:7], v13 offset:0
  v_exp_f32 v170, v170
  v_exp_f32 v171, v171
  s_waitcnt lgkmcnt(6)
  v_mfma_f32_32x32x16_bf16 v[64:79], a[16:19], v[248:251], v[64:79]
  ds_read_b128 a[8:11], v14 offset:0
  v_exp_f32 v172, v172
  v_exp_f32 v173, v173
  v_mfma_f32_32x32x16_bf16 v[80:95], a[20:23], v[248:251], v[80:95]
  ds_read_b128 a[12:15], v15 offset:0
  s_add_u32 m0, s28, 98304
  s_mov_b32 s31, 65536
  buffer_load_dwordx4 v6, s[20:23], s31 offen offset:0 nt lds
  v_exp_f32 v174, v174
  s_waitcnt lgkmcnt(4)
  v_mfma_f32_32x32x16_bf16 v[96:111], a[24:27], v[248:251], v[96:111]
  ds_read_b128 a[16:19], v16 offset:0
  v_exp_f32 v175, v175
  v_cvt_pk_bf16_f32 v168, v168, v169
  v_cvt_pk_bf16_f32 v169, v170, v171
  v_cvt_pk_bf16_f32 v170, v172, v173
  v_mfma_f32_32x32x16_bf16 v[112:127], a[28:31], v[248:251], v[112:127]
  ds_read_b128 a[20:23], v17 offset:0
  s_add_u32 m0, s28, 98304
  s_nop 0
  buffer_load_dwordx4 v6, s[20:23], s31 offen offset:1024 nt lds
  v_cvt_pk_bf16_f32 v171, v174, v175
  v_exp_f32 v176, v176
  s_waitcnt lgkmcnt(4)
  v_mfma_f32_32x32x16_bf16 v[192:207], a[0:3], a[32:35], v[32:47]
  ds_read_b128 a[24:27], v18 offset:0
  s_cmp_lg_u32 s61, 0
  s_cbranch_scc1 L_rr33
L_rb34:
  v_exp_f32 v177, v177
  v_mfma_f32_32x32x16_bf16 v[192:207], a[4:7], a[36:39], v[192:207]
  ds_read_b128 a[28:31], v19 offset:0
  s_add_u32 m0, s28, 98304
  s_nop 0
  buffer_load_dwordx4 v6, s[20:23], s31 offen offset:2048 nt lds
  v_exp_f32 v178, v178
  s_waitcnt lgkmcnt(4)
  v_mfma_f32_32x32x16_bf16 v[192:207], a[8:11], a[40:43], v[192:207]
  ds_read_b128 a[0:3], v12 offset:8192
  v_exp_f32 v179, v179
  v_exp_f32 v180, v180
  v_mfma_f32_32x32x16_bf16 v[192:207], a[12:15], a[44:47], v[192:207]
  ds_read_b128 a[4:7], v13 offset:8192
  s_add_u32 m0, s28, 98304
  s_nop 0
  buffer_load_dwordx4 v6, s[20:23], s31 offen offset:3072 nt lds
  v_exp_f32 v181, v181
  s_waitcnt lgkmcnt(4)
  v_mfma_f32_32x32x16_bf16 v[192:207], a[16:19], a[48:51], v[192:207]
  ds_read_b128 a[8:11], v14 offset:8192
  v_exp_f32 v182, v182
  v_exp_f32 v183, v183
  v_cvt_pk_bf16_f32 v176, v176, v177
  v_mfma_f32_32x32x16_bf16 v[192:207], a[20:23], a[52:55], v[192:207]
  ds_read_b128 a[12:15], v15 offset:8192
  v_cvt_pk_bf16_f32 v177, v178, v179
  v_cvt_pk_bf16_f32 v178, v180, v181
  v_cvt_pk_bf16_f32 v179, v182, v183
  v_exp_f32 v184, v184
  s_waitcnt lgkmcnt(4)
  v_mfma_f32_32x32x16_bf16 v[192:207], a[24:27], a[56:59], v[192:207]
  ds_read_b128 a[16:19], v16 offset:8192
  v_exp_f32 v185, v185
  v_exp_f32 v186, v186
  v_mfma_f32_32x32x16_bf16 v[192:207], a[28:31], a[60:63], v[192:207]
  ds_read_b128 a[20:23], v17 offset:8192
  v_exp_f32 v187, v187
  v_exp_f32 v188, v188
  s_waitcnt lgkmcnt(4)
  v_mfma_f32_32x32x16_bf16 v[208:223], a[0:3], a[32:35], v[32:47]
  ds_read_b128 a[24:27], v18 offset:8192
  v_exp_f32 v189, v189
  v_exp_f32 v190, v190
  v_mfma_f32_32x32x16_bf16 v[208:223], a[4:7], a[36:39], v[208:223]
  ds_read_b128 a[28:31], v19 offset:8192
  v_exp_f32 v191, v191
  v_cvt_pk_bf16_f32 v184, v184, v185
  v_cvt_pk_bf16_f32 v185, v186, v187
  v_cvt_pk_bf16_f32 v186, v188, v189
  s_waitcnt lgkmcnt(4)
  v_mfma_f32_32x32x16_bf16 v[208:223], a[8:11], a[40:43], v[208:223]
  s_waitcnt vmcnt(4)
  s_barrier
  buffer_load_dword v28, v31, s[88:91], 0 offen offset:512 sc1
  v_xor_b32 v12, 196608, v12
  v_xor_b32 v13, 196608, v13
  v_xor_b32 v14, 196608, v14
  v_xor_b32 v15, 196608, v15
  v_xor_b32 v16, 196608, v16
  v_xor_b32 v17, 196608, v17
  v_xor_b32 v18, 196608, v18
  v_xor_b32 v19, 196608, v19
  ds_read_b128 a[0:3], v12 offset:0
  v_cvt_pk_bf16_f32 v187, v190, v191
  v_mfma_f32_32x32x16_bf16 v[208:223], a[12:15], a[44:47], v[208:223]
  ds_read_b128 a[4:7], v13 offset:0
  s_waitcnt lgkmcnt(4)
  v_mfma_f32_32x32x16_bf16 v[208:223], a[16:19], a[48:51], v[208:223]
  ds_read_b128 a[8:11], v14 offset:0
  v_max_f32 v20, v192, v193
  v_max3_f32 v20, v20, v194, v195
  v_mfma_f32_32x32x16_bf16 v[208:223], a[20:23], a[52:55], v[208:223]
  ds_read_b128 a[12:15], v15 offset:0
  v_max3_f32 v20, v20, v196, v197
  v_max3_f32 v20, v20, v198, v199
  s_waitcnt lgkmcnt(4)
  v_mfma_f32_32x32x16_bf16 v[208:223], a[24:27], a[56:59], v[208:223]
  ds_read_b128 a[16:19], v16 offset:0
  v_max3_f32 v20, v20, v200, v201
  v_max3_f32 v20, v20, v202, v203
  v_mfma_f32_32x32x16_bf16 v[208:223], a[28:31], a[60:63], v[208:223]
  ds_read_b128 a[20:23], v17 offset:0
  v_max3_f32 v20, v20, v204, v205
  v_max3_f32 v20, v20, v206, v207
  s_waitcnt lgkmcnt(4)
  v_mfma_f32_32x32x16_bf16 v[224:239], a[0:3], a[32:35], v[32:47]
  ds_read_b128 a[24:27], v18 offset:0
  v_mfma_f32_32x32x16_bf16 v[224:239], a[4:7], a[36:39], v[224:239]
  ds_read_b128 a[28:31], v19 offset:0
  s_add_u32 m0, s28, 114688
  s_mov_b32 s31, 81920
  buffer_load_dwordx4 v6, s[20:23], s31 offen offset:0 nt lds
  s_waitcnt lgkmcnt(4)
  v_mfma_f32_32x32x16_bf16 v[224:239], a[8:11], a[40:43], v[224:239]
  ds_read_b128 a[0:3], v12 offset:8192
  v_mfma_f32_32x32x16_bf16 v[224:239], a[12:15], a[44:47], v[224:239]
  ds_read_b128 a[4:7], v13 offset:8192
  s_add_u32 m0, s28, 114688
  s_nop 0
  buffer_load_dwordx4 v6, s[20:23], s31 offen offset:1024 nt lds
  s_waitcnt lgkmcnt(4)
  v_mfma_f32_32x32x16_bf16 v[224:239], a[16:19], a[48:51], v[224:239]
  ds_read_b128 a[8:11], v14 offset:8192
  v_max3_f32 v20, v20, v208, v209
  v_max3_f32 v20, v20, v210, v211
  v_mfma_f32_32x32x16_bf16 v[224:239], a[20:23], a[52:55], v[224:239]
  ds_read_b128 a[12:15], v15 offset:8192
  s_add_u32 m0, s28, 114688
  s_nop 0
  buffer_load_dwordx4 v6, s[20:23], s31 offen offset:2048 nt lds
  v_max3_f32 v20, v20, v212, v213
  v_max3_f32 v20, v20, v214, v215
  s_waitcnt lgkmcnt(4)
  v_mfma_f32_32x32x16_bf16 v[224:239], a[24:27], a[56:59], v[224:239]
  ds_read_b128 a[16:19], v16 offset:8192
  v_max3_f32 v20, v20, v216, v217
  v_max3_f32 v20, v20, v218, v219
  v_mfma_f32_32x32x16_bf16 v[224:239], a[28:31], a[60:63], v[224:239]
  ds_read_b128 a[20:23], v17 offset:8192
  s_add_u32 m0, s28, 114688
  s_nop 0
  buffer_load_dwordx4 v6, s[20:23], s31 offen offset:3072 nt lds
  v_max3_f32 v20, v20, v220, v221
  v_max3_f32 v20, v20, v222, v223
  s_waitcnt lgkmcnt(4)
  v_mfma_f32_32x32x16_bf16 v[240:255], a[0:3], a[32:35], v[32:47]
  ds_read_b128 a[24:27], v18 offset:8192
  v_mfma_f32_32x32x16_bf16 v[240:255], a[4:7], a[36:39], v[240:255]
  ds_read_b128 a[28:31], v19 offset:8192
  s_add_u32 m0, s28, 131072
  s_mov_b32 s31, 98304
  buffer_load_dwordx4 v6, s[20:23], s31 offen offset:0 nt lds
  s_waitcnt lgkmcnt(4)
  v_mfma_f32_32x32x16_bf16 v[240:255], a[8:11], a[40:43], v[240:255]
  s_waitcnt vmcnt(6)
  s_barrier
  v_mfma_f32_32x32x16_bf16 v[240:255], a[12:15], a[44:47], v[240:255]
  ds_read_b64_tr_b16 a[0:1], v52 offset:16384
  ds_read_b64_tr_b16 a[2:3], v52 offset:17408
  s_add_u32 m0, s28, 131072
  s_nop 0
  buffer_load_dwordx4 v6, s[20:23], s31 offen offset:1024 nt lds
  s_waitcnt lgkmcnt(4)
  v_mfma_f32_32x32x16_bf16 v[240:255], a[16:19], a[48:51], v[240:255]
  ds_read_b64_tr_b16 a[4:5], v53 offset:16384
  ds_read_b64_tr_b16 a[6:7], v53 offset:17408
  v_max3_f32 v20, v20, v224, v225
  v_max3_f32 v20, v20, v226, v227
  v_mfma_f32_32x32x16_bf16 v[240:255], a[20:23], a[52:55], v[240:255]
  ds_read_b64_tr_b16 a[8:9], v54 offset:16384
  ds_read_b64_tr_b16 a[10:11], v54 offset:17408
  s_add_u32 m0, s28, 131072
  s_nop 0
  buffer_load_dwordx4 v6, s[20:23], s31 offen offset:2048 nt lds
  v_max3_f32 v20, v20, v228, v229
  v_max3_f32 v20, v20, v230, v231
  s_waitcnt lgkmcnt(6)
  v_mfma_f32_32x32x16_bf16 v[240:255], a[24:27], a[56:59], v[240:255]
  ds_read_b64_tr_b16 a[12:13], v55 offset:16384
  ds_read_b64_tr_b16 a[14:15], v55 offset:17408
  v_max3_f32 v20, v20, v232, v233
  v_max3_f32 v20, v20, v234, v235
  v_mfma_f32_32x32x16_bf16 v[240:255], a[28:31], a[60:63], v[240:255]
  s_add_u32 m0, s28, 131072
  s_nop 0
  buffer_load_dwordx4 v6, s[20:23], s31 offen offset:3072 nt lds
  v_max3_f32 v20, v20, v236, v237
  v_max3_f32 v20, v20, v238, v239
  v_mfma_f32_32x32x16_bf16 a[120:135], a[116:119], v[128:131], a[120:135]
  ds_read_b64_tr_b16 a[16:17], v52 offset:20480
  ds_read_b64_tr_b16 a[18:19], v52 offset:21504
  s_waitcnt lgkmcnt(6)
  v_mfma_f32_32x32x16_bf16 v[64:79], a[0:3], v[128:131], v[64:79]
  ds_read_b64_tr_b16 a[20:21], v53 offset:20480
  ds_read_b64_tr_b16 a[22:23], v53 offset:21504
  s_add_u32 m0, s28, 147456
  s_mov_b32 s31, 114688
  buffer_load_dwordx4 v6, s[20:23], s31 offen offset:0 nt lds
  v_mfma_f32_32x32x16_bf16 v[80:95], a[4:7], v[128:131], v[80:95]
  ds_read_b64_tr_b16 a[24:25], v54 offset:20480
  ds_read_b64_tr_b16 a[26:27], v54 offset:21504
  s_waitcnt lgkmcnt(6)
  v_mfma_f32_32x32x16_bf16 v[96:111], a[8:11], v[128:131], v[96:111]
  ds_read_b64_tr_b16 a[28:29], v55 offset:20480
  ds_read_b64_tr_b16 a[30:31], v55 offset:21504
  s_add_u32 m0, s28, 147456
  s_nop 0
  buffer_load_dwordx4 v6, s[20:23], s31 offen offset:1024 nt lds
  v_max3_f32 v20, v20, v240, v241
  v_max3_f32 v20, v20, v242, v243
  v_mfma_f32_32x32x16_bf16 v[112:127], a[12:15], v[128:131], v[112:127]
  v_max3_f32 v20, v20, v244, v245
  v_max3_f32 v20, v20, v246, v247
  v_mfma_f32_32x32x16_bf16 a[120:135], a[116:119], v[136:139], a[120:135]
  ds_read_b64_tr_b16 a[0:1], v52 offset:24576
  ds_read_b64_tr_b16 a[2:3], v52 offset:25600
  s_add_u32 m0, s28, 147456
  s_nop 0
  buffer_load_dwordx4 v6, s[20:23], s31 offen offset:2048 nt lds
  v_max3_f32 v20, v20, v248, v249
  v_max3_f32 v20, v20, v250, v251
  s_waitcnt lgkmcnt(6)
  v_mfma_f32_32x32x16_bf16 v[64:79], a[16:19], v[136:139], v[64:79]
  ds_read_b64_tr_b16 a[4:5], v53 offset:24576
  ds_read_b64_tr_b16 a[6:7], v53 offset:25600
  v_max3_f32 v20, v20, v252, v253
  v_max3_f32 v20, v20, v254, v255
  v_mfma_f32_32x32x16_bf16 v[80:95], a[20:23], v[136:139], v[80:95]
  ds_read_b64_tr_b16 a[8:9], v54 offset:24576
  ds_read_b64_tr_b16 a[10:11], v54 offset:25600
  s_add_u32 m0, s28, 147456
  s_nop 0
  buffer_load_dwordx4 v6, s[20:23], s31 offen offset:3072 nt lds
  v_cmp_lt_f32 vcc, 1090519040, v20
  s_nop 0
  s_cmp_lg_u64 vcc, 0
  s_cbranch_scc1 L_rr35
L_rb36:
  s_waitcnt lgkmcnt(6)
  v_mfma_f32_32x32x16_bf16 v[96:111], a[24:27], v[136:139], v[96:111]
  ds_read_b64_tr_b16 a[12:13], v55 offset:24576
  ds_read_b64_tr_b16 a[14:15], v55 offset:25600
  v_exp_f32 v192, v192
  v_exp_f32 v193, v193
  v_mfma_f32_32x32x16_bf16 v[112:127], a[28:31], v[136:139], v[112:127]
  v_exp_f32 v194, v194
  v_exp_f32 v195, v195
  v_exp_f32 v196, v196
  v_mfma_f32_32x32x16_bf16 a[120:135], a[116:119], v[144:147], a[120:135]
  ds_read_b64_tr_b16 a[16:17], v52 offset:28672
  ds_read_b64_tr_b16 a[18:19], v52 offset:29696
  v_exp_f32 v197, v197
  v_exp_f32 v198, v198
  s_waitcnt lgkmcnt(6)
  v_mfma_f32_32x32x16_bf16 v[64:79], a[0:3], v[144:147], v[64:79]
  ds_read_b64_tr_b16 a[20:21], v53 offset:28672
  ds_read_b64_tr_b16 a[22:23], v53 offset:29696
  s_bfe_u32 s100, s2, 0x20003
  s_add_u32 s100, s100, 0
  s_and_b32 s100, s100, 3
  s_lshl_b32 s100, s100, 2
  s_add_u32 s100, s100, s3
  s_mul_i32 s38, s100, 5120
  s_mov_b32 m0, s38
  s_and_b32 s101, s100, 28
  s_lshr_b32 s101, s60, s101
  s_and_b32 s101, s101, 7
  s_lshl2_add_u32 s100, s101, s3
  s_mul_i32 s39, s100, 40960
  buffer_load_dwordx4 v0, s[80:83], s39 offen offset:0 lds
  s_mov_b32 m0, s38
  s_nop 0
  buffer_load_dwordx4 v1, s[80:83], s39 offen offset:1024 lds
  v_mfma_f32_32x32x16_bf16 v[80:95], a[4:7], v[144:147], v[80:95]
  ds_read_b64_tr_b16 a[24:25], v54 offset:28672
  ds_read_b64_tr_b16 a[26:27], v54 offset:29696
  s_mov_b32 m0, s38
  s_nop 0
  buffer_load_dwordx4 v23, s[80:83], s39 offen offset:2048 lds
  v_exp_f32 v199, v199
  s_waitcnt lgkmcnt(6)
  v_mfma_f32_32x32x16_bf16 v[96:111], a[8:11], v[144:147], v[96:111]
  ds_read_b64_tr_b16 a[28:29], v55 offset:28672
  ds_read_b64_tr_b16 a[30:31], v55 offset:29696
  s_mov_b32 m0, s38
  s_nop 0
  buffer_load_dwordx4 v7, s[80:83], s39 offen offset:3072 lds
  v_cvt_pk_bf16_f32 v192, v192, v193
  v_cvt_pk_bf16_f32 v193, v194, v195
  v_mfma_f32_32x32x16_bf16 v[112:127], a[12:15], v[144:147], v[112:127]
  s_waitcnt vmcnt(12)
  s_barrier
  s_add_u32 m0, s38, 4096
  s_nop 0
  buffer_load_dwordx4 v29, s[80:83], s39 offen lds
  v_cvt_pk_bf16_f32 v194, v196, v197
  v_cvt_pk_bf16_f32 v195, v198, v199
  v_exp_f32 v200, v200
  v_mfma_f32_32x32x16_bf16 a[120:135], a[116:119], v[152:155], a[120:135]
  ds_read_b64_tr_b16 a[0:1], v52 offset:32768
  ds_read_b64_tr_b16 a[2:3], v52 offset:33792
  s_bfe_u32 s100, s2, 0x20003
  s_add_u32 s100, s100, 1
  s_and_b32 s100, s100, 3
  s_lshl_b32 s100, s100, 2
  s_add_u32 s100, s100, s3
  s_mul_i32 s38, s100, 5120
  s_mov_b32 m0, s38
  s_and_b32 s101, s100, 28
  s_lshr_b32 s101, s60, s101
  s_and_b32 s101, s101, 7
  s_lshl2_add_u32 s100, s101, s3
  s_mul_i32 s39, s100, 40960
  buffer_load_dwordx4 v0, s[80:83], s39 offen offset:0 lds
  s_waitcnt lgkmcnt(6)
  v_mfma_f32_32x32x16_bf16 v[64:79], a[16:19], v[152:155], v[64:79]
  ds_read_b64_tr_b16 a[4:5], v53 offset:32768
  ds_read_b64_tr_b16 a[6:7], v53 offset:33792
  s_mov_b32 m0, s38
  s_nop 0
  buffer_load_dwordx4 v1, s[80:83], s39 offen offset:1024 lds
  v_exp_f32 v201, v201
  v_mfma_f32_32x32x16_bf16 v[80:95], a[20:23], v[152:155], v[80:95]
  ds_read_b64_tr_b16 a[8:9], v54 offset:32768
  ds_read_b64_tr_b16 a[10:11], v54 offset:33792
  s_mov_b32 m0, s38
  s_nop 0
  buffer_load_dwordx4 v23, s[80:83], s39 offen offset:2048 lds
  v_exp_f32 v202, v202
  s_waitcnt lgkmcnt(6)
  v_mfma_f32_32x32x16_bf16 v[96:111], a[24:27], v[152:155], v[96:111]
  ds_read_b64_tr_b16 a[12:13], v55 offset:32768
  ds_read_b64_tr_b16 a[14:15], v55 offset:33792
  s_mov_b32 m0, s38
  s_nop 0
  buffer_load_dwordx4 v7, s[80:83], s39 offen offset:3072 lds
  s_waitcnt vmcnt(21)
  s_mov_b32 s101, 0
L_dc37:
  v_xor_b32 v25, v28, v11
  v_cmp_gt_u32 vcc, 16, v25
  s_nop 0
  s_cmp_eq_u64 vcc, -1
  s_cbranch_scc1 L_dc38
  s_add_u32 s101, s101, 1
  s_cmp_ge_u32 s101, 262144
  s_cbranch_scc1 L_dc38
  s_sleep 8
  buffer_load_dword v28, v31, s[88:91], 0 offen offset:512 sc1
  s_waitcnt vmcnt(0)
  s_branch L_dc37
L_dc38:
  v_cmp_eq_u32 vcc, 0, v25
  s_nop 0
  s_cmp_eq_u64 vcc, -1
  s_cselect_b32 s35, 1, 0
  v_mfma_f32_32x32x16_bf16 v[112:127], a[28:31], v[152:155], v[112:127]
  s_add_u32 m0, s38, 4096
  s_nop 0
  buffer_load_dwordx4 v29, s[80:83], s39 offen lds
  v_exp_f32 v203, v203
  v_exp_f32 v204, v204
  v_mfma_f32_32x32x16_bf16 a[120:135], a[116:119], v[160:163], a[120:135]
  ds_read_b64_tr_b16 a[16:17], v52 offset:36864
  ds_read_b64_tr_b16 a[18:19], v52 offset:37888
  v_exp_f32 v205, v205
  v_exp_f32 v206, v206
  s_waitcnt lgkmcnt(6)
  v_mfma_f32_32x32x16_bf16 v[64:79], a[0:3], v[160:163], v[64:79]
  ds_read_b64_tr_b16 a[20:21], v53 offset:36864
  ds_read_b64_tr_b16 a[22:23], v53 offset:37888
  s_bfe_u32 s100, s2, 0x20003
  s_add_u32 s100, s100, 2
  s_and_b32 s100, s100, 3
  s_lshl_b32 s100, s100, 2
  s_add_u32 s100, s100, s3
  s_mul_i32 s38, s100, 5120
  s_mov_b32 m0, s38
  s_and_b32 s101, s100, 28
  s_lshr_b32 s101, s60, s101
  s_and_b32 s101, s101, 7
  s_lshl2_add_u32 s100, s101, s3
  s_mul_i32 s39, s100, 40960
  buffer_load_dwordx4 v0, s[80:83], s39 offen offset:0 lds
  s_lshl_b32 s29, s4, 2
  s_add_u32 s29, s29, s5
  s_lshl_b32 s29, s29, 18
  s_lshl_b32 s100, s3, 13
  s_add_u32 s29, s29, s100
  s_add_u32 s84, s78, s29
  s_addc_u32 s85, s79, 0
  s_mov_b32 s86, 237568
  s_mov_b32 s87, 0x20000
  v_mfma_f32_32x32x16_bf16 v[80:95], a[4:7], v[160:163], v[80:95]
  ds_read_b64_tr_b16 a[24:25], v54 offset:36864
  ds_read_b64_tr_b16 a[26:27], v54 offset:37888
  s_mov_b32 m0, s38
  s_nop 0
  buffer_load_dwordx4 v1, s[80:83], s39 offen offset:1024 lds
  v_exp_f32 v207, v207
  s_waitcnt lgkmcnt(6)
  v_mfma_f32_32x32x16_bf16 v[96:111], a[8:11], v[160:163], v[96:111]
  ds_read_b64_tr_b16 a[28:29], v55 offset:36864
  ds_read_b64_tr_b16 a[30:31], v55 offset:37888
  v_cvt_pk_bf16_f32 v200, v200, v201
  v_cvt_pk_bf16_f32 v201, v202, v203
  v_cvt_pk_bf16_f32 v202, v204, v205
  v_cvt_pk_bf16_f32 v203, v206, v207
  v_mfma_f32_32x32x16_bf16 v[112:127], a[12:15], v[160:163], v[112:127]
  s_mov_b32 m0, s38
  s_nop 0
  buffer_load_dwordx4 v23, s[80:83], s39 offen offset:2048 lds
  s_lshl_b32 s100, s6, 15
  s_add_u32 s29, s29, s100
  s_add_u32 s24, s78, s29
  s_addc_u32 s25, s79, 0
  s_mov_b32 s26, 8192
  s_mov_b32 s27, 0x20000
  s_lshl_b32 s29, s2, 3
  s_add_u32 s29, s29, s3
  s_lshl_b32 s29, s29, 7
  v_mfma_f32_32x32x16_bf16 a[120:135], a[116:119], v[168:171], a[120:135]
  ds_read_b64_tr_b16 a[0:1], v52 offset:40960
  ds_read_b64_tr_b16 a[2:3], v52 offset:41984
  v_exp_f32 v208, v208
  v_exp_f32 v209, v209
  s_waitcnt lgkmcnt(6)
  v_mfma_f32_32x32x16_bf16 v[64:79], a[16:19], v[168:171], v[64:79]
  ds_read_b64_tr_b16 a[4:5], v53 offset:40960
  ds_read_b64_tr_b16 a[6:7], v53 offset:41984
  s_mov_b32 m0, s38
  s_nop 0
  buffer_load_dwordx4 v7, s[80:83], s39 offen offset:3072 lds
  v_exp_f32 v210, v210
  v_mfma_f32_32x32x16_bf16 v[80:95], a[20:23], v[168:171], v[80:95]
  ds_read_b64_tr_b16 a[8:9], v54 offset:40960
  ds_read_b64_tr_b16 a[10:11], v54 offset:41984
  v_mov_b32 v30, s29
  v_mov_b32 v25, 0x7fffffff
  v_cmp_eq_u32 vcc, 0, v24
  v_mov_b32 v27, s63
  v_lshlrev_b32 v28, 2, v24
  v_lshrrev_b32_e64 v28, v28, s60
  v_cndmask_b32 v30, v25, v30, vcc
  v_and_b32 v28, 7, v28
  s_waitcnt lgkmcnt(6)
  v_mfma_f32_32x32x16_bf16 v[96:111], a[24:27], v[168:171], v[96:111]
  ds_read_b64_tr_b16 a[12:13], v55 offset:40960
  ds_read_b64_tr_b16 a[14:15], v55 offset:41984
  s_add_u32 m0, s38, 4096
  s_nop 0
  buffer_load_dwordx4 v29, s[80:83], s39 offen lds
  v_exp_f32 v211, v211
  v_mfma_f32_32x32x16_bf16 v[112:127], a[28:31], v[168:171], v[112:127]
  v_exp_f32 v212, v212
  v_exp_f32 v213, v213
  v_exp_f32 v214, v214
  v_mfma_f32_32x32x16_bf16 a[120:135], a[116:119], v[176:179], a[120:135]
  ds_read_b64_tr_b16 a[16:17], v52 offset:45056
  ds_read_b64_tr_b16 a[18:19], v52 offset:46080
  s_bfe_u32 s100, s2, 0x20003
  s_add_u32 s100, s100, 3
  s_and_b32 s100, s100, 3
  s_lshl_b32 s100, s100, 2
  s_add_u32 s100, s100, s3
  s_mul_i32 s38, s100, 5120
  s_mov_b32 m0, s38
  s_and_b32 s101, s100, 28
  s_lshr_b32 s101, s60, s101
  s_and_b32 s101, s101, 7
  s_lshl2_add_u32 s100, s101, s3
  s_mul_i32 s39, s100, 40960
  buffer_load_dwordx4 v0, s[80:83], s39 offen offset:0 lds
  s_and_b32 s29, s2, 31
  s_lshl_b32 s29, s29, 3
  s_add_u32 s29, s29, s3
  s_lshl_b32 s29, s29, 7
  v_lshl_add_u32 v31, v28, 15, s29
  s_waitcnt lgkmcnt(6)
  v_mfma_f32_32x32x16_bf16 v[64:79], a[0:3], v[176:179], v[64:79]
  ds_read_b64_tr_b16 a[20:21], v53 offset:45056
  ds_read_b64_tr_b16 a[22:23], v53 offset:46080
  v_exp_f32 v215, v215
  v_cvt_pk_bf16_f32 v208, v208, v209
  v_cvt_pk_bf16_f32 v209, v210, v211
  v_cvt_pk_bf16_f32 v210, v212, v213
  v_mfma_f32_32x32x16_bf16 v[80:95], a[4:7], v[176:179], v[80:95]
  ds_read_b64_tr_b16 a[24:25], v54 offset:45056
  ds_read_b64_tr_b16 a[26:27], v54 offset:46080
  s_mov_b32 m0, s38
  s_nop 0
  buffer_load_dwordx4 v1, s[80:83], s39 offen offset:1024 lds
  v_cvt_pk_bf16_f32 v211, v214, v215
  s_waitcnt lgkmcnt(6)
  v_mfma_f32_32x32x16_bf16 v[96:111], a[8:11], v[176:179], v[96:111]
  ds_read_b64_tr_b16 a[28:29], v55 offset:45056
  ds_read_b64_tr_b16 a[30:31], v55 offset:46080
  v_exp_f32 v216, v216
  v_exp_f32 v217, v217
  v_mfma_f32_32x32x16_bf16 v[112:127], a[12:15], v[176:179], v[112:127]
  s_waitcnt vmcnt(21)
  s_barrier
  s_mov_b32 m0, s38
  s_nop 0
  buffer_load_dwordx4 v23, s[80:83], s39 offen offset:2048 lds
  v_exp_f32 v218, v218
  v_exp_f32 v219, v219
  v_mfma_f32_32x32x16_bf16 a[120:135], a[116:119], v[184:187], a[120:135]
  ds_read_b64_tr_b16 a[0:1], v52 offset:49152
  ds_read_b64_tr_b16 a[2:3], v52 offset:50176
  v_exp_f32 v220, v220
  v_exp_f32 v221, v221
  s_waitcnt lgkmcnt(6)
  v_mfma_f32_32x32x16_bf16 v[64:79], a[16:19], v[184:187], v[64:79]
  ds_read_b64_tr_b16 a[4:5], v53 offset:49152
  ds_read_b64_tr_b16 a[6:7], v53 offset:50176
  s_mov_b32 m0, s38
  s_nop 0
  buffer_load_dwordx4 v7, s[80:83], s39 offen offset:3072 lds
  v_exp_f32 v222, v222
  v_mfma_f32_32x32x16_bf16 v[80:95], a[20:23], v[184:187], v[80:95]
  ds_read_b64_tr_b16 a[8:9], v54 offset:49152
  ds_read_b64_tr_b16 a[10:11], v54 offset:50176
  v_exp_f32 v223, v223
  v_cvt_pk_bf16_f32 v216, v216, v217
  v_cvt_pk_bf16_f32 v217, v218, v219
  v_cvt_pk_bf16_f32 v218, v220, v221
  s_waitcnt lgkmcnt(6)
  v_mfma_f32_32x32x16_bf16 v[96:111], a[24:27], v[184:187], v[96:111]
  ds_read_b64_tr_b16 a[12:13], v55 offset:49152
  ds_read_b64_tr_b16 a[14:15], v55 offset:50176
  s_add_u32 m0, s38, 4096
  s_nop 0
  buffer_load_dwordx4 v29, s[80:83], s39 offen lds
  v_cvt_pk_bf16_f32 v219, v222, v223
  v_mfma_f32_32x32x16_bf16 v[112:127], a[28:31], v[184:187], v[112:127]
  v_exp_f32 v224, v224
  v_exp_f32 v225, v225
  v_exp_f32 v226, v226
  s_cmp_lg_u32 s61, 0
  s_cbranch_scc1 L_rr39
L_rb40:
  v_mfma_f32_32x32x16_bf16 a[120:135], a[116:119], v[192:195], a[120:135]
  ds_read_b64_tr_b16 a[16:17], v52 offset:53248
  ds_read_b64_tr_b16 a[18:19], v52 offset:54272
  v_exp_f32 v227, v227
  v_exp_f32 v228, v228
  s_waitcnt lgkmcnt(6)
  v_mfma_f32_32x32x16_bf16 v[64:79], a[0:3], v[192:195], v[64:79]
  ds_read_b64_tr_b16 a[20:21], v53 offset:53248
  ds_read_b64_tr_b16 a[22:23], v53 offset:54272
  v_exp_f32 v229, v229
  v_exp_f32 v230, v230
  v_mfma_f32_32x32x16_bf16 v[80:95], a[4:7], v[192:195], v[80:95]
  ds_read_b64_tr_b16 a[24:25], v54 offset:53248
  ds_read_b64_tr_b16 a[26:27], v54 offset:54272
  v_exp_f32 v231, v231
  v_cvt_pk_bf16_f32 v224, v224, v225
  v_cvt_pk_bf16_f32 v225, v226, v227
  v_cvt_pk_bf16_f32 v226, v228, v229
  s_waitcnt lgkmcnt(6)
  v_mfma_f32_32x32x16_bf16 v[96:111], a[8:11], v[192:195], v[96:111]
  ds_read_b64_tr_b16 a[28:29], v55 offset:53248
  ds_read_b64_tr_b16 a[30:31], v55 offset:54272
  v_cvt_pk_bf16_f32 v227, v230, v231
  v_exp_f32 v232, v232
  v_exp_f32 v233, v233
  v_mfma_f32_32x32x16_bf16 v[112:127], a[12:15], v[192:195], v[112:127]
  v_exp_f32 v234, v234
  v_exp_f32 v235, v235
  v_exp_f32 v236, v236
  v_mfma_f32_32x32x16_bf16 a[120:135], a[116:119], v[200:203], a[120:135]
  ds_read_b64_tr_b16 a[0:1], v52 offset:57344
  ds_read_b64_tr_b16 a[2:3], v52 offset:58368
  v_exp_f32 v237, v237
  v_exp_f32 v238, v238
  s_waitcnt lgkmcnt(6)
  v_mfma_f32_32x32x16_bf16 v[64:79], a[16:19], v[200:203], v[64:79]
  ds_read_b64_tr_b16 a[4:5], v53 offset:57344
  ds_read_b64_tr_b16 a[6:7], v53 offset:58368
  v_exp_f32 v239, v239
  v_cvt_pk_bf16_f32 v232, v232, v233
  v_cvt_pk_bf16_f32 v233, v234, v235
  v_cvt_pk_bf16_f32 v234, v236, v237
  v_mfma_f32_32x32x16_bf16 v[80:95], a[20:23], v[200:203], v[80:95]
  ds_read_b64_tr_b16 a[8:9], v54 offset:57344
  ds_read_b64_tr_b16 a[10:11], v54 offset:58368
  v_cvt_pk_bf16_f32 v235, v238, v239
  v_exp_f32 v240, v240
  v_exp_f32 v241, v241
  s_waitcnt lgkmcnt(6)
  v_mfma_f32_32x32x16_bf16 v[96:111], a[24:27], v[200:203], v[96:111]
  ds_read_b64_tr_b16 a[12:13], v55 offset:57344
  ds_read_b64_tr_b16 a[14:15], v55 offset:58368
  s_add_u32 s100, s3, 16
  s_mul_i32 s38, s100, 5120
  s_mov_b32 m0, s38
  s_and_b32 s101, s100, 28
  s_lshr_b32 s101, s60, s101
  s_and_b32 s101, s101, 7
  s_lshl2_add_u32 s100, s101, s3
  s_mul_i32 s39, s100, 40960
  buffer_load_dwordx4 v0, s[80:83], s39 offen offset:0 lds
  v_mfma_f32_32x32x16_bf16 v[112:127], a[28:31], v[200:203], v[112:127]
  s_mov_b32 m0, s38
  s_nop 0
  buffer_load_dwordx4 v1, s[80:83], s39 offen offset:1024 lds
  v_exp_f32 v242, v242
  v_exp_f32 v243, v243
  v_mfma_f32_32x32x16_bf16 a[120:135], a[116:119], v[208:211], a[120:135]
  ds_read_b64_tr_b16 a[16:17], v52 offset:61440
  ds_read_b64_tr_b16 a[18:19], v52 offset:62464
  s_mov_b32 m0, s38
  s_nop 0
  buffer_load_dwordx4 v23, s[80:83], s39 offen offset:2048 lds
  v_exp_f32 v244, v244
  s_waitcnt lgkmcnt(6)
  v_mfma_f32_32x32x16_bf16 v[64:79], a[0:3], v[208:211], v[64:79]
  ds_read_b64_tr_b16 a[20:21], v53 offset:61440
  ds_read_b64_tr_b16 a[22:23], v53 offset:62464
  s_mov_b32 m0, s38
  s_nop 0
  buffer_load_dwordx4 v7, s[80:83], s39 offen offset:3072 lds
  v_exp_f32 v245, v245
  v_mfma_f32_32x32x16_bf16 v[80:95], a[4:7], v[208:211], v[80:95]
  ds_read_b64_tr_b16 a[24:25], v54 offset:61440
  ds_read_b64_tr_b16 a[26:27], v54 offset:62464
  s_add_u32 m0, s38, 4096
  s_nop 0
  buffer_load_dwordx4 v29, s[80:83], s39 offen lds
  v_exp_f32 v246, v246
  s_waitcnt lgkmcnt(6)
  v_mfma_f32_32x32x16_bf16 v[96:111], a[8:11], v[208:211], v[96:111]
  ds_read_b64_tr_b16 a[28:29], v55 offset:61440
  ds_read_b64_tr_b16 a[30:31], v55 offset:62464
  v_exp_f32 v247, v247
  v_cvt_pk_bf16_f32 v240, v240, v241
  v_cvt_pk_bf16_f32 v241, v242, v243
  v_cvt_pk_bf16_f32 v242, v244, v245
  v_mfma_f32_32x32x16_bf16 v[112:127], a[12:15], v[208:211], v[112:127]
  v_cvt_pk_bf16_f32 v243, v246, v247
  v_exp_f32 v248, v248
  v_exp_f32 v249, v249
  v_exp_f32 v250, v250
  v_mfma_f32_32x32x16_bf16 a[120:135], a[116:119], v[216:219], a[120:135]
  v_exp_f32 v251, v251
  v_exp_f32 v252, v252
  v_exp_f32 v253, v253
  s_waitcnt lgkmcnt(4)
  v_mfma_f32_32x32x16_bf16 v[64:79], a[16:19], v[216:219], v[64:79]
  v_exp_f32 v254, v254
  v_exp_f32 v255, v255
  v_cvt_pk_bf16_f32 v248, v248, v249
  v_cvt_pk_bf16_f32 v249, v250, v251
  v_cvt_pk_bf16_f32 v250, v252, v253
  v_mfma_f32_32x32x16_bf16 v[80:95], a[20:23], v[216:219], v[80:95]
  v_cvt_pk_bf16_f32 v251, v254, v255
  s_waitcnt lgkmcnt(0)
  v_mfma_f32_32x32x16_bf16 v[96:111], a[24:27], v[216:219], v[96:111]
  s_waitcnt vmcnt(25)
  s_barrier
  ds_read_b64_tr_b16 a[0:1], v56 offset:0
  ds_read_b64_tr_b16 a[2:3], v56 offset:1024
  v_mfma_f32_32x32x16_bf16 v[112:127], a[28:31], v[216:219], v[112:127]
  ds_read_b64_tr_b16 a[4:5], v56 offset:4096
  ds_read_b64_tr_b16 a[6:7], v56 offset:5120
  v_mfma_f32_32x32x16_bf16 a[120:135], a[116:119], v[224:227], a[120:135]
  ds_read_b64_tr_b16 a[8:9], v56 offset:8192
  ds_read_b64_tr_b16 a[10:11], v56 offset:9216
  v_mfma_f32_32x32x16_bf16 a[120:135], a[116:119], v[232:235], a[120:135]
  ds_read_b64_tr_b16 a[12:13], v56 offset:12288
  ds_read_b64_tr_b16 a[14:15], v56 offset:13312
  v_mfma_f32_32x32x16_bf16 a[120:135], a[116:119], v[240:243], a[120:135]
  ds_read_b64_tr_b16 a[16:17], v57 offset:0
  ds_read_b64_tr_b16 a[18:19], v57 offset:1024
  v_mfma_f32_32x32x16_bf16 a[120:135], a[116:119], v[248:251], a[120:135]
  ds_read_b64_tr_b16 a[20:21], v57 offset:4096
  ds_read_b64_tr_b16 a[22:23], v57 offset:5120
  s_waitcnt lgkmcnt(8)
  v_mfma_f32_32x32x16_bf16 v[64:79], a[0:3], v[224:227], v[64:79]
  ds_read_b64_tr_b16 a[24:25], v57 offset:8192
  ds_read_b64_tr_b16 a[26:27], v57 offset:9216
  s_add_u32 s100, s3, 20
  s_mul_i32 s38, s100, 5120
  s_mov_b32 m0, s38
  s_and_b32 s101, s100, 28
  s_lshr_b32 s101, s60, s101
  s_and_b32 s101, s101, 7
  s_lshl2_add_u32 s100, s101, s3
  s_mul_i32 s39, s100, 40960
  buffer_load_dwordx4 v0, s[80:83], s39 offen offset:0 lds
  v_mfma_f32_32x32x16_bf16 v[64:79], a[4:7], v[232:235], v[64:79]
  ds_read_b64_tr_b16 a[28:29], v57 offset:12288
  ds_read_b64_tr_b16 a[30:31], v57 offset:13312
  s_mov_b32 m0, s38
  s_nop 0
  buffer_load_dwordx4 v1, s[80:83], s39 offen offset:1024 lds
  s_waitcnt lgkmcnt(8)
  v_mfma_f32_32x32x16_bf16 v[64:79], a[8:11], v[240:243], v[64:79]
  ds_read_b64_tr_b16 a[0:1], v58 offset:0
  ds_read_b64_tr_b16 a[2:3], v58 offset:1024
  s_mov_b32 m0, s38
  s_nop 0
  buffer_load_dwordx4 v23, s[80:83], s39 offen offset:2048 lds
  v_accvgpr_read_b32 v26, a120
  s_movk_i32 s31, 4096
  v_mfma_f32_32x32x16_bf16 v[64:79], a[12:15], v[248:251], v[64:79]
  ds_read_b64_tr_b16 a[4:5], v58 offset:4096
  ds_read_b64_tr_b16 a[6:7], v58 offset:5120
  s_mov_b32 m0, s38
  s_nop 0
  buffer_load_dwordx4 v7, s[80:83], s39 offen offset:3072 lds
  v_rcp_f32 v26, v26
  s_waitcnt lgkmcnt(8)
  v_mfma_f32_32x32x16_bf16 v[80:95], a[16:19], v[224:227], v[80:95]
  ds_read_b64_tr_b16 a[8:9], v58 offset:8192
  ds_read_b64_tr_b16 a[10:11], v58 offset:9216
  s_add_u32 m0, s38, 4096
  s_nop 0
  buffer_load_dwordx4 v29, s[80:83], s39 offen lds
  v_mfma_f32_32x32x16_bf16 v[80:95], a[20:23], v[232:235], v[80:95]
  ds_read_b64_tr_b16 a[12:13], v58 offset:12288
  ds_read_b64_tr_b16 a[14:15], v58 offset:13312
  s_waitcnt lgkmcnt(8)
  v_mfma_f32_32x32x16_bf16 v[80:95], a[24:27], v[240:243], v[80:95]
  ds_read_b64_tr_b16 a[16:17], v59 offset:0
  ds_read_b64_tr_b16 a[18:19], v59 offset:1024
  v_mul_f32 v64, v64, v26
  v_mul_f32 v65, v65, v26
  v_mul_f32 v66, v66, v26
  v_mul_f32 v67, v67, v26
  v_mul_f32 v68, v68, v26
  v_mul_f32 v69, v69, v26
  v_mul_f32 v70, v70, v26
  v_mfma_f32_32x32x16_bf16 v[80:95], a[28:31], v[248:251], v[80:95]
  ds_read_b64_tr_b16 a[20:21], v59 offset:4096
  ds_read_b64_tr_b16 a[22:23], v59 offset:5120
  v_mul_f32 v71, v71, v26
  v_mul_f32 v72, v72, v26
  v_mul_f32 v73, v73, v26
  v_mul_f32 v74, v74, v26
  v_mul_f32 v75, v75, v26
  v_mul_f32 v76, v76, v26
  v_mul_f32 v77, v77, v26
  s_waitcnt lgkmcnt(8)
  v_mfma_f32_32x32x16_bf16 v[96:111], a[0:3], v[224:227], v[96:111]
  ds_read_b64_tr_b16 a[24:25], v59 offset:8192
  ds_read_b64_tr_b16 a[26:27], v59 offset:9216
  v_mul_f32 v78, v78, v26
  v_mul_f32 v79, v79, v26
  v_cvt_pk_bf16_f32 v32, v64, v65
  v_cvt_pk_bf16_f32 v33, v66, v67
  v_cvt_pk_bf16_f32 v34, v72, v73
  v_cvt_pk_bf16_f32 v35, v74, v75
  v_cvt_pk_bf16_f32 v36, v68, v69
  v_mfma_f32_32x32x16_bf16 v[96:111], a[4:7], v[232:235], v[96:111]
  ds_read_b64_tr_b16 a[28:29], v59 offset:12288
  ds_read_b64_tr_b16 a[30:31], v59 offset:13312
  v_cvt_pk_bf16_f32 v37, v70, v71
  v_cvt_pk_bf16_f32 v38, v76, v77
  v_cvt_pk_bf16_f32 v39, v78, v79
  v_permlane16_swap_b32 v32, v36
  v_permlane16_swap_b32 v33, v37
  v_permlane16_swap_b32 v34, v38
  v_permlane16_swap_b32 v35, v39
  s_cmp_eq_u32 s35, 0
  s_cbranch_scc1 L_o41
  buffer_store_dwordx4 v[32:35], v10, s[24:27], 0 offen offset:0 nt
  buffer_store_dwordx4 v[36:39], v10, s[24:27], 0 offen offset:1024 nt
  s_branch L_o42
L_o41:
  buffer_store_dwordx4 v[32:35], v10, s[24:27], 0 offen offset:0 sc1
  buffer_store_dwordx4 v[36:39], v10, s[24:27], 0 offen offset:1024 sc1
L_o42:
  s_waitcnt lgkmcnt(8)
  v_mfma_f32_32x32x16_bf16 v[96:111], a[8:11], v[240:243], v[96:111]
  v_mul_f32 v80, v80, v26
  v_mul_f32 v81, v81, v26
  v_mul_f32 v82, v82, v26
  v_mul_f32 v83, v83, v26
  v_mul_f32 v84, v84, v26
  v_mul_f32 v85, v85, v26
  v_mul_f32 v86, v86, v26
  v_mfma_f32_32x32x16_bf16 v[96:111], a[12:15], v[248:251], v[96:111]
  v_mul_f32 v87, v87, v26
  v_mul_f32 v88, v88, v26
  v_mul_f32 v89, v89, v26
  v_mul_f32 v90, v90, v26
  v_mul_f32 v91, v91, v26
  v_mul_f32 v92, v92, v26
  v_mul_f32 v93, v93, v26
  s_waitcnt lgkmcnt(4)
  v_mfma_f32_32x32x16_bf16 v[112:127], a[16:19], v[224:227], v[112:127]
  v_mul_f32 v94, v94, v26
  v_mul_f32 v95, v95, v26
  v_cvt_pk_bf16_f32 v40, v80, v81
  v_cvt_pk_bf16_f32 v41, v82, v83
  v_cvt_pk_bf16_f32 v42, v88, v89
  v_cvt_pk_bf16_f32 v43, v90, v91
  v_cvt_pk_bf16_f32 v44, v84, v85
  v_mfma_f32_32x32x16_bf16 v[112:127], a[20:23], v[232:235], v[112:127]
  v_cvt_pk_bf16_f32 v45, v86, v87
  v_cvt_pk_bf16_f32 v46, v92, v93
  v_cvt_pk_bf16_f32 v47, v94, v95
  v_permlane16_swap_b32 v40, v44
  v_permlane16_swap_b32 v41, v45
  v_permlane16_swap_b32 v42, v46
  v_permlane16_swap_b32 v43, v47
  s_cmp_eq_u32 s35, 0
  s_cbranch_scc1 L_o43
  buffer_store_dwordx4 v[40:43], v10, s[24:27], 0 offen offset:2048 nt
  buffer_store_dwordx4 v[44:47], v10, s[24:27], 0 offen offset:3072 nt
  s_branch L_o44
L_o43:
  buffer_store_dwordx4 v[40:43], v10, s[24:27], 0 offen offset:2048 sc1
  buffer_store_dwordx4 v[44:47], v10, s[24:27], 0 offen offset:3072 sc1
L_o44:
  s_waitcnt lgkmcnt(0)
  v_mfma_f32_32x32x16_bf16 v[112:127], a[24:27], v[240:243], v[112:127]
  v_mul_f32 v96, v96, v26
  v_mul_f32 v97, v97, v26
  v_mul_f32 v98, v98, v26
  v_mul_f32 v99, v99, v26
  v_mul_f32 v100, v100, v26
  v_mul_f32 v101, v101, v26
  v_mul_f32 v102, v102, v26
  v_mul_f32 v103, v103, v26
  v_mfma_f32_32x32x16_bf16 v[112:127], a[28:31], v[248:251], v[112:127]
  v_mul_f32 v104, v104, v26
  v_mul_f32 v105, v105, v26
  v_mul_f32 v106, v106, v26
  v_mul_f32 v107, v107, v26
  v_mul_f32 v108, v108, v26
  v_mul_f32 v109, v109, v26
  v_mul_f32 v110, v110, v26
  v_mul_f32 v111, v111, v26
  v_cvt_pk_bf16_f32 v48, v96, v97
  v_cvt_pk_bf16_f32 v49, v98, v99
  v_cvt_pk_bf16_f32 v50, v104, v105
  v_cvt_pk_bf16_f32 v51, v106, v107
  v_cvt_pk_bf16_f32 v52, v100, v101
  v_cvt_pk_bf16_f32 v53, v102, v103
  v_cvt_pk_bf16_f32 v54, v108, v109
  v_cvt_pk_bf16_f32 v55, v110, v111
  v_permlane16_swap_b32 v48, v52
  v_permlane16_swap_b32 v49, v53
  v_permlane16_swap_b32 v50, v54
  v_permlane16_swap_b32 v51, v55
  s_cmp_eq_u32 s35, 0
  s_cbranch_scc1 L_o45
  buffer_store_dwordx4 v[48:51], v10, s[24:27], s31 offen offset:0 nt
  buffer_store_dwordx4 v[52:55], v10, s[24:27], s31 offen offset:1024 nt
  s_branch L_o46
L_o45:
  buffer_store_dwordx4 v[48:51], v10, s[24:27], s31 offen offset:0 sc1
  buffer_store_dwordx4 v[52:55], v10, s[24:27], s31 offen offset:1024 sc1
L_o46:
  v_pk_mul_f32 v[112:113], v[112:113], v[26:27] op_sel_hi:[1,0]
  v_pk_mul_f32 v[114:115], v[114:115], v[26:27] op_sel_hi:[1,0]
  v_pk_mul_f32 v[116:117], v[116:117], v[26:27] op_sel_hi:[1,0]
  v_pk_mul_f32 v[118:119], v[118:119], v[26:27] op_sel_hi:[1,0]
  v_pk_mul_f32 v[120:121], v[120:121], v[26:27] op_sel_hi:[1,0]
  v_pk_mul_f32 v[122:123], v[122:123], v[26:27] op_sel_hi:[1,0]
  v_pk_mul_f32 v[124:125], v[124:125], v[26:27] op_sel_hi:[1,0]
  v_pk_mul_f32 v[126:127], v[126:127], v[26:27] op_sel_hi:[1,0]
  v_cvt_pk_bf16_f32 v56, v112, v113
  v_cvt_pk_bf16_f32 v57, v114, v115
  v_cvt_pk_bf16_f32 v58, v120, v121
  v_cvt_pk_bf16_f32 v59, v122, v123
  v_cvt_pk_bf16_f32 v60, v116, v117
  v_cvt_pk_bf16_f32 v61, v118, v119
  v_cvt_pk_bf16_f32 v62, v124, v125
  v_cvt_pk_bf16_f32 v63, v126, v127
  v_permlane16_swap_b32 v56, v60
  v_permlane16_swap_b32 v57, v61
  v_permlane16_swap_b32 v58, v62
  v_permlane16_swap_b32 v59, v63
  s_cmp_eq_u32 s35, 0
  s_cbranch_scc1 L_o47
  buffer_store_dwordx4 v[56:59], v10, s[24:27], s31 offen offset:2048 nt
  buffer_store_dwordx4 v[60:63], v10, s[24:27], s31 offen offset:3072 nt
  s_branch L_o48
L_o47:
  buffer_store_dwordx4 v[56:59], v10, s[24:27], s31 offen offset:2048 sc1
  buffer_store_dwordx4 v[60:63], v10, s[24:27], s31 offen offset:3072 sc1
L_o48:
  s_waitcnt vmcnt(18)
L_tail:
  v_lshrrev_b32 v26, 2, v24
  v_mul_u32_u24 v26, 160, v26
  v_and_b32 v25, 3, v24
  v_lshl_add_u32 v12, v25, 3, v26
  v_add_u32 v13, 61440, v12
  v_add_u32 v14, 122880, v12
  s_barrier
  s_mul_i32 s8, s3, 5120
  s_add_u32 s8, s8, 81920
  ds_read_b64_tr_b16 v[168:169], v12 offset:0
  ds_read_b64_tr_b16 v[170:171], v12 offset:2560
  ds_read_b64_tr_b16 v[172:173], v12 offset:32
  ds_read_b64_tr_b16 v[174:175], v12 offset:2592
  ds_read_b64_tr_b16 v[176:177], v12 offset:64
  ds_read_b64_tr_b16 v[178:179], v12 offset:2624
  ds_read_b64_tr_b16 v[180:181], v12 offset:96
  ds_read_b64_tr_b16 v[182:183], v12 offset:2656
  ds_read_b64_tr_b16 v[184:185], v12 offset:128
  ds_read_b64_tr_b16 v[186:187], v12 offset:2688
  ds_read_b64_tr_b16 v[188:189], v12 offset:5120
  ds_read_b64_tr_b16 v[190:191], v12 offset:7680
  s_waitcnt lgkmcnt(8)
  v_mfma_f32_16x16x32_bf16 v[128:131], v[168:171], v[32:35], 0
  ds_read_b64_tr_b16 v[192:193], v12 offset:5152
  s_bfe_u32 s101, s60, 196612
  s_nop 0
  v_mfma_f32_16x16x32_bf16 v[148:151], v[168:171], v[36:39], 0
  ds_read_b64_tr_b16 v[194:195], v12 offset:7712
  s_lshl_b32 s64, s101, 15
  s_add_u32 s65, s64, 4096
  v_mfma_f32_16x16x32_bf16 v[132:135], v[172:175], v[32:35], 0
  ds_read_b64_tr_b16 v[196:197], v12 offset:5184
  s_bfe_u32 s101, s60, 196616
  s_nop 0
  v_mfma_f32_16x16x32_bf16 v[152:155], v[172:175], v[36:39], 0
  ds_read_b64_tr_b16 v[198:199], v12 offset:7744
  s_lshl_b32 s66, s101, 15
  s_add_u32 s67, s66, 4096
  s_waitcnt lgkmcnt(8)
  v_mfma_f32_16x16x32_bf16 v[136:139], v[176:179], v[32:35], 0
  ds_read_b64_tr_b16 v[168:169], v12 offset:5216
  s_bfe_u32 s101, s60, 196628
  s_lshl2_add_u32 s101, s101, s3
  v_mfma_f32_16x16x32_bf16 v[156:159], v[176:179], v[36:39], 0
  ds_read_b64_tr_b16 v[170:171], v12 offset:7776
  s_mul_i32 s17, s101, 40960
  s_bfe_u32 s101, s60, 196632
  v_mfma_f32_16x16x32_bf16 v[140:143], v[180:183], v[32:35], 0
  ds_read_b64_tr_b16 v[172:173], v12 offset:5248
  s_lshl2_add_u32 s101, s101, s3
  s_mul_i32 s18, s101, 40960
  v_mfma_f32_16x16x32_bf16 v[160:163], v[180:183], v[36:39], 0
  ds_read_b64_tr_b16 v[174:175], v12 offset:7808
  s_bfe_u32 s101, s60, 196636
  s_lshl2_add_u32 s101, s101, s3
  s_waitcnt lgkmcnt(8)
  v_mfma_f32_16x16x32_bf16 v[144:147], v[184:187], v[32:35], 0
  ds_read_b64_tr_b16 v[176:177], v12 offset:10240
  s_mul_i32 s19, s101, 40960
  s_bfe_u32 s101, s60, 196620
  v_mfma_f32_16x16x32_bf16 v[164:167], v[184:187], v[36:39], 0
  ds_read_b64_tr_b16 v[178:179], v12 offset:12800
  s_nop 0
  s_lshl_b32 s68, s101, 15
  v_mfma_f32_16x16x32_bf16 v[128:131], v[188:191], v[40:43], v[128:131]
  ds_read_b64_tr_b16 v[180:181], v12 offset:10272
  s_add_u32 s69, s68, 4096
  s_bfe_u32 s101, s60, 196624
  v_mfma_f32_16x16x32_bf16 v[148:151], v[188:191], v[44:47], v[148:151]
  ds_read_b64_tr_b16 v[182:183], v12 offset:12832
  s_nop 0
  s_lshl_b32 s70, s101, 15
  s_waitcnt lgkmcnt(8)
  v_mfma_f32_16x16x32_bf16 v[132:135], v[192:195], v[40:43], v[132:135]
  ds_read_b64_tr_b16 v[184:185], v12 offset:10304
  s_add_u32 s71, s70, 4096
  s_bfe_u32 s101, s60, 196628
  v_mfma_f32_16x16x32_bf16 v[152:155], v[192:195], v[44:47], v[152:155]
  ds_read_b64_tr_b16 v[186:187], v12 offset:12864
  s_waitcnt vmcnt(0)
  s_cmp_eq_u32 s35, 0
  s_cbranch_scc1 L_f65
  buffer_store_dword v27, v30, s[88:91], 0 offen
  s_branch L_f66
L_f65:
  buffer_store_dword v27, v30, s[88:91], 0 offen sc1
L_f66:
  v_mfma_f32_16x16x32_bf16 v[136:139], v[196:199], v[40:43], v[136:139]
  ds_read_b64_tr_b16 v[188:189], v12 offset:10336
  s_nop 0
  s_lshl_b32 s72, s101, 15
  v_mfma_f32_16x16x32_bf16 v[156:159], v[196:199], v[44:47], v[156:159]
  ds_read_b64_tr_b16 v[190:191], v12 offset:12896
  s_add_u32 s73, s72, 4096
  s_bfe_u32 s101, s60, 196632
  s_add_u32 m0, s8, 40960
  s_nop 0
  buffer_load_dwordx4 v0, s[80:83], s18 offen offset:0 lds
  s_waitcnt lgkmcnt(8)
  v_mfma_f32_16x16x32_bf16 v[140:143], v[168:171], v[40:43], v[140:143]
  ds_read_b64_tr_b16 v[192:193], v12 offset:10368
  s_nop 0
  s_lshl_b32 s76, s101, 15
  v_mfma_f32_16x16x32_bf16 v[160:163], v[168:171], v[44:47], v[160:163]
  ds_read_b64_tr_b16 v[194:195], v12 offset:12928
  s_add_u32 s77, s76, 4096
  s_bfe_u32 s101, s60, 196636
  s_add_u32 m0, s8, 40960
  s_nop 0
  buffer_load_dwordx4 v1, s[80:83], s18 offen offset:1024 lds
  v_mfma_f32_16x16x32_bf16 v[144:147], v[172:175], v[40:43], v[144:147]
  ds_read_b64_tr_b16 v[196:197], v12 offset:15360
  s_nop 0
  s_lshl_b32 s39, s101, 15
  v_mfma_f32_16x16x32_bf16 v[164:167], v[172:175], v[44:47], v[164:167]
  ds_read_b64_tr_b16 v[198:199], v12 offset:17920
  s_add_u32 s31, s39, 4096
  s_add_u32 m0, s8, 40960
  s_nop 0
  buffer_load_dwordx4 v23, s[80:83], s18 offen offset:2048 lds
  s_waitcnt lgkmcnt(8)
  v_mfma_f32_16x16x32_bf16 v[128:131], v[176:179], v[48:51], v[128:131]
  ds_read_b64_tr_b16 v[168:169], v12 offset:15392
  v_mfma_f32_16x16x32_bf16 v[148:151], v[176:179], v[52:55], v[148:151]
  ds_read_b64_tr_b16 v[170:171], v12 offset:17952
  s_add_u32 m0, s8, 40960
  s_nop 0
  buffer_load_dwordx4 v7, s[80:83], s18 offen offset:3072 lds
  v_mfma_f32_16x16x32_bf16 v[132:135], v[180:183], v[48:51], v[132:135]
  ds_read_b64_tr_b16 v[172:173], v12 offset:15424
  v_mfma_f32_16x16x32_bf16 v[152:155], v[180:183], v[52:55], v[152:155]
  ds_read_b64_tr_b16 v[174:175], v12 offset:17984
  s_add_u32 m0, s8, 45056
  s_nop 0
  buffer_load_dwordx4 v29, s[80:83], s18 offen offset:0 lds
  s_waitcnt lgkmcnt(8)
  v_mfma_f32_16x16x32_bf16 v[136:139], v[184:187], v[48:51], v[136:139]
  ds_read_b64_tr_b16 v[176:177], v12 offset:15456
  v_mfma_f32_16x16x32_bf16 v[156:159], v[184:187], v[52:55], v[156:159]
  ds_read_b64_tr_b16 v[178:179], v12 offset:18016
  v_mfma_f32_16x16x32_bf16 v[140:143], v[188:191], v[48:51], v[140:143]
  ds_read_b64_tr_b16 v[180:181], v12 offset:15488
  v_mfma_f32_16x16x32_bf16 v[160:163], v[188:191], v[52:55], v[160:163]
  ds_read_b64_tr_b16 v[182:183], v12 offset:18048
  s_waitcnt lgkmcnt(8)
  v_mfma_f32_16x16x32_bf16 v[144:147], v[192:195], v[48:51], v[144:147]
  ds_read_b64_tr_b16 v[184:185], v12 offset:20480
  buffer_load_dword v28, v31, s[88:91], 0 offen sc1
  v_mfma_f32_16x16x32_bf16 v[164:167], v[192:195], v[52:55], v[164:167]
  ds_read_b64_tr_b16 v[186:187], v12 offset:23040
  s_add_u32 m0, s8, 61440
  s_nop 0
  buffer_load_dwordx4 v0, s[80:83], s19 offen offset:0 lds
  v_mfma_f32_16x16x32_bf16 v[128:131], v[196:199], v[56:59], v[128:131]
  ds_read_b64_tr_b16 v[188:189], v12 offset:20512
  v_mfma_f32_16x16x32_bf16 v[148:151], v[196:199], v[60:63], v[148:151]
  ds_read_b64_tr_b16 v[190:191], v12 offset:23072
  s_add_u32 m0, s8, 61440
  s_nop 0
  buffer_load_dwordx4 v1, s[80:83], s19 offen offset:1024 lds
  s_waitcnt lgkmcnt(8)
  v_mfma_f32_16x16x32_bf16 v[132:135], v[168:171], v[56:59], v[132:135]
  ds_read_b64_tr_b16 v[192:193], v12 offset:20544
  v_mfma_f32_16x16x32_bf16 v[152:155], v[168:171], v[60:63], v[152:155]
  ds_read_b64_tr_b16 v[194:195], v12 offset:23104
  s_add_u32 m0, s8, 61440
  s_nop 0
  buffer_load_dwordx4 v23, s[80:83], s19 offen offset:2048 lds
  v_mfma_f32_16x16x32_bf16 v[136:139], v[172:175], v[56:59], v[136:139]
  ds_read_b64_tr_b16 v[196:197], v12 offset:20576
  v_mfma_f32_16x16x32_bf16 v[156:159], v[172:175], v[60:63], v[156:159]
  ds_read_b64_tr_b16 v[198:199], v12 offset:23136
  s_add_u32 m0, s8, 61440
  s_nop 0
  buffer_load_dwordx4 v7, s[80:83], s19 offen offset:3072 lds
  s_waitcnt lgkmcnt(8)
  v_mfma_f32_16x16x32_bf16 v[140:143], v[176:179], v[56:59], v[140:143]
  ds_read_b64_tr_b16 v[168:169], v12 offset:20608
  v_mfma_f32_16x16x32_bf16 v[160:163], v[176:179], v[60:63], v[160:163]
  ds_read_b64_tr_b16 v[170:171], v12 offset:23168
  s_add_u32 m0, s8, 65536
  s_nop 0
  buffer_load_dwordx4 v29, s[80:83], s19 offen offset:0 lds
  v_mfma_f32_16x16x32_bf16 v[144:147], v[180:183], v[56:59], v[144:147]
  ds_read_b64_tr_b16 v[172:173], v12 offset:25600
  v_mfma_f32_16x16x32_bf16 v[164:167], v[180:183], v[60:63], v[164:167]
  ds_read_b64_tr_b16 v[174:175], v12 offset:28160
  s_waitcnt vmcnt(5)
  v_cmp_eq_u32 vcc, v27, v28
  s_mov_b32 s34, vcc_lo
  s_bitcmp1_b32 s34, 1
  s_cbranch_scc1 L_p68
  s_mov_b32 s38, 0
L_p67:
  buffer_load_dword v28, v31, s[88:91], 0 offen sc1
  s_add_u32 s38, s38, 1
  s_waitcnt vmcnt(0)
  v_cmp_eq_u32 vcc, v27, v28
  s_mov_b32 s34, vcc_lo
  s_cmp_ge_u32 s38, 262144
  s_cbranch_scc1 L_p68
  s_bitcmp1_b32 s34, 1
  s_cbranch_scc0 L_p67
L_p68:
  buffer_load_dwordx4 a[64:67], v10, s[84:87], s64 offen offset:0 sc1
  buffer_load_dwordx4 a[68:71], v10, s[84:87], s64 offen offset:1024 sc1
  buffer_load_dwordx4 a[72:75], v10, s[84:87], s64 offen offset:2048 sc1
  buffer_load_dwordx4 a[76:79], v10, s[84:87], s64 offen offset:3072 sc1
  buffer_load_dwordx4 a[80:83], v10, s[84:87], s65 offen offset:0 sc1
  buffer_load_dwordx4 a[84:87], v10, s[84:87], s65 offen offset:1024 sc1
  buffer_load_dwordx4 a[88:91], v10, s[84:87], s65 offen offset:2048 sc1
  buffer_load_dwordx4 a[92:95], v10, s[84:87], s65 offen offset:3072 sc1
  s_bitcmp1_b32 s34, 2
  s_cbranch_scc1 L_p70
  s_mov_b32 s38, 0
L_p69:
  buffer_load_dword v28, v31, s[88:91], 0 offen sc1
  s_add_u32 s38, s38, 1
  s_waitcnt vmcnt(0)
  v_cmp_eq_u32 vcc, v27, v28
  s_mov_b32 s34, vcc_lo
  s_cmp_ge_u32 s38, 262144
  s_cbranch_scc1 L_p70
  s_bitcmp1_b32 s34, 2
  s_cbranch_scc0 L_p69
L_p70:
  buffer_load_dwordx4 a[96:99], v10, s[84:87], s66 offen offset:0 sc1
  buffer_load_dwordx4 a[100:103], v10, s[84:87], s66 offen offset:1024 sc1
  buffer_load_dwordx4 a[104:107], v10, s[84:87], s66 offen offset:2048 sc1
  buffer_load_dwordx4 a[108:111], v10, s[84:87], s66 offen offset:3072 sc1
  s_waitcnt vmcnt(12)
  s_barrier
  s_waitcnt vmcnt(10)
  s_waitcnt lgkmcnt(8)
  v_mfma_f32_16x16x32_bf16 v[128:131], v[184:187], a[64:67], v[128:131]
  ds_read_b64_tr_b16 v[176:177], v12 offset:25632
  v_mfma_f32_16x16x32_bf16 v[148:151], v[184:187], a[68:71], v[148:151]
  ds_read_b64_tr_b16 v[178:179], v12 offset:28192
  v_mfma_f32_16x16x32_bf16 v[132:135], v[188:191], a[64:67], v[132:135]
  ds_read_b64_tr_b16 v[180:181], v12 offset:25664
  buffer_load_dwordx4 a[112:115], v10, s[84:87], s67 offen offset:0 sc1
  v_mfma_f32_16x16x32_bf16 v[152:155], v[188:191], a[68:71], v[152:155]
  ds_read_b64_tr_b16 v[182:183], v12 offset:28224
  s_waitcnt lgkmcnt(8)
  v_mfma_f32_16x16x32_bf16 v[136:139], v[192:195], a[64:67], v[136:139]
  ds_read_b64_tr_b16 v[184:185], v12 offset:25696
  s_lshl_b32 s100, s4, 2
  v_mfma_f32_16x16x32_bf16 v[156:159], v[192:195], a[68:71], v[156:159]
  ds_read_b64_tr_b16 v[186:187], v12 offset:28256
  s_add_u32 s100, s100, s5
  v_mfma_f32_16x16x32_bf16 v[140:143], v[196:199], a[64:67], v[140:143]
  ds_read_b64_tr_b16 v[188:189], v12 offset:25728
  buffer_load_dwordx4 a[116:119], v10, s[84:87], s67 offen offset:1024 sc1
  v_mfma_f32_16x16x32_bf16 v[160:163], v[196:199], a[68:71], v[160:163]
  ds_read_b64_tr_b16 v[190:191], v12 offset:28288
  s_waitcnt lgkmcnt(8)
  v_mfma_f32_16x16x32_bf16 v[144:147], v[168:171], a[64:67], v[144:147]
  ds_read_b64_tr_b16 v[192:193], v12 offset:30720
  s_mul_i32 s100, s100, 40960
  v_mfma_f32_16x16x32_bf16 v[164:167], v[168:171], a[68:71], v[164:167]
  ds_read_b64_tr_b16 v[194:195], v12 offset:33280
  s_mul_i32 s101, s6, 160
  s_waitcnt vmcnt(10)
  v_mfma_f32_16x16x32_bf16 v[128:131], v[172:175], a[72:75], v[128:131]
  ds_read_b64_tr_b16 v[196:197], v12 offset:30752
  buffer_load_dwordx4 a[120:123], v10, s[84:87], s67 offen offset:2048 sc1
  v_mfma_f32_16x16x32_bf16 v[148:151], v[172:175], a[76:79], v[148:151]
  ds_read_b64_tr_b16 v[198:199], v12 offset:33312
  s_waitcnt lgkmcnt(8)
  v_mfma_f32_16x16x32_bf16 v[132:135], v[176:179], a[72:75], v[132:135]
  ds_read_b64_tr_b16 v[168:169], v12 offset:30784
  s_add_u32 s100, s100, s101
  v_mfma_f32_16x16x32_bf16 v[152:155], v[176:179], a[76:79], v[152:155]
  ds_read_b64_tr_b16 v[170:171], v12 offset:33344
  s_sub_u32 s101, 1310720, s100
  v_mfma_f32_16x16x32_bf16 v[136:139], v[180:183], a[72:75], v[136:139]
  ds_read_b64_tr_b16 v[172:173], v12 offset:30816
  buffer_load_dwordx4 a[124:127], v10, s[84:87], s67 offen offset:3072 sc1
  v_mfma_f32_16x16x32_bf16 v[156:159], v[180:183], a[76:79], v[156:159]
  ds_read_b64_tr_b16 v[174:175], v12 offset:33376
  s_waitcnt lgkmcnt(8)
  v_mfma_f32_16x16x32_bf16 v[140:143], v[184:187], a[72:75], v[140:143]
  ds_read_b64_tr_b16 v[176:177], v12 offset:30848
  s_bitcmp1_b32 s34, 3
  s_cbranch_scc1 L_p72
  s_mov_b32 s38, 0
L_p71:
  buffer_load_dword v28, v31, s[88:91], 0 offen sc1
  s_add_u32 s38, s38, 1
  s_waitcnt vmcnt(0)
  v_cmp_eq_u32 vcc, v27, v28
  s_mov_b32 s34, vcc_lo
  s_cmp_ge_u32 s38, 262144
  s_cbranch_scc1 L_p72
  s_bitcmp1_b32 s34, 3
  s_cbranch_scc0 L_p71
L_p72:
  v_mfma_f32_16x16x32_bf16 v[160:163], v[184:187], a[76:79], v[160:163]
  ds_read_b64_tr_b16 v[178:179], v12 offset:33408
  v_and_b32 v2, 15, v24
  v_mfma_f32_16x16x32_bf16 v[144:147], v[188:191], a[72:75], v[144:147]
  ds_read_b64_tr_b16 v[180:181], v12 offset:35840
  buffer_load_dwordx4 a[128:131], v10, s[84:87], s68 offen offset:0 sc1
  v_mfma_f32_16x16x32_bf16 v[164:167], v[188:191], a[76:79], v[164:167]
  ds_read_b64_tr_b16 v[182:183], v12 offset:38400
  s_waitcnt vmcnt(11)
  s_waitcnt lgkmcnt(8)
  v_mfma_f32_16x16x32_bf16 v[128:131], v[192:195], a[80:83], v[128:131]
  ds_read_b64_tr_b16 v[184:185], v12 offset:35872
  v_mul_u32_u24 v2, 1280, v2
  v_mfma_f32_16x16x32_bf16 v[148:151], v[192:195], a[84:87], v[148:151]
  ds_read_b64_tr_b16 v[186:187], v12 offset:38432
  v_lshrrev_b32 v3, 4, v24
  v_mfma_f32_16x16x32_bf16 v[132:135], v[196:199], a[80:83], v[132:135]
  ds_read_b64_tr_b16 v[188:189], v12 offset:35904
  buffer_load_dwordx4 a[132:135], v10, s[84:87], s68 offen offset:1024 sc1
  v_mfma_f32_16x16x32_bf16 v[152:155], v[196:199], a[84:87], v[152:155]
  ds_read_b64_tr_b16 v[190:191], v12 offset:38464
  s_waitcnt lgkmcnt(8)
  v_mfma_f32_16x16x32_bf16 v[136:139], v[168:171], a[80:83], v[136:139]
  ds_read_b64_tr_b16 v[192:193], v12 offset:35936
  v_lshl_add_u32 v2, v3, 3, v2
  v_mfma_f32_16x16x32_bf16 v[156:159], v[168:171], a[84:87], v[156:159]
  ds_read_b64_tr_b16 v[194:195], v12 offset:38496
  v_mov_b32 v5, 0xfffcfffc
  v_mfma_f32_16x16x32_bf16 v[140:143], v[172:175], a[80:83], v[140:143]
  ds_read_b64_tr_b16 v[196:197], v12 offset:35968
  buffer_load_dwordx4 a[136:139], v10, s[84:87], s68 offen offset:2048 sc1
  v_mfma_f32_16x16x32_bf16 v[160:163], v[172:175], a[84:87], v[160:163]
  ds_read_b64_tr_b16 v[198:199], v12 offset:38528
  s_waitcnt lgkmcnt(8)
  v_mfma_f32_16x16x32_bf16 v[144:147], v[176:179], a[80:83], v[144:147]
  ds_read_b64_tr_b16 v[168:169], v12 offset:40960
  s_add_u32 s29, s33, 4096
  v_mfma_f32_16x16x32_bf16 v[164:167], v[176:179], a[84:87], v[164:167]
  ds_read_b64_tr_b16 v[170:171], v12 offset:43520
  s_mov_b32 s36, 0x00020002
  s_waitcnt vmcnt(11)
  v_mfma_f32_16x16x32_bf16 v[128:131], v[180:183], a[88:91], v[128:131]
  ds_read_b64_tr_b16 v[172:173], v12 offset:40992
  buffer_load_dwordx4 a[140:143], v10, s[84:87], s68 offen offset:3072 sc1
  v_mfma_f32_16x16x32_bf16 v[148:151], v[180:183], a[92:95], v[148:151]
  ds_read_b64_tr_b16 v[174:175], v12 offset:43552
  s_waitcnt lgkmcnt(8)
  v_mfma_f32_16x16x32_bf16 v[132:135], v[184:187], a[88:91], v[132:135]
  ds_read_b64_tr_b16 v[176:177], v12 offset:41024
  s_mov_b32 s37, 0
  v_mfma_f32_16x16x32_bf16 v[152:155], v[184:187], a[92:95], v[152:155]
  ds_read_b64_tr_b16 v[178:179], v12 offset:43584
  s_mov_b32 s26, 0
  v_mfma_f32_16x16x32_bf16 v[136:139], v[188:191], a[88:91], v[136:139]
  ds_read_b64_tr_b16 v[180:181], v12 offset:41056
  buffer_load_dwordx4 a[144:147], v10, s[84:87], s69 offen offset:0 sc1
  v_mfma_f32_16x16x32_bf16 v[156:159], v[188:191], a[92:95], v[156:159]
  ds_read_b64_tr_b16 v[182:183], v12 offset:43616
  s_waitcnt lgkmcnt(8)
  v_mfma_f32_16x16x32_bf16 v[140:143], v[192:195], a[88:91], v[140:143]
  ds_read_b64_tr_b16 v[184:185], v12 offset:41088
  s_lshl_b32 s27, s3, 10
  v_mfma_f32_16x16x32_bf16 v[160:163], v[192:195], a[92:95], v[160:163]
  ds_read_b64_tr_b16 v[186:187], v12 offset:43648
  v_add_u32 v3, s27, v10
  v_mfma_f32_16x16x32_bf16 v[144:147], v[196:199], a[88:91], v[144:147]
  ds_read_b64_tr_b16 v[188:189], v12 offset:46080
  buffer_load_dwordx4 a[148:151], v10, s[84:87], s69 offen offset:1024 sc1
  v_mfma_f32_16x16x32_bf16 v[164:167], v[196:199], a[92:95], v[164:167]
  ds_read_b64_tr_b16 v[190:191], v12 offset:48640
  s_waitcnt vmcnt(12)
  s_waitcnt lgkmcnt(8)
  v_mfma_f32_16x16x32_bf16 v[128:131], v[168:171], a[96:99], v[128:131]
  ds_read_b64_tr_b16 v[192:193], v12 offset:46112
  s_add_u32 s8, s74, s100
  s_addc_u32 s9, s75, 0
  v_mfma_f32_16x16x32_bf16 v[148:151], v[168:171], a[100:103], v[148:151]
  ds_read_b64_tr_b16 v[194:195], v12 offset:48672
  s_mov_b32 s10, s101
  v_mfma_f32_16x16x32_bf16 v[132:135], v[172:175], a[96:99], v[132:135]
  ds_read_b64_tr_b16 v[196:197], v12 offset:46144
  s_mov_b32 s11, 0x20000
  v_mfma_f32_16x16x32_bf16 v[152:155], v[172:175], a[100:103], v[152:155]
  ds_read_b64_tr_b16 v[198:199], v12 offset:48704
  s_waitcnt lgkmcnt(8)
  v_mfma_f32_16x16x32_bf16 v[136:139], v[176:179], a[96:99], v[136:139]
  ds_read_b64_tr_b16 v[168:169], v12 offset:46176
  buffer_load_dwordx4 a[152:155], v10, s[84:87], s69 offen offset:2048 sc1
  v_mfma_f32_16x16x32_bf16 v[156:159], v[176:179], a[100:103], v[156:159]
  ds_read_b64_tr_b16 v[170:171], v12 offset:48736
  s_and_b32 s80, s63, 3
  v_mfma_f32_16x16x32_bf16 v[140:143], v[180:183], a[96:99], v[140:143]
  ds_read_b64_tr_b16 v[172:173], v12 offset:46208
  s_and_b32 s81, s63, 3
  v_mfma_f32_16x16x32_bf16 v[160:163], v[180:183], a[100:103], v[160:163]
  ds_read_b64_tr_b16 v[174:175], v12 offset:48768
  s_waitcnt lgkmcnt(8)
  v_mfma_f32_16x16x32_bf16 v[144:147], v[184:187], a[96:99], v[144:147]
  ds_read_b64_tr_b16 v[176:177], v12 offset:51200
  buffer_load_dwordx4 a[156:159], v10, s[84:87], s69 offen offset:3072 sc1
  v_mfma_f32_16x16x32_bf16 v[164:167], v[184:187], a[100:103], v[164:167]
  ds_read_b64_tr_b16 v[178:179], v12 offset:53760
  s_and_b32 s82, s63, 3
  s_waitcnt vmcnt(12)
  v_mfma_f32_16x16x32_bf16 v[128:131], v[188:191], a[104:107], v[128:131]
  ds_read_b64_tr_b16 v[180:181], v12 offset:51232
  s_bitcmp1_b32 s34, 4
  s_cbranch_scc1 L_p74
  s_mov_b32 s38, 0
L_p73:
  buffer_load_dword v28, v31, s[88:91], 0 offen sc1
  s_add_u32 s38, s38, 1
  s_waitcnt vmcnt(0)
  v_cmp_eq_u32 vcc, v27, v28
  s_mov_b32 s34, vcc_lo
  s_cmp_ge_u32 s38, 262144
  s_cbranch_scc1 L_p74
  s_bitcmp1_b32 s34, 4
  s_cbranch_scc0 L_p73
L_p74:
  v_mfma_f32_16x16x32_bf16 v[148:151], v[188:191], a[108:111], v[148:151]
  ds_read_b64_tr_b16 v[182:183], v12 offset:53792
  s_waitcnt lgkmcnt(8)
  v_mfma_f32_16x16x32_bf16 v[132:135], v[192:195], a[104:107], v[132:135]
  ds_read_b64_tr_b16 v[184:185], v12 offset:51264
  buffer_load_dwordx4 a[0:3], v10, s[84:87], s70 offen offset:0 sc1
  v_mfma_f32_16x16x32_bf16 v[152:155], v[192:195], a[108:111], v[152:155]
  ds_read_b64_tr_b16 v[186:187], v12 offset:53824
  s_and_b32 s83, s63, 3
  v_mfma_f32_16x16x32_bf16 v[136:139], v[196:199], a[104:107], v[136:139]
  ds_read_b64_tr_b16 v[188:189], v12 offset:51296
  s_add_u32 s100, s5, 1
  v_mfma_f32_16x16x32_bf16 v[156:159], v[196:199], a[108:111], v[156:159]
  ds_read_b64_tr_b16 v[190:191], v12 offset:53856
  s_waitcnt lgkmcnt(8)
  v_mfma_f32_16x16x32_bf16 v[140:143], v[168:171], a[104:107], v[140:143]
  ds_read_b64_tr_b16 v[192:193], v12 offset:51328
  buffer_load_dwordx4 a[4:7], v10, s[84:87], s70 offen offset:1024 sc1
  v_mfma_f32_16x16x32_bf16 v[160:163], v[168:171], a[108:111], v[160:163]
  ds_read_b64_tr_b16 v[194:195], v12 offset:53888
  s_and_b32 s100, s100, 3
  v_mfma_f32_16x16x32_bf16 v[144:147], v[172:175], a[104:107], v[144:147]
  ds_read_b64_tr_b16 v[196:197], v12 offset:56320
  s_lshl_b32 s100, s100, 2
  v_mfma_f32_16x16x32_bf16 v[164:167], v[172:175], a[108:111], v[164:167]
  ds_read_b64_tr_b16 v[198:199], v12 offset:58880
  s_waitcnt vmcnt(12)
  s_waitcnt lgkmcnt(8)
  v_mfma_f32_16x16x32_bf16 v[128:131], v[176:179], a[112:115], v[128:131]
  ds_read_b64_tr_b16 v[168:169], v12 offset:56352
  buffer_load_dwordx4 a[8:11], v10, s[84:87], s70 offen offset:2048 sc1
  v_mfma_f32_16x16x32_bf16 v[148:151], v[176:179], a[116:119], v[148:151]
  ds_read_b64_tr_b16 v[170:171], v12 offset:58912
  s_add_u32 s100, s100, s5
  v_mfma_f32_16x16x32_bf16 v[132:135], v[180:183], a[112:115], v[132:135]
  ds_read_b64_tr_b16 v[172:173], v12 offset:56384
  s_mul_i32 s100, s100, 5120
  v_mfma_f32_16x16x32_bf16 v[152:155], v[180:183], a[116:119], v[152:155]
  ds_read_b64_tr_b16 v[174:175], v12 offset:58944
  s_waitcnt lgkmcnt(8)
  v_mfma_f32_16x16x32_bf16 v[136:139], v[184:187], a[112:115], v[136:139]
  ds_read_b64_tr_b16 v[176:177], v12 offset:56416
  buffer_load_dwordx4 a[12:15], v10, s[84:87], s70 offen offset:3072 sc1
  v_mfma_f32_16x16x32_bf16 v[156:159], v[184:187], a[116:119], v[156:159]
  ds_read_b64_tr_b16 v[178:179], v12 offset:58976
  s_add_u32 s13, s100, s27
  v_mfma_f32_16x16x32_bf16 v[140:143], v[188:191], a[112:115], v[140:143]
  ds_read_b64_tr_b16 v[180:181], v12 offset:56448
  s_add_u32 s17, s100, 4096
  v_mfma_f32_16x16x32_bf16 v[160:163], v[188:191], a[116:119], v[160:163]
  ds_read_b64_tr_b16 v[182:183], v12 offset:59008
  s_waitcnt lgkmcnt(8)
  v_mfma_f32_16x16x32_bf16 v[144:147], v[192:195], a[112:115], v[144:147]
  ds_read_b64_tr_b16 v[184:185], v13 offset:0
  buffer_load_dwordx4 a[16:19], v10, s[84:87], s71 offen offset:0 sc1
  v_mfma_f32_16x16x32_bf16 v[164:167], v[192:195], a[116:119], v[164:167]
  ds_read_b64_tr_b16 v[186:187], v13 offset:2560
  s_add_u32 s100, s5, 2
  s_waitcnt vmcnt(13)
  v_mfma_f32_16x16x32_bf16 v[128:131], v[196:199], a[120:123], v[128:131]
  ds_read_b64_tr_b16 v[188:189], v13 offset:32
  s_and_b32 s100, s100, 3
  v_mfma_f32_16x16x32_bf16 v[148:151], v[196:199], a[124:127], v[148:151]
  ds_read_b64_tr_b16 v[190:191], v13 offset:2592
  s_waitcnt lgkmcnt(8)
  v_mfma_f32_16x16x32_bf16 v[132:135], v[168:171], a[120:123], v[132:135]
  ds_read_b64_tr_b16 v[192:193], v13 offset:64
  buffer_load_dwordx4 a[20:23], v10, s[84:87], s71 offen offset:1024 sc1
  v_mfma_f32_16x16x32_bf16 v[152:155], v[168:171], a[124:127], v[152:155]
  ds_read_b64_tr_b16 v[194:195], v13 offset:2624
  s_lshl_b32 s100, s100, 2
  v_mfma_f32_16x16x32_bf16 v[136:139], v[172:175], a[120:123], v[136:139]
  ds_read_b64_tr_b16 v[196:197], v13 offset:96
  s_add_u32 s100, s100, s5
  v_mfma_f32_16x16x32_bf16 v[156:159], v[172:175], a[124:127], v[156:159]
  ds_read_b64_tr_b16 v[198:199], v13 offset:2656
  s_waitcnt lgkmcnt(8)
  v_mfma_f32_16x16x32_bf16 v[140:143], v[176:179], a[120:123], v[140:143]
  ds_read_b64_tr_b16 v[168:169], v13 offset:128
  buffer_load_dwordx4 a[24:27], v10, s[84:87], s71 offen offset:2048 sc1
  v_mfma_f32_16x16x32_bf16 v[160:163], v[176:179], a[124:127], v[160:163]
  ds_read_b64_tr_b16 v[170:171], v13 offset:2688
  s_mul_i32 s100, s100, 5120
  v_mfma_f32_16x16x32_bf16 v[144:147], v[180:183], a[120:123], v[144:147]
  ds_read_b64_tr_b16 v[172:173], v13 offset:5120
  s_add_u32 s14, s100, s27
  v_mfma_f32_16x16x32_bf16 v[164:167], v[180:183], a[124:127], v[164:167]
  ds_read_b64_tr_b16 v[174:175], v13 offset:7680
  s_waitcnt vmcnt(13)
  s_waitcnt lgkmcnt(8)
  v_mfma_f32_16x16x32_bf16 v[128:131], v[184:187], a[128:131], v[128:131]
  ds_read_b64_tr_b16 v[176:177], v13 offset:5152
  buffer_load_dwordx4 a[28:31], v10, s[84:87], s71 offen offset:3072 sc1
  v_mfma_f32_16x16x32_bf16 v[148:151], v[184:187], a[132:135], v[148:151]
  ds_read_b64_tr_b16 v[178:179], v13 offset:7712
  s_add_u32 s18, s100, 4096
  v_mfma_f32_16x16x32_bf16 v[132:135], v[188:191], a[128:131], v[132:135]
  ds_read_b64_tr_b16 v[180:181], v13 offset:5184
  s_add_u32 s100, s5, 3
  v_mfma_f32_16x16x32_bf16 v[152:155], v[188:191], a[132:135], v[152:155]
  ds_read_b64_tr_b16 v[182:183], v13 offset:7744
  s_waitcnt lgkmcnt(8)
  v_mfma_f32_16x16x32_bf16 v[136:139], v[192:195], a[128:131], v[136:139]
  ds_read_b64_tr_b16 v[184:185], v13 offset:5216
  s_bitcmp1_b32 s34, 5
  s_cbranch_scc1 L_p76
  s_mov_b32 s38, 0
L_p75:
  buffer_load_dword v28, v31, s[88:91], 0 offen sc1
  s_add_u32 s38, s38, 1
  s_waitcnt vmcnt(0)
  v_cmp_eq_u32 vcc, v27, v28
  s_mov_b32 s34, vcc_lo
  s_cmp_ge_u32 s38, 262144
  s_cbranch_scc1 L_p76
  s_bitcmp1_b32 s34, 5
  s_cbranch_scc0 L_p75
L_p76:
  v_mfma_f32_16x16x32_bf16 v[156:159], v[192:195], a[132:135], v[156:159]
  ds_read_b64_tr_b16 v[186:187], v13 offset:7776
  s_and_b32 s100, s100, 3
  v_mfma_f32_16x16x32_bf16 v[140:143], v[196:199], a[128:131], v[140:143]
  ds_read_b64_tr_b16 v[188:189], v13 offset:5248
  buffer_load_dwordx4 a[32:35], v10, s[84:87], s72 offen offset:0 sc1
  v_mfma_f32_16x16x32_bf16 v[160:163], v[196:199], a[132:135], v[160:163]
  ds_read_b64_tr_b16 v[190:191], v13 offset:7808
  s_waitcnt lgkmcnt(8)
  v_mfma_f32_16x16x32_bf16 v[144:147], v[168:171], a[128:131], v[144:147]
  ds_read_b64_tr_b16 v[192:193], v13 offset:10240
  s_lshl_b32 s100, s100, 2
  v_mfma_f32_16x16x32_bf16 v[164:167], v[168:171], a[132:135], v[164:167]
  ds_read_b64_tr_b16 v[194:195], v13 offset:12800
  s_add_u32 s100, s100, s5
  s_waitcnt vmcnt(13)
  v_mfma_f32_16x16x32_bf16 v[128:131], v[172:175], a[136:139], v[128:131]
  ds_read_b64_tr_b16 v[196:197], v13 offset:10272
  buffer_load_dwordx4 a[36:39], v10, s[84:87], s72 offen offset:1024 sc1
  v_mfma_f32_16x16x32_bf16 v[148:151], v[172:175], a[140:143], v[148:151]
  ds_read_b64_tr_b16 v[198:199], v13 offset:12832
  s_waitcnt lgkmcnt(8)
  v_mfma_f32_16x16x32_bf16 v[132:135], v[176:179], a[136:139], v[132:135]
  ds_read_b64_tr_b16 v[168:169], v13 offset:10304
  s_mul_i32 s100, s100, 5120
  v_mfma_f32_16x16x32_bf16 v[152:155], v[176:179], a[140:143], v[152:155]
  ds_read_b64_tr_b16 v[170:171], v13 offset:12864
  s_add_u32 s15, s100, s27
  v_mfma_f32_16x16x32_bf16 v[136:139], v[180:183], a[136:139], v[136:139]
  ds_read_b64_tr_b16 v[172:173], v13 offset:10336
  buffer_load_dwordx4 a[40:43], v10, s[84:87], s72 offen offset:2048 sc1
  v_mfma_f32_16x16x32_bf16 v[156:159], v[180:183], a[140:143], v[156:159]
  ds_read_b64_tr_b16 v[174:175], v13 offset:12896
  s_waitcnt lgkmcnt(8)
  v_mfma_f32_16x16x32_bf16 v[140:143], v[184:187], a[136:139], v[140:143]
  ds_read_b64_tr_b16 v[176:177], v13 offset:10368
  s_add_u32 s19, s100, 4096
  v_mfma_f32_16x16x32_bf16 v[160:163], v[184:187], a[140:143], v[160:163]
  ds_read_b64_tr_b16 v[178:179], v13 offset:12928
  s_lshl_b32 s12, s3, 5
  v_mfma_f32_16x16x32_bf16 v[144:147], v[188:191], a[136:139], v[144:147]
  ds_read_b64_tr_b16 v[180:181], v13 offset:15360
  buffer_load_dwordx4 a[44:47], v10, s[84:87], s72 offen offset:3072 sc1
  v_mfma_f32_16x16x32_bf16 v[164:167], v[188:191], a[140:143], v[164:167]
  ds_read_b64_tr_b16 v[182:183], v13 offset:17920
  s_waitcnt vmcnt(14)
  s_waitcnt lgkmcnt(8)
  v_mfma_f32_16x16x32_bf16 v[128:131], v[192:195], a[144:147], v[128:131]
  ds_read_b64_tr_b16 v[184:185], v13 offset:15392
  s_add_u32 s16, s12, 20480
  v_mfma_f32_16x16x32_bf16 v[148:151], v[192:195], a[148:151], v[148:151]
  ds_read_b64_tr_b16 v[186:187], v13 offset:17952
  s_movk_i32 s20, 20480
  v_mfma_f32_16x16x32_bf16 v[132:135], v[196:199], a[144:147], v[132:135]
  ds_read_b64_tr_b16 v[188:189], v13 offset:15424
  buffer_load_dwordx4 a[48:51], v10, s[84:87], s73 offen offset:0 sc1
  v_mfma_f32_16x16x32_bf16 v[152:155], v[196:199], a[148:151], v[152:155]
  ds_read_b64_tr_b16 v[190:191], v13 offset:17984
  s_waitcnt lgkmcnt(8)
  v_mfma_f32_16x16x32_bf16 v[136:139], v[168:171], a[144:147], v[136:139]
  ds_read_b64_tr_b16 v[192:193], v13 offset:15456
  v_mfma_f32_16x16x32_bf16 v[156:159], v[168:171], a[148:151], v[156:159]
  ds_read_b64_tr_b16 v[194:195], v13 offset:18016
  v_mfma_f32_16x16x32_bf16 v[140:143], v[172:175], a[144:147], v[140:143]
  ds_read_b64_tr_b16 v[196:197], v13 offset:15488
  buffer_load_dwordx4 a[52:55], v10, s[84:87], s73 offen offset:1024 sc1
  v_mfma_f32_16x16x32_bf16 v[160:163], v[172:175], a[148:151], v[160:163]
  ds_read_b64_tr_b16 v[198:199], v13 offset:18048
  s_waitcnt lgkmcnt(8)
  v_mfma_f32_16x16x32_bf16 v[144:147], v[176:179], a[144:147], v[144:147]
  ds_read_b64_tr_b16 v[168:169], v13 offset:20480
  v_mfma_f32_16x16x32_bf16 v[164:167], v[176:179], a[148:151], v[164:167]
  ds_read_b64_tr_b16 v[170:171], v13 offset:23040
  s_waitcnt vmcnt(14)
  v_mfma_f32_16x16x32_bf16 v[128:131], v[180:183], a[152:155], v[128:131]
  ds_read_b64_tr_b16 v[172:173], v13 offset:20512
  buffer_load_dwordx4 a[56:59], v10, s[84:87], s73 offen offset:2048 sc1
  v_mfma_f32_16x16x32_bf16 v[148:151], v[180:183], a[156:159], v[148:151]
  ds_read_b64_tr_b16 v[174:175], v13 offset:23072
  s_waitcnt lgkmcnt(8)
  v_mfma_f32_16x16x32_bf16 v[132:135], v[184:187], a[152:155], v[132:135]
  ds_read_b64_tr_b16 v[176:177], v13 offset:20544
  v_mfma_f32_16x16x32_bf16 v[152:155], v[184:187], a[156:159], v[152:155]
  ds_read_b64_tr_b16 v[178:179], v13 offset:23104
  v_mfma_f32_16x16x32_bf16 v[136:139], v[188:191], a[152:155], v[136:139]
  ds_read_b64_tr_b16 v[180:181], v13 offset:20576
  buffer_load_dwordx4 a[60:63], v10, s[84:87], s73 offen offset:3072 sc1
  v_mfma_f32_16x16x32_bf16 v[156:159], v[188:191], a[156:159], v[156:159]
  ds_read_b64_tr_b16 v[182:183], v13 offset:23136
  s_waitcnt lgkmcnt(8)
  v_mfma_f32_16x16x32_bf16 v[140:143], v[192:195], a[152:155], v[140:143]
  ds_read_b64_tr_b16 v[184:185], v13 offset:20608
  s_bitcmp1_b32 s34, 6
  s_cbranch_scc1 L_p78
  s_mov_b32 s38, 0
L_p77:
  buffer_load_dword v28, v31, s[88:91], 0 offen sc1
  s_add_u32 s38, s38, 1
  s_waitcnt vmcnt(0)
  v_cmp_eq_u32 vcc, v27, v28
  s_mov_b32 s34, vcc_lo
  s_cmp_ge_u32 s38, 262144
  s_cbranch_scc1 L_p78
  s_bitcmp1_b32 s34, 6
  s_cbranch_scc0 L_p77
L_p78:
  v_mfma_f32_16x16x32_bf16 v[160:163], v[192:195], a[156:159], v[160:163]
  ds_read_b64_tr_b16 v[186:187], v13 offset:23168
  v_mfma_f32_16x16x32_bf16 v[144:147], v[196:199], a[152:155], v[144:147]
  ds_read_b64_tr_b16 v[188:189], v13 offset:25600
  buffer_load_dwordx4 a[160:163], v10, s[84:87], s76 offen offset:0 sc1
  v_mfma_f32_16x16x32_bf16 v[164:167], v[196:199], a[156:159], v[164:167]
  ds_read_b64_tr_b16 v[190:191], v13 offset:28160
  s_waitcnt vmcnt(15)
  s_waitcnt lgkmcnt(8)
  v_mfma_f32_16x16x32_bf16 v[128:131], v[168:171], a[0:3], v[128:131]
  ds_read_b64_tr_b16 v[192:193], v13 offset:25632
  v_mfma_f32_16x16x32_bf16 v[148:151], v[168:171], a[4:7], v[148:151]
  ds_read_b64_tr_b16 v[194:195], v13 offset:28192
  v_mfma_f32_16x16x32_bf16 v[132:135], v[172:175], a[0:3], v[132:135]
  ds_read_b64_tr_b16 v[196:197], v13 offset:25664
  buffer_load_dwordx4 a[164:167], v10, s[84:87], s76 offen offset:1024 sc1
  v_mfma_f32_16x16x32_bf16 v[152:155], v[172:175], a[4:7], v[152:155]
  ds_read_b64_tr_b16 v[198:199], v13 offset:28224
  s_waitcnt lgkmcnt(8)
  v_mfma_f32_16x16x32_bf16 v[136:139], v[176:179], a[0:3], v[136:139]
  ds_read_b64_tr_b16 v[168:169], v13 offset:25696
  v_mfma_f32_16x16x32_bf16 v[156:159], v[176:179], a[4:7], v[156:159]
  ds_read_b64_tr_b16 v[170:171], v13 offset:28256
  v_mfma_f32_16x16x32_bf16 v[140:143], v[180:183], a[0:3], v[140:143]
  ds_read_b64_tr_b16 v[172:173], v13 offset:25728
  v_mfma_f32_16x16x32_bf16 v[160:163], v[180:183], a[4:7], v[160:163]
  ds_read_b64_tr_b16 v[174:175], v13 offset:28288
  s_waitcnt lgkmcnt(8)
  v_mfma_f32_16x16x32_bf16 v[144:147], v[184:187], a[0:3], v[144:147]
  ds_read_b64_tr_b16 v[176:177], v13 offset:30720
  buffer_load_dwordx4 a[168:171], v10, s[84:87], s76 offen offset:2048 sc1
  v_mfma_f32_16x16x32_bf16 v[164:167], v[184:187], a[4:7], v[164:167]
  ds_read_b64_tr_b16 v[178:179], v13 offset:33280
  s_waitcnt vmcnt(15)
  v_mfma_f32_16x16x32_bf16 v[128:131], v[188:191], a[8:11], v[128:131]
  ds_read_b64_tr_b16 v[180:181], v13 offset:30752
  v_mfma_f32_16x16x32_bf16 v[148:151], v[188:191], a[12:15], v[148:151]
  ds_read_b64_tr_b16 v[182:183], v13 offset:33312
  s_waitcnt lgkmcnt(8)
  v_mfma_f32_16x16x32_bf16 v[132:135], v[192:195], a[8:11], v[132:135]
  ds_read_b64_tr_b16 v[184:185], v13 offset:30784
  buffer_load_dwordx4 a[172:175], v10, s[84:87], s76 offen offset:3072 sc1
  v_mfma_f32_16x16x32_bf16 v[152:155], v[192:195], a[12:15], v[152:155]
  ds_read_b64_tr_b16 v[186:187], v13 offset:33344
  v_mfma_f32_16x16x32_bf16 v[136:139], v[196:199], a[8:11], v[136:139]
  ds_read_b64_tr_b16 v[188:189], v13 offset:30816
  v_mfma_f32_16x16x32_bf16 v[156:159], v[196:199], a[12:15], v[156:159]
  ds_read_b64_tr_b16 v[190:191], v13 offset:33376
  s_waitcnt lgkmcnt(8)
  v_mfma_f32_16x16x32_bf16 v[140:143], v[168:171], a[8:11], v[140:143]
  ds_read_b64_tr_b16 v[192:193], v13 offset:30848
  buffer_load_dwordx4 a[176:179], v10, s[84:87], s77 offen offset:0 sc1
  v_mfma_f32_16x16x32_bf16 v[160:163], v[168:171], a[12:15], v[160:163]
  ds_read_b64_tr_b16 v[194:195], v13 offset:33408
  v_mfma_f32_16x16x32_bf16 v[144:147], v[172:175], a[8:11], v[144:147]
  ds_read_b64_tr_b16 v[196:197], v13 offset:35840
  v_mfma_f32_16x16x32_bf16 v[164:167], v[172:175], a[12:15], v[164:167]
  ds_read_b64_tr_b16 v[198:199], v13 offset:38400
  s_waitcnt vmcnt(15)
  s_waitcnt lgkmcnt(8)
  v_mfma_f32_16x16x32_bf16 v[128:131], v[176:179], a[16:19], v[128:131]
  ds_read_b64_tr_b16 v[168:169], v13 offset:35872
  buffer_load_dwordx4 a[180:183], v10, s[84:87], s77 offen offset:1024 sc1
  v_mfma_f32_16x16x32_bf16 v[148:151], v[176:179], a[20:23], v[148:151]
  ds_read_b64_tr_b16 v[170:171], v13 offset:38432
  v_mfma_f32_16x16x32_bf16 v[132:135], v[180:183], a[16:19], v[132:135]
  ds_read_b64_tr_b16 v[172:173], v13 offset:35904
  v_mfma_f32_16x16x32_bf16 v[152:155], v[180:183], a[20:23], v[152:155]
  ds_read_b64_tr_b16 v[174:175], v13 offset:38464
  s_waitcnt lgkmcnt(8)
  v_mfma_f32_16x16x32_bf16 v[136:139], v[184:187], a[16:19], v[136:139]
  ds_read_b64_tr_b16 v[176:177], v13 offset:35936
  buffer_load_dwordx4 a[184:187], v10, s[84:87], s77 offen offset:2048 sc1
  v_mfma_f32_16x16x32_bf16 v[156:159], v[184:187], a[20:23], v[156:159]
  ds_read_b64_tr_b16 v[178:179], v13 offset:38496
  v_mfma_f32_16x16x32_bf16 v[140:143], v[188:191], a[16:19], v[140:143]
  ds_read_b64_tr_b16 v[180:181], v13 offset:35968
  v_mfma_f32_16x16x32_bf16 v[160:163], v[188:191], a[20:23], v[160:163]
  ds_read_b64_tr_b16 v[182:183], v13 offset:38528
  s_waitcnt lgkmcnt(8)
  v_mfma_f32_16x16x32_bf16 v[144:147], v[192:195], a[16:19], v[144:147]
  ds_read_b64_tr_b16 v[184:185], v13 offset:40960
  buffer_load_dwordx4 a[188:191], v10, s[84:87], s77 offen offset:3072 sc1
  v_mfma_f32_16x16x32_bf16 v[164:167], v[192:195], a[20:23], v[164:167]
  ds_read_b64_tr_b16 v[186:187], v13 offset:43520
  s_waitcnt vmcnt(16)
  v_mfma_f32_16x16x32_bf16 v[128:131], v[196:199], a[24:27], v[128:131]
  ds_read_b64_tr_b16 v[188:189], v13 offset:40992
  s_bitcmp1_b32 s34, 7
  s_cbranch_scc1 L_p80
  s_mov_b32 s38, 0
L_p79:
  buffer_load_dword v28, v31, s[88:91], 0 offen sc1
  s_add_u32 s38, s38, 1
  s_waitcnt vmcnt(0)
  v_cmp_eq_u32 vcc, v27, v28
  s_mov_b32 s34, vcc_lo
  s_cmp_ge_u32 s38, 262144
  s_cbranch_scc1 L_p80
  s_bitcmp1_b32 s34, 7
  s_cbranch_scc0 L_p79
L_p80:
  v_mfma_f32_16x16x32_bf16 v[148:151], v[196:199], a[28:31], v[148:151]
  ds_read_b64_tr_b16 v[190:191], v13 offset:43552
  s_waitcnt lgkmcnt(8)
  v_mfma_f32_16x16x32_bf16 v[132:135], v[168:171], a[24:27], v[132:135]
  ds_read_b64_tr_b16 v[192:193], v13 offset:41024
  buffer_load_dwordx4 a[192:195], v10, s[84:87], s39 offen offset:0 sc1
  v_mfma_f32_16x16x32_bf16 v[152:155], v[168:171], a[28:31], v[152:155]
  ds_read_b64_tr_b16 v[194:195], v13 offset:43584
  v_mfma_f32_16x16x32_bf16 v[136:139], v[172:175], a[24:27], v[136:139]
  ds_read_b64_tr_b16 v[196:197], v13 offset:41056
  v_mfma_f32_16x16x32_bf16 v[156:159], v[172:175], a[28:31], v[156:159]
  ds_read_b64_tr_b16 v[198:199], v13 offset:43616
  s_waitcnt lgkmcnt(8)
  v_mfma_f32_16x16x32_bf16 v[140:143], v[176:179], a[24:27], v[140:143]
  ds_read_b64_tr_b16 v[168:169], v13 offset:41088
  buffer_load_dwordx4 a[196:199], v10, s[84:87], s39 offen offset:1024 sc1
  v_mfma_f32_16x16x32_bf16 v[160:163], v[176:179], a[28:31], v[160:163]
  ds_read_b64_tr_b16 v[170:171], v13 offset:43648
  v_mfma_f32_16x16x32_bf16 v[144:147], v[180:183], a[24:27], v[144:147]
  ds_read_b64_tr_b16 v[172:173], v13 offset:46080
  v_mfma_f32_16x16x32_bf16 v[164:167], v[180:183], a[28:31], v[164:167]
  ds_read_b64_tr_b16 v[174:175], v13 offset:48640
  s_waitcnt vmcnt(16)
  s_waitcnt lgkmcnt(8)
  v_mfma_f32_16x16x32_bf16 v[128:131], v[184:187], a[32:35], v[128:131]
  ds_read_b64_tr_b16 v[176:177], v13 offset:46112
  buffer_load_dwordx4 a[200:203], v10, s[84:87], s39 offen offset:2048 sc1
  v_mfma_f32_16x16x32_bf16 v[148:151], v[184:187], a[36:39], v[148:151]
  ds_read_b64_tr_b16 v[178:179], v13 offset:48672
  v_mfma_f32_16x16x32_bf16 v[132:135], v[188:191], a[32:35], v[132:135]
  ds_read_b64_tr_b16 v[180:181], v13 offset:46144
  v_mfma_f32_16x16x32_bf16 v[152:155], v[188:191], a[36:39], v[152:155]
  ds_read_b64_tr_b16 v[182:183], v13 offset:48704
  s_waitcnt lgkmcnt(8)
  v_mfma_f32_16x16x32_bf16 v[136:139], v[192:195], a[32:35], v[136:139]
  ds_read_b64_tr_b16 v[184:185], v13 offset:46176
  buffer_load_dwordx4 a[204:207], v10, s[84:87], s39 offen offset:3072 sc1
  v_mfma_f32_16x16x32_bf16 v[156:159], v[192:195], a[36:39], v[156:159]
  ds_read_b64_tr_b16 v[186:187], v13 offset:48736
  v_mfma_f32_16x16x32_bf16 v[140:143], v[196:199], a[32:35], v[140:143]
  ds_read_b64_tr_b16 v[188:189], v13 offset:46208
  v_mfma_f32_16x16x32_bf16 v[160:163], v[196:199], a[36:39], v[160:163]
  ds_read_b64_tr_b16 v[190:191], v13 offset:48768
  s_waitcnt lgkmcnt(8)
  v_mfma_f32_16x16x32_bf16 v[144:147], v[168:171], a[32:35], v[144:147]
  ds_read_b64_tr_b16 v[192:193], v13 offset:51200
  v_mfma_f32_16x16x32_bf16 v[164:167], v[168:171], a[36:39], v[164:167]
  ds_read_b64_tr_b16 v[194:195], v13 offset:53760
  s_waitcnt vmcnt(16)
  v_mfma_f32_16x16x32_bf16 v[128:131], v[172:175], a[40:43], v[128:131]
  ds_read_b64_tr_b16 v[196:197], v13 offset:51232
  buffer_load_dwordx4 a[208:211], v10, s[84:87], s31 offen offset:0 sc1
  v_mfma_f32_16x16x32_bf16 v[148:151], v[172:175], a[44:47], v[148:151]
  ds_read_b64_tr_b16 v[198:199], v13 offset:53792
  s_waitcnt lgkmcnt(8)
  v_mfma_f32_16x16x32_bf16 v[132:135], v[176:179], a[40:43], v[132:135]
  ds_read_b64_tr_b16 v[168:169], v13 offset:51264
  v_mfma_f32_16x16x32_bf16 v[152:155], v[176:179], a[44:47], v[152:155]
  ds_read_b64_tr_b16 v[170:171], v13 offset:53824
  v_mfma_f32_16x16x32_bf16 v[136:139], v[180:183], a[40:43], v[136:139]
  ds_read_b64_tr_b16 v[172:173], v13 offset:51296
  buffer_load_dwordx4 a[212:215], v10, s[84:87], s31 offen offset:1024 sc1
  v_mfma_f32_16x16x32_bf16 v[156:159], v[180:183], a[44:47], v[156:159]
  ds_read_b64_tr_b16 v[174:175], v13 offset:53856
  s_waitcnt lgkmcnt(8)
  v_mfma_f32_16x16x32_bf16 v[140:143], v[184:187], a[40:43], v[140:143]
  ds_read_b64_tr_b16 v[176:177], v13 offset:51328
  v_mfma_f32_16x16x32_bf16 v[160:163], v[184:187], a[44:47], v[160:163]
  ds_read_b64_tr_b16 v[178:179], v13 offset:53888
  v_mfma_f32_16x16x32_bf16 v[144:147], v[188:191], a[40:43], v[144:147]
  ds_read_b64_tr_b16 v[180:181], v13 offset:56320
  buffer_load_dwordx4 a[216:219], v10, s[84:87], s31 offen offset:2048 sc1
  v_mfma_f32_16x16x32_bf16 v[164:167], v[188:191], a[44:47], v[164:167]
  ds_read_b64_tr_b16 v[182:183], v13 offset:58880
  s_waitcnt vmcnt(17)
  s_waitcnt lgkmcnt(8)
  v_mfma_f32_16x16x32_bf16 v[128:131], v[192:195], a[48:51], v[128:131]
  ds_read_b64_tr_b16 v[184:185], v13 offset:56352
  v_mfma_f32_16x16x32_bf16 v[148:151], v[192:195], a[52:55], v[148:151]
  ds_read_b64_tr_b16 v[186:187], v13 offset:58912
  v_mfma_f32_16x16x32_bf16 v[132:135], v[196:199], a[48:51], v[132:135]
  ds_read_b64_tr_b16 v[188:189], v13 offset:56384
  buffer_load_dwordx4 a[220:223], v10, s[84:87], s31 offen offset:3072 sc1
  v_mfma_f32_16x16x32_bf16 v[152:155], v[196:199], a[52:55], v[152:155]
  ds_read_b64_tr_b16 v[190:191], v13 offset:58944
  s_waitcnt lgkmcnt(8)
  v_mfma_f32_16x16x32_bf16 v[136:139], v[168:171], a[48:51], v[136:139]
  ds_read_b64_tr_b16 v[192:193], v13 offset:56416
  v_mfma_f32_16x16x32_bf16 v[156:159], v[168:171], a[52:55], v[156:159]
  ds_read_b64_tr_b16 v[194:195], v13 offset:58976
  v_mfma_f32_16x16x32_bf16 v[140:143], v[172:175], a[48:51], v[140:143]
  ds_read_b64_tr_b16 v[196:197], v13 offset:56448
  v_mfma_f32_16x16x32_bf16 v[160:163], v[172:175], a[52:55], v[160:163]
  ds_read_b64_tr_b16 v[198:199], v13 offset:59008
  s_waitcnt lgkmcnt(8)
  v_mfma_f32_16x16x32_bf16 v[144:147], v[176:179], a[48:51], v[144:147]
  ds_read_b64_tr_b16 v[168:169], v14 offset:0
  v_mfma_f32_16x16x32_bf16 v[164:167], v[176:179], a[52:55], v[164:167]
  ds_read_b64_tr_b16 v[170:171], v14 offset:2560
  s_waitcnt vmcnt(16)
  v_mfma_f32_16x16x32_bf16 v[128:131], v[180:183], a[56:59], v[128:131]
  ds_read_b64_tr_b16 v[172:173], v14 offset:5120
  v_mfma_f32_16x16x32_bf16 v[148:151], v[180:183], a[60:63], v[148:151]
  ds_read_b64_tr_b16 v[174:175], v14 offset:7680
  s_waitcnt lgkmcnt(8)
  v_mfma_f32_16x16x32_bf16 v[132:135], v[184:187], a[56:59], v[132:135]
  ds_read_b64_tr_b16 v[176:177], v14 offset:10240
  v_mfma_f32_16x16x32_bf16 v[152:155], v[184:187], a[60:63], v[152:155]
  ds_read_b64_tr_b16 v[178:179], v14 offset:12800
  v_mfma_f32_16x16x32_bf16 v[136:139], v[188:191], a[56:59], v[136:139]
  ds_read_b64_tr_b16 v[180:181], v14 offset:15360
  v_mfma_f32_16x16x32_bf16 v[156:159], v[188:191], a[60:63], v[156:159]
  ds_read_b64_tr_b16 v[182:183], v14 offset:17920
  s_waitcnt lgkmcnt(8)
  v_mfma_f32_16x16x32_bf16 v[140:143], v[192:195], a[56:59], v[140:143]
  ds_read_b64_tr_b16 v[184:185], v14 offset:20480
  v_mfma_f32_16x16x32_bf16 v[160:163], v[192:195], a[60:63], v[160:163]
  ds_read_b64_tr_b16 v[186:187], v14 offset:23040
  v_mfma_f32_16x16x32_bf16 v[144:147], v[196:199], a[56:59], v[144:147]
  ds_read_b64_tr_b16 v[188:189], v14 offset:25600
  v_mfma_f32_16x16x32_bf16 v[164:167], v[196:199], a[60:63], v[164:167]
  ds_read_b64_tr_b16 v[190:191], v14 offset:28160
  s_waitcnt vmcnt(14)
  s_waitcnt lgkmcnt(8)
  v_mfma_f32_16x16x32_bf16 v[128:131], v[168:171], a[160:163], v[128:131]
  ds_read_b64_tr_b16 v[192:193], v14 offset:30720
  v_mfma_f32_16x16x32_bf16 v[148:151], v[168:171], a[164:167], v[148:151]
  ds_read_b64_tr_b16 v[194:195], v14 offset:33280
  v_max3_f32 v25, |v132|, |v133|, |v134|
  v_max3_f32 v25, v25, |v135|, |v152|
  v_max3_f32 v25, v25, |v153|, |v154|
  s_waitcnt vmcnt(12)
  v_mfma_f32_16x16x32_bf16 v[128:131], v[172:175], a[168:171], v[128:131]
  ds_read_b64_tr_b16 v[196:197], v14 offset:35840
  v_max_f32_e64 v25, v25, |v155|
  s_nop 0
  v_readlane_b32 s71, v25, 0
  v_mfma_f32_16x16x32_bf16 v[148:151], v[172:175], a[172:175], v[148:151]
  ds_read_b64_tr_b16 v[198:199], v14 offset:38400
  v_readlane_b32 s72, v25, 21
  v_readlane_b32 s73, v25, 42
  s_waitcnt vmcnt(10)
  s_waitcnt lgkmcnt(8)
  v_mfma_f32_16x16x32_bf16 v[128:131], v[176:179], a[176:179], v[128:131]
  ds_read_b64_tr_b16 v[168:169], v14 offset:32
  v_readlane_b32 s100, v25, 63
  s_max_u32 s71, s71, s72
  v_mfma_f32_16x16x32_bf16 v[148:151], v[176:179], a[180:183], v[148:151]
  ds_read_b64_tr_b16 v[170:171], v14 offset:2592
  s_max_u32 s73, s73, s100
  s_max_u32 s71, s71, s73
  s_waitcnt vmcnt(8)
  v_mfma_f32_16x16x32_bf16 v[128:131], v[180:183], a[184:187], v[128:131]
  ds_read_b64_tr_b16 v[172:173], v14 offset:5152
  s_lshr_b32 s71, s71, 23
  s_max_u32 s71, s71, 1
  v_mfma_f32_16x16x32_bf16 v[148:151], v[180:183], a[188:191], v[148:151]
  ds_read_b64_tr_b16 v[174:175], v14 offset:7712
  s_min_u32 s71, s71, 239
  s_sub_u32 s64, 254, s71
  s_waitcnt vmcnt(6)
  s_waitcnt lgkmcnt(8)
  v_mfma_f32_16x16x32_bf16 v[128:131], v[184:187], a[192:195], v[128:131]
  ds_read_b64_tr_b16 v[176:177], v14 offset:10272
  s_lshl_b32 s64, s64, 23
  s_add_u32 s65, s71, 15
  v_mfma_f32_16x16x32_bf16 v[148:151], v[184:187], a[196:199], v[148:151]
  ds_read_b64_tr_b16 v[178:179], v14 offset:12832
  s_lshl_b32 s65, s65, 23
  s_sub_i32 s66, s71, 8
  s_waitcnt vmcnt(4)
  v_mfma_f32_16x16x32_bf16 v[128:131], v[188:191], a[200:203], v[128:131]
  ds_read_b64_tr_b16 v[180:181], v14 offset:15392
  s_max_i32 s66, s66, 0
  s_lshl_b32 s66, s66, 23
  v_mfma_f32_16x16x32_bf16 v[148:151], v[188:191], a[204:207], v[148:151]
  ds_read_b64_tr_b16 v[182:183], v14 offset:17952
  s_bfe_u32 s72, s71, 131072
  s_lshl_b32 s72, s72, 16
  s_waitcnt vmcnt(2)
  s_waitcnt lgkmcnt(8)
  v_mfma_f32_16x16x32_bf16 v[128:131], v[192:195], a[208:211], v[128:131]
  ds_read_b64_tr_b16 v[184:185], v14 offset:20512
  s_or_b32 s67, s72, s80
  s_bfe_u32 s72, s71, 131074
  v_mfma_f32_16x16x32_bf16 v[148:151], v[192:195], a[212:215], v[148:151]
  ds_read_b64_tr_b16 v[186:187], v14 offset:23072
  s_lshl_b32 s72, s72, 16
  s_or_b32 s68, s72, s81
  s_waitcnt vmcnt(0)
  v_mfma_f32_16x16x32_bf16 v[128:131], v[196:199], a[216:219], v[128:131]
  ds_read_b64_tr_b16 v[188:189], v14 offset:25632
  s_bfe_u32 s72, s71, 131076
  s_lshl_b32 s72, s72, 16
  v_mfma_f32_16x16x32_bf16 v[148:151], v[196:199], a[220:223], v[148:151]
  ds_read_b64_tr_b16 v[190:191], v14 offset:28192
  s_or_b32 s69, s72, s82
  s_bfe_u32 s72, s71, 131078
  s_waitcnt lgkmcnt(8)
  v_mfma_f32_16x16x32_bf16 v[132:135], v[168:171], a[160:163], v[132:135]
  ds_read_b64_tr_b16 v[192:193], v14 offset:30752
  s_lshl_b32 s72, s72, 16
  s_or_b32 s70, s72, s83
  v_mfma_f32_16x16x32_bf16 v[152:155], v[168:171], a[164:167], v[152:155]
  ds_read_b64_tr_b16 v[194:195], v14 offset:33312
  v_mfma_f32_16x16x32_bf16 v[132:135], v[172:175], a[168:171], v[132:135]
  ds_read_b64_tr_b16 v[196:197], v14 offset:35872
  v_max3_f32 v25, |v128|, |v129|, |v130|
  v_max3_f32 v25, v25, |v131|, |v148|
  v_mfma_f32_16x16x32_bf16 v[152:155], v[172:175], a[172:175], v[152:155]
  ds_read_b64_tr_b16 v[198:199], v14 offset:38432
  v_max3_f32 v25, v25, |v149|, |v150|
  s_waitcnt lgkmcnt(8)
  v_mfma_f32_16x16x32_bf16 v[132:135], v[176:179], a[176:179], v[132:135]
  ds_read_b64_tr_b16 v[168:169], v14 offset:64
  v_max_f32_e64 v25, v25, |v151|
  v_cmp_le_f32 vcc, s65, v25
  v_mfma_f32_16x16x32_bf16 v[152:155], v[176:179], a[180:183], v[152:155]
  ds_read_b64_tr_b16 v[170:171], v14 offset:2624
  v_cmp_le_f32 s[72:73], s66, v25
  v_mfma_f32_16x16x32_bf16 v[132:135], v[180:183], a[184:187], v[132:135]
  ds_read_b64_tr_b16 v[172:173], v14 offset:5184
  s_cmp_lg_u64 vcc, 0
  s_cbranch_scc1 L_xr51
  s_cmp_eq_u64 s[72:73], 0
  s_cbranch_scc1 L_xr51
L_xb52:
  v_fma_mixlo_f16 v200, v128, s64, 0
  v_mfma_f32_16x16x32_bf16 v[152:155], v[180:183], a[188:191], v[152:155]
  ds_read_b64_tr_b16 v[174:175], v14 offset:7744
  v_fma_mixlo_f16 v201, v130, s64, 0
  s_waitcnt lgkmcnt(8)
  v_mfma_f32_16x16x32_bf16 v[132:135], v[184:187], a[192:195], v[132:135]
  ds_read_b64_tr_b16 v[176:177], v14 offset:10304
  v_fma_mixlo_f16 v202, v148, s64, 0
  v_mfma_f32_16x16x32_bf16 v[152:155], v[184:187], a[196:199], v[152:155]
  ds_read_b64_tr_b16 v[178:179], v14 offset:12864
  v_fma_mixlo_f16 v203, v150, s64, 0
  v_fma_mixhi_f16 v200, v129, s64, 0
  v_mfma_f32_16x16x32_bf16 v[132:135], v[188:191], a[200:203], v[132:135]
  ds_read_b64_tr_b16 v[180:181], v14 offset:15424
  v_fma_mixhi_f16 v201, v131, s64, 0
  v_mfma_f32_16x16x32_bf16 v[152:155], v[188:191], a[204:207], v[152:155]
  ds_read_b64_tr_b16 v[182:183], v14 offset:17984
  v_fma_mixhi_f16 v202, v149, s64, 0
  v_fma_mixhi_f16 v203, v151, s64, 0
  s_waitcnt lgkmcnt(8)
  v_mfma_f32_16x16x32_bf16 v[132:135], v[192:195], a[208:211], v[132:135]
  ds_read_b64_tr_b16 v[184:185], v14 offset:20544
  v_and_or_b32 v200, v200, v5, s67
  v_mfma_f32_16x16x32_bf16 v[152:155], v[192:195], a[212:215], v[152:155]
  ds_read_b64_tr_b16 v[186:187], v14 offset:23104
  v_and_or_b32 v201, v201, v5, s68
  v_and_or_b32 v202, v202, v5, s69
  v_mfma_f32_16x16x32_bf16 v[132:135], v[196:199], a[216:219], v[132:135]
  ds_read_b64_tr_b16 v[188:189], v14 offset:25664
  v_and_or_b32 v203, v203, v5, s70
  v_mfma_f32_16x16x32_bf16 v[152:155], v[196:199], a[220:223], v[152:155]
  ds_read_b64_tr_b16 v[190:191], v14 offset:28224
  s_cmp_eq_u32 s3, s5
  s_cbranch_scc1 L_x49
  buffer_store_dwordx4 v[200:203], v10, s[96:99], s33 offen offset:0 sc1
  s_branch L_x50
L_x49:
  ds_write_b128 v10, v[128:131] offset:0
  ds_write_b128 v10, v[148:151] offset:5120
L_x50:
  s_waitcnt lgkmcnt(8)
  v_mfma_f32_16x16x32_bf16 v[136:139], v[168:171], a[160:163], v[136:139]
  ds_read_b64_tr_b16 v[192:193], v14 offset:30784
  v_mfma_f32_16x16x32_bf16 v[156:159], v[168:171], a[164:167], v[156:159]
  ds_read_b64_tr_b16 v[194:195], v14 offset:33344
  v_mfma_f32_16x16x32_bf16 v[136:139], v[172:175], a[168:171], v[136:139]
  ds_read_b64_tr_b16 v[196:197], v14 offset:35904
  v_max3_f32 v25, |v132|, |v133|, |v134|
  v_max3_f32 v25, v25, |v135|, |v152|
  v_mfma_f32_16x16x32_bf16 v[156:159], v[172:175], a[172:175], v[156:159]
  ds_read_b64_tr_b16 v[198:199], v14 offset:38464
  v_max3_f32 v25, v25, |v153|, |v154|
  s_waitcnt lgkmcnt(8)
  v_mfma_f32_16x16x32_bf16 v[136:139], v[176:179], a[176:179], v[136:139]
  ds_read_b64_tr_b16 v[168:169], v14 offset:96
  v_max_f32_e64 v25, v25, |v155|
  v_cmp_le_f32 vcc, s65, v25
  v_mfma_f32_16x16x32_bf16 v[156:159], v[176:179], a[180:183], v[156:159]
  ds_read_b64_tr_b16 v[170:171], v14 offset:2656
  v_cmp_le_f32 s[72:73], s66, v25
  v_mfma_f32_16x16x32_bf16 v[136:139], v[180:183], a[184:187], v[136:139]
  ds_read_b64_tr_b16 v[172:173], v14 offset:5216
  s_cmp_lg_u64 vcc, 0
  s_cbranch_scc1 L_xr55
  s_cmp_eq_u64 s[72:73], 0
  s_cbranch_scc1 L_xr55
L_xb56:
  v_fma_mixlo_f16 v204, v132, s64, 0
  v_mfma_f32_16x16x32_bf16 v[156:159], v[180:183], a[188:191], v[156:159]
  ds_read_b64_tr_b16 v[174:175], v14 offset:7776
  v_fma_mixlo_f16 v205, v134, s64, 0
  s_waitcnt lgkmcnt(8)
  v_mfma_f32_16x16x32_bf16 v[136:139], v[184:187], a[192:195], v[136:139]
  ds_read_b64_tr_b16 v[176:177], v14 offset:10336
  v_fma_mixlo_f16 v206, v152, s64, 0
  v_mfma_f32_16x16x32_bf16 v[156:159], v[184:187], a[196:199], v[156:159]
  ds_read_b64_tr_b16 v[178:179], v14 offset:12896
  v_fma_mixlo_f16 v207, v154, s64, 0
  v_fma_mixhi_f16 v204, v133, s64, 0
  v_mfma_f32_16x16x32_bf16 v[136:139], v[188:191], a[200:203], v[136:139]
  ds_read_b64_tr_b16 v[180:181], v14 offset:15456
  v_fma_mixhi_f16 v205, v135, s64, 0
  v_mfma_f32_16x16x32_bf16 v[156:159], v[188:191], a[204:207], v[156:159]
  ds_read_b64_tr_b16 v[182:183], v14 offset:18016
  v_fma_mixhi_f16 v206, v153, s64, 0
  v_fma_mixhi_f16 v207, v155, s64, 0
  s_waitcnt lgkmcnt(8)
  v_mfma_f32_16x16x32_bf16 v[136:139], v[192:195], a[208:211], v[136:139]
  ds_read_b64_tr_b16 v[184:185], v14 offset:20576
  v_and_or_b32 v204, v204, v5, s67
  v_mfma_f32_16x16x32_bf16 v[156:159], v[192:195], a[212:215], v[156:159]
  ds_read_b64_tr_b16 v[186:187], v14 offset:23136
  v_and_or_b32 v205, v205, v5, s68
  v_and_or_b32 v206, v206, v5, s69
  v_mfma_f32_16x16x32_bf16 v[136:139], v[196:199], a[216:219], v[136:139]
  ds_read_b64_tr_b16 v[188:189], v14 offset:25696
  v_and_or_b32 v207, v207, v5, s70
  v_mfma_f32_16x16x32_bf16 v[156:159], v[196:199], a[220:223], v[156:159]
  ds_read_b64_tr_b16 v[190:191], v14 offset:28256
  s_cmp_eq_u32 s3, s5
  s_cbranch_scc1 L_x53
  buffer_store_dwordx4 v[204:207], v10, s[96:99], s33 offen offset:1024 sc1
  s_branch L_x54
L_x53:
  ds_write_b128 v10, v[132:135] offset:1024
  ds_write_b128 v10, v[152:155] offset:6144
L_x54:
  s_waitcnt lgkmcnt(8)
  v_mfma_f32_16x16x32_bf16 v[140:143], v[168:171], a[160:163], v[140:143]
  ds_read_b64_tr_b16 v[192:193], v14 offset:30816
  v_mfma_f32_16x16x32_bf16 v[160:163], v[168:171], a[164:167], v[160:163]
  ds_read_b64_tr_b16 v[194:195], v14 offset:33376
  v_mfma_f32_16x16x32_bf16 v[140:143], v[172:175], a[168:171], v[140:143]
  ds_read_b64_tr_b16 v[196:197], v14 offset:35936
  v_max3_f32 v25, |v136|, |v137|, |v138|
  v_max3_f32 v25, v25, |v139|, |v156|
  v_mfma_f32_16x16x32_bf16 v[160:163], v[172:175], a[172:175], v[160:163]
  ds_read_b64_tr_b16 v[198:199], v14 offset:38496
  v_max3_f32 v25, v25, |v157|, |v158|
  s_waitcnt lgkmcnt(8)
  v_mfma_f32_16x16x32_bf16 v[140:143], v[176:179], a[176:179], v[140:143]
  ds_read_b64_tr_b16 v[168:169], v14 offset:128
  v_max_f32_e64 v25, v25, |v159|
  v_cmp_le_f32 vcc, s65, v25
  v_mfma_f32_16x16x32_bf16 v[160:163], v[176:179], a[180:183], v[160:163]
  ds_read_b64_tr_b16 v[170:171], v14 offset:2688
  v_cmp_le_f32 s[72:73], s66, v25
  v_mfma_f32_16x16x32_bf16 v[140:143], v[180:183], a[184:187], v[140:143]
  ds_read_b64_tr_b16 v[172:173], v14 offset:5248
  s_cmp_lg_u64 vcc, 0
  s_cbranch_scc1 L_xr59
  s_cmp_eq_u64 s[72:73], 0
  s_cbranch_scc1 L_xr59
L_xb60:
  v_fma_mixlo_f16 v208, v136, s64, 0
  v_mfma_f32_16x16x32_bf16 v[160:163], v[180:183], a[188:191], v[160:163]
  ds_read_b64_tr_b16 v[174:175], v14 offset:7808
  v_fma_mixlo_f16 v209, v138, s64, 0
  s_waitcnt lgkmcnt(8)
  v_mfma_f32_16x16x32_bf16 v[140:143], v[184:187], a[192:195], v[140:143]
  ds_read_b64_tr_b16 v[176:177], v14 offset:10368
  v_fma_mixlo_f16 v210, v156, s64, 0
  v_mfma_f32_16x16x32_bf16 v[160:163], v[184:187], a[196:199], v[160:163]
  ds_read_b64_tr_b16 v[178:179], v14 offset:12928
  v_fma_mixlo_f16 v211, v158, s64, 0
  v_fma_mixhi_f16 v208, v137, s64, 0
  v_mfma_f32_16x16x32_bf16 v[140:143], v[188:191], a[200:203], v[140:143]
  ds_read_b64_tr_b16 v[180:181], v14 offset:15488
  v_fma_mixhi_f16 v209, v139, s64, 0
  v_mfma_f32_16x16x32_bf16 v[160:163], v[188:191], a[204:207], v[160:163]
  ds_read_b64_tr_b16 v[182:183], v14 offset:18048
  v_fma_mixhi_f16 v210, v157, s64, 0
  v_fma_mixhi_f16 v211, v159, s64, 0
  s_waitcnt lgkmcnt(8)
  v_mfma_f32_16x16x32_bf16 v[140:143], v[192:195], a[208:211], v[140:143]
  ds_read_b64_tr_b16 v[184:185], v14 offset:20608
  v_and_or_b32 v208, v208, v5, s67
  v_mfma_f32_16x16x32_bf16 v[160:163], v[192:195], a[212:215], v[160:163]
  ds_read_b64_tr_b16 v[186:187], v14 offset:23168
  v_and_or_b32 v209, v209, v5, s68
  v_and_or_b32 v210, v210, v5, s69
  v_mfma_f32_16x16x32_bf16 v[140:143], v[196:199], a[216:219], v[140:143]
  ds_read_b64_tr_b16 v[188:189], v14 offset:25728
  v_and_or_b32 v211, v211, v5, s70
  v_mfma_f32_16x16x32_bf16 v[160:163], v[196:199], a[220:223], v[160:163]
  ds_read_b64_tr_b16 v[190:191], v14 offset:28288
  s_cmp_eq_u32 s3, s5
  s_cbranch_scc1 L_x57
  buffer_store_dwordx4 v[208:211], v10, s[96:99], s33 offen offset:2048 sc1
  s_branch L_x58
L_x57:
  ds_write_b128 v10, v[136:139] offset:2048
  ds_write_b128 v10, v[156:159] offset:7168
L_x58:
  s_waitcnt lgkmcnt(8)
  v_mfma_f32_16x16x32_bf16 v[144:147], v[168:171], a[160:163], v[144:147]
  ds_read_b64_tr_b16 v[192:193], v14 offset:30848
  v_mfma_f32_16x16x32_bf16 v[164:167], v[168:171], a[164:167], v[164:167]
  ds_read_b64_tr_b16 v[194:195], v14 offset:33408
  v_mfma_f32_16x16x32_bf16 v[144:147], v[172:175], a[168:171], v[144:147]
  ds_read_b64_tr_b16 v[196:197], v14 offset:35968
  v_max3_f32 v25, |v140|, |v141|, |v142|
  v_max3_f32 v25, v25, |v143|, |v160|
  v_mfma_f32_16x16x32_bf16 v[164:167], v[172:175], a[172:175], v[164:167]
  ds_read_b64_tr_b16 v[198:199], v14 offset:38528
  v_max3_f32 v25, v25, |v161|, |v162|
  s_waitcnt lgkmcnt(8)
  v_mfma_f32_16x16x32_bf16 v[144:147], v[176:179], a[176:179], v[144:147]
  v_max_f32_e64 v25, v25, |v163|
  v_cmp_le_f32 vcc, s65, v25
  v_mfma_f32_16x16x32_bf16 v[164:167], v[176:179], a[180:183], v[164:167]
  v_cmp_le_f32 s[72:73], s66, v25
  v_mfma_f32_16x16x32_bf16 v[144:147], v[180:183], a[184:187], v[144:147]
  s_cmp_lg_u64 vcc, 0
  s_cbranch_scc1 L_xr63
  s_cmp_eq_u64 s[72:73], 0
  s_cbranch_scc1 L_xr63
L_xb64:
  v_fma_mixlo_f16 v212, v140, s64, 0
  v_mfma_f32_16x16x32_bf16 v[164:167], v[180:183], a[188:191], v[164:167]
  v_fma_mixlo_f16 v213, v142, s64, 0
  s_waitcnt lgkmcnt(4)
  v_mfma_f32_16x16x32_bf16 v[144:147], v[184:187], a[192:195], v[144:147]
  v_fma_mixlo_f16 v214, v160, s64, 0
  v_mfma_f32_16x16x32_bf16 v[164:167], v[184:187], a[196:199], v[164:167]
  v_fma_mixlo_f16 v215, v162, s64, 0
  v_fma_mixhi_f16 v212, v141, s64, 0
  v_mfma_f32_16x16x32_bf16 v[144:147], v[188:191], a[200:203], v[144:147]
  v_fma_mixhi_f16 v213, v143, s64, 0
  v_mfma_f32_16x16x32_bf16 v[164:167], v[188:191], a[204:207], v[164:167]
  v_fma_mixhi_f16 v214, v161, s64, 0
  v_fma_mixhi_f16 v215, v163, s64, 0
  s_waitcnt lgkmcnt(0)
  v_mfma_f32_16x16x32_bf16 v[144:147], v[192:195], a[208:211], v[144:147]
  v_and_or_b32 v212, v212, v5, s67
  v_mfma_f32_16x16x32_bf16 v[164:167], v[192:195], a[212:215], v[164:167]
  v_and_or_b32 v213, v213, v5, s68
  v_and_or_b32 v214, v214, v5, s69
  v_mfma_f32_16x16x32_bf16 v[144:147], v[196:199], a[216:219], v[144:147]
  v_and_or_b32 v215, v215, v5, s70
  v_mfma_f32_16x16x32_bf16 v[164:167], v[196:199], a[220:223], v[164:167]
  s_cmp_eq_u32 s3, s5
  s_cbranch_scc1 L_x61
  buffer_store_dwordx4 v[212:215], v10, s[96:99], s33 offen offset:3072 sc1
  s_branch L_x62
L_x61:
  ds_write_b128 v10, v[140:143] offset:3072
  ds_write_b128 v10, v[160:163] offset:8192
L_x62:
  v_max3_f32 v25, |v144|, |v145|, |v146|
  s_nop 0
  v_max3_f32 v25, v25, |v147|, |v164|
  v_max3_f32 v25, v25, |v165|, |v166|
  v_max_f32_e64 v25, v25, |v167|
  v_cmp_le_f32 vcc, s65, v25
  v_cmp_le_f32 s[72:73], s66, v25
  s_cmp_lg_u64 vcc, 0
  s_cbranch_scc1 L_xr83
  s_cmp_eq_u64 s[72:73], 0
  s_cbranch_scc1 L_xr83
L_xb84:
  v_fma_mixlo_f16 v216, v144, s64, 0
  v_fma_mixlo_f16 v217, v146, s64, 0
  v_fma_mixlo_f16 v218, v164, s64, 0
  v_fma_mixlo_f16 v219, v166, s64, 0
  v_fma_mixhi_f16 v216, v145, s64, 0
  v_fma_mixhi_f16 v217, v147, s64, 0
  v_fma_mixhi_f16 v218, v165, s64, 0
  v_fma_mixhi_f16 v219, v167, s64, 0
  v_and_or_b32 v216, v216, v5, s67
  v_and_or_b32 v217, v217, v5, s68
  v_and_or_b32 v218, v218, v5, s69
  v_and_or_b32 v219, v219, v5, s70
  s_cmp_eq_u32 s3, s5
  s_cbranch_scc1 L_x81
  buffer_store_dwordx4 v[216:219], v10, s[96:99], s29 offen offset:0 sc1
L_x81:
  s_cmp_lg_u32 s3, s5
  s_cselect_b32 s26, 0x38, 0
  v_mov_b32 v7, 0x0c0c0602
  s_bitcmp1_b32 s26, 0
  s_cbranch_scc1 L_q91
  buffer_load_dwordx4 v[32:35], v10, s[96:99], s13 offen sc1
L_q91:
  s_bitcmp1_b32 s26, 1
  s_cbranch_scc1 L_q92
  buffer_load_dwordx4 v[40:43], v10, s[96:99], s14 offen sc1
L_q92:
  s_bitcmp1_b32 s26, 2
  s_cbranch_scc1 L_q93
  buffer_load_dwordx4 v[48:51], v10, s[96:99], s15 offen sc1
L_q93:
  s_bitcmp1_b32 s26, 3
  s_cbranch_scc1 L_q94
  buffer_load_dwordx4 v[36:39], v10, s[96:99], s17 offen sc1
L_q94:
  s_bitcmp1_b32 s26, 4
  s_cbranch_scc1 L_q95
  buffer_load_dwordx4 v[44:47], v10, s[96:99], s18 offen sc1
L_q95:
  s_bitcmp1_b32 s26, 5
  s_cbranch_scc1 L_q96
  buffer_load_dwordx4 v[52:55], v10, s[96:99], s19 offen sc1
L_q96:
  s_waitcnt lgkmcnt(0)
  s_barrier
  ds_read_b128 v[64:67], v3
  ds_read_b128 v[68:71], v3 offset:5120
  s_waitcnt vmcnt(0)
  s_branch L_q89
L_q85:
  s_bitcmp1_b32 s26, 0
  s_cbranch_scc1 L_q97
  buffer_load_dwordx4 v[32:35], v10, s[96:99], s13 offen sc1
L_q97:
  s_bitcmp1_b32 s26, 1
  s_cbranch_scc1 L_q98
  buffer_load_dwordx4 v[40:43], v10, s[96:99], s14 offen sc1
L_q98:
  s_bitcmp1_b32 s26, 2
  s_cbranch_scc1 L_q99
  buffer_load_dwordx4 v[48:51], v10, s[96:99], s15 offen sc1
L_q99:
  s_bitcmp1_b32 s26, 3
  s_cbranch_scc1 L_q100
  buffer_load_dwordx4 v[36:39], v10, s[96:99], s17 offen sc1
L_q100:
  s_bitcmp1_b32 s26, 4
  s_cbranch_scc1 L_q101
  buffer_load_dwordx4 v[44:47], v10, s[96:99], s18 offen sc1
L_q101:
  s_bitcmp1_b32 s26, 5
  s_cbranch_scc1 L_q102
  buffer_load_dwordx4 v[52:55], v10, s[96:99], s19 offen sc1
L_q102:
  s_and_b32 s100, s26, 0x47
  s_cmp_lg_u32 s100, 7
  s_cbranch_scc1 L_q88
  v_perm_b32 v84, v33, v32, v7
  v_perm_b32 v85, v35, v34, v7
  v_perm_b32 v86, v41, v40, v7
  v_perm_b32 v87, v43, v42, v7
  v_perm_b32 v88, v49, v48, v7
  v_perm_b32 v89, v51, v50, v7
  v_lshl_or_b32 v84, v85, 16, v84
  v_lshl_or_b32 v86, v87, 16, v86
  v_lshl_or_b32 v88, v89, 16, v88
  v_readfirstlane_b32 s64, v84
  v_readfirstlane_b32 s65, v86
  v_readfirstlane_b32 s66, v88
  v_and_or_b32 v32, v32, v5, s36
  v_and_or_b32 v33, v33, v5, s36
  v_and_or_b32 v34, v34, v5, s36
  v_and_or_b32 v35, v35, v5, s36
  s_and_b32 s64, s64, 0x03030303
  s_mul_i32 s64, s64, 0x01041040
  s_lshr_b32 s64, s64, 24
  s_lshl_b32 s64, s64, 23
  v_and_or_b32 v40, v40, v5, s36
  v_and_or_b32 v41, v41, v5, s36
  v_and_or_b32 v42, v42, v5, s36
  v_and_or_b32 v43, v43, v5, s36
  s_and_b32 s65, s65, 0x03030303
  s_mul_i32 s65, s65, 0x01041040
  s_lshr_b32 s65, s65, 24
  s_lshl_b32 s65, s65, 23
  v_and_or_b32 v48, v48, v5, s36
  v_and_or_b32 v49, v49, v5, s36
  v_and_or_b32 v50, v50, v5, s36
  v_and_or_b32 v51, v51, v5, s36
  s_and_b32 s66, s66, 0x03030303
  s_mul_i32 s66, s66, 0x01041040
  s_lshr_b32 s66, s66, 24
  s_lshl_b32 s66, s66, 23
  s_waitcnt lgkmcnt(0)
  v_fma_mix_f32 v64, v32, s64, v64 op_sel:[0,0,0] op_sel_hi:[1,0,0]
  v_fma_mix_f32 v65, v32, s64, v65 op_sel:[1,0,0] op_sel_hi:[1,0,0]
  v_fma_mix_f32 v66, v33, s64, v66 op_sel:[0,0,0] op_sel_hi:[1,0,0]
  v_fma_mix_f32 v67, v33, s64, v67 op_sel:[1,0,0] op_sel_hi:[1,0,0]
  v_fma_mix_f32 v68, v34, s64, v68 op_sel:[0,0,0] op_sel_hi:[1,0,0]
  v_fma_mix_f32 v69, v34, s64, v69 op_sel:[1,0,0] op_sel_hi:[1,0,0]
  v_fma_mix_f32 v70, v35, s64, v70 op_sel:[0,0,0] op_sel_hi:[1,0,0]
  v_fma_mix_f32 v71, v35, s64, v71 op_sel:[1,0,0] op_sel_hi:[1,0,0]
  v_fma_mix_f32 v64, v40, s65, v64 op_sel:[0,0,0] op_sel_hi:[1,0,0]
  v_fma_mix_f32 v65, v40, s65, v65 op_sel:[1,0,0] op_sel_hi:[1,0,0]
  v_fma_mix_f32 v66, v41, s65, v66 op_sel:[0,0,0] op_sel_hi:[1,0,0]
  v_fma_mix_f32 v67, v41, s65, v67 op_sel:[1,0,0] op_sel_hi:[1,0,0]
  v_fma_mix_f32 v68, v42, s65, v68 op_sel:[0,0,0] op_sel_hi:[1,0,0]
  v_fma_mix_f32 v69, v42, s65, v69 op_sel:[1,0,0] op_sel_hi:[1,0,0]
  v_fma_mix_f32 v70, v43, s65, v70 op_sel:[0,0,0] op_sel_hi:[1,0,0]
  v_fma_mix_f32 v71, v43, s65, v71 op_sel:[1,0,0] op_sel_hi:[1,0,0]
  v_fma_mix_f32 v64, v48, s66, v64 op_sel:[0,0,0] op_sel_hi:[1,0,0]
  v_fma_mix_f32 v65, v48, s66, v65 op_sel:[1,0,0] op_sel_hi:[1,0,0]
  v_fma_mix_f32 v66, v49, s66, v66 op_sel:[0,0,0] op_sel_hi:[1,0,0]
  v_fma_mix_f32 v67, v49, s66, v67 op_sel:[1,0,0] op_sel_hi:[1,0,0]
  v_fma_mix_f32 v68, v50, s66, v68 op_sel:[0,0,0] op_sel_hi:[1,0,0]
  v_fma_mix_f32 v69, v50, s66, v69 op_sel:[1,0,0] op_sel_hi:[1,0,0]
  v_fma_mix_f32 v70, v51, s66, v70 op_sel:[0,0,0] op_sel_hi:[1,0,0]
  v_fma_mix_f32 v71, v51, s66, v71 op_sel:[1,0,0] op_sel_hi:[1,0,0]
  v_cvt_pk_bf16_f32 v80, v64, v65
  v_cvt_pk_bf16_f32 v81, v66, v67
  buffer_store_dwordx2 v[80:81], v2, s[8:11], s12 offen offset:0
  v_cvt_pk_bf16_f32 v82, v68, v69
  v_cvt_pk_bf16_f32 v83, v70, v71
  buffer_store_dwordx2 v[82:83], v2, s[8:11], s16 offen offset:0
  s_bitset1_b32 s26, 6
  s_waitcnt vmcnt(2)
  s_branch L_q89
L_q88:
  s_waitcnt vmcnt(0)
L_q89:
  s_add_u32 s37, s37, 1
  s_bitcmp1_b32 s26, 0
  s_cbranch_scc1 L_q103
  v_xor_b32 v4, s80, v32
  v_bitop3_b32 v4, v4, v33, s81 bitop3:0xf6
  v_bitop3_b32 v4, v4, v34, s82 bitop3:0xf6
  v_bitop3_b32 v4, v4, v35, s83 bitop3:0xf6
  v_and_b32 v4, 3, v4
  v_cmp_ne_u32 vcc, 0, v4
  s_nop 0
  s_cmp_lg_u64 vcc, 0
  s_cbranch_scc1 L_q103
  s_bitset1_b32 s26, 0
L_q103:
  s_bitcmp1_b32 s26, 1
  s_cbranch_scc1 L_q104
  v_xor_b32 v4, s80, v40
  v_bitop3_b32 v4, v4, v41, s81 bitop3:0xf6
  v_bitop3_b32 v4, v4, v42, s82 bitop3:0xf6
  v_bitop3_b32 v4, v4, v43, s83 bitop3:0xf6
  v_and_b32 v4, 3, v4
  v_cmp_ne_u32 vcc, 0, v4
  s_nop 0
  s_cmp_lg_u64 vcc, 0
  s_cbranch_scc1 L_q104
  s_bitset1_b32 s26, 1
L_q104:
  s_bitcmp1_b32 s26, 2
  s_cbranch_scc1 L_q105
  v_xor_b32 v4, s80, v48
  v_bitop3_b32 v4, v4, v49, s81 bitop3:0xf6
  v_bitop3_b32 v4, v4, v50, s82 bitop3:0xf6
  v_bitop3_b32 v4, v4, v51, s83 bitop3:0xf6
  v_and_b32 v4, 3, v4
  v_cmp_ne_u32 vcc, 0, v4
  s_nop 0
  s_cmp_lg_u64 vcc, 0
  s_cbranch_scc1 L_q105
  s_bitset1_b32 s26, 2
L_q105:
  s_bitcmp1_b32 s26, 3
  s_cbranch_scc1 L_q106
  v_xor_b32 v4, s80, v36
  v_bitop3_b32 v4, v4, v37, s81 bitop3:0xf6
  v_bitop3_b32 v4, v4, v38, s82 bitop3:0xf6
  v_bitop3_b32 v4, v4, v39, s83 bitop3:0xf6
  v_and_b32 v4, 3, v4
  v_cmp_ne_u32 vcc, 0, v4
  s_nop 0
  s_cmp_lg_u64 vcc, 0
  s_cbranch_scc1 L_q106
  s_bitset1_b32 s26, 3
L_q106:
  s_bitcmp1_b32 s26, 4
  s_cbranch_scc1 L_q107
  v_xor_b32 v4, s80, v44
  v_bitop3_b32 v4, v4, v45, s81 bitop3:0xf6
  v_bitop3_b32 v4, v4, v46, s82 bitop3:0xf6
  v_bitop3_b32 v4, v4, v47, s83 bitop3:0xf6
  v_and_b32 v4, 3, v4
  v_cmp_ne_u32 vcc, 0, v4
  s_nop 0
  s_cmp_lg_u64 vcc, 0
  s_cbranch_scc1 L_q107
  s_bitset1_b32 s26, 4
L_q107:
  s_bitcmp1_b32 s26, 5
  s_cbranch_scc1 L_q108
  v_xor_b32 v4, s80, v52
  v_bitop3_b32 v4, v4, v53, s81 bitop3:0xf6
  v_bitop3_b32 v4, v4, v54, s82 bitop3:0xf6
  v_bitop3_b32 v4, v4, v55, s83 bitop3:0xf6
  v_and_b32 v4, 3, v4
  v_cmp_ne_u32 vcc, 0, v4
  s_nop 0
  s_cmp_lg_u64 vcc, 0
  s_cbranch_scc1 L_q108
  s_bitset1_b32 s26, 5
L_q108:
  s_and_b32 s100, s26, 0x3f
  s_cmp_eq_u32 s100, 0x3f
  s_cbranch_scc1 L_q86
  s_cmp_lt_u32 s37, 262144
  s_cbranch_scc1 L_q85
L_q86:
  s_bitcmp1_b32 s26, 6
  s_cbranch_scc1 L_q87
  v_perm_b32 v84, v33, v32, v7
  v_perm_b32 v85, v35, v34, v7
  v_perm_b32 v86, v41, v40, v7
  v_perm_b32 v87, v43, v42, v7
  v_perm_b32 v88, v49, v48, v7
  v_perm_b32 v89, v51, v50, v7
  v_lshl_or_b32 v84, v85, 16, v84
  v_lshl_or_b32 v86, v87, 16, v86
  v_lshl_or_b32 v88, v89, 16, v88
  v_readfirstlane_b32 s64, v84
  v_readfirstlane_b32 s65, v86
  v_readfirstlane_b32 s66, v88
  v_and_or_b32 v32, v32, v5, s36
  v_and_or_b32 v33, v33, v5, s36
  v_and_or_b32 v34, v34, v5, s36
  v_and_or_b32 v35, v35, v5, s36
  s_and_b32 s64, s64, 0x03030303
  s_mul_i32 s64, s64, 0x01041040
  s_lshr_b32 s64, s64, 24
  s_lshl_b32 s64, s64, 23
  v_and_or_b32 v40, v40, v5, s36
  v_and_or_b32 v41, v41, v5, s36
  v_and_or_b32 v42, v42, v5, s36
  v_and_or_b32 v43, v43, v5, s36
  s_and_b32 s65, s65, 0x03030303
  s_mul_i32 s65, s65, 0x01041040
  s_lshr_b32 s65, s65, 24
  s_lshl_b32 s65, s65, 23
  v_and_or_b32 v48, v48, v5, s36
  v_and_or_b32 v49, v49, v5, s36
  v_and_or_b32 v50, v50, v5, s36
  v_and_or_b32 v51, v51, v5, s36
  s_and_b32 s66, s66, 0x03030303
  s_mul_i32 s66, s66, 0x01041040
  s_lshr_b32 s66, s66, 24
  s_lshl_b32 s66, s66, 23
  s_waitcnt lgkmcnt(0)
  v_fma_mix_f32 v64, v32, s64, v64 op_sel:[0,0,0] op_sel_hi:[1,0,0]
  v_fma_mix_f32 v65, v32, s64, v65 op_sel:[1,0,0] op_sel_hi:[1,0,0]
  v_fma_mix_f32 v66, v33, s64, v66 op_sel:[0,0,0] op_sel_hi:[1,0,0]
  v_fma_mix_f32 v67, v33, s64, v67 op_sel:[1,0,0] op_sel_hi:[1,0,0]
  v_fma_mix_f32 v68, v34, s64, v68 op_sel:[0,0,0] op_sel_hi:[1,0,0]
  v_fma_mix_f32 v69, v34, s64, v69 op_sel:[1,0,0] op_sel_hi:[1,0,0]
  v_fma_mix_f32 v70, v35, s64, v70 op_sel:[0,0,0] op_sel_hi:[1,0,0]
  v_fma_mix_f32 v71, v35, s64, v71 op_sel:[1,0,0] op_sel_hi:[1,0,0]
  v_fma_mix_f32 v64, v40, s65, v64 op_sel:[0,0,0] op_sel_hi:[1,0,0]
  v_fma_mix_f32 v65, v40, s65, v65 op_sel:[1,0,0] op_sel_hi:[1,0,0]
  v_fma_mix_f32 v66, v41, s65, v66 op_sel:[0,0,0] op_sel_hi:[1,0,0]
  v_fma_mix_f32 v67, v41, s65, v67 op_sel:[1,0,0] op_sel_hi:[1,0,0]
  v_fma_mix_f32 v68, v42, s65, v68 op_sel:[0,0,0] op_sel_hi:[1,0,0]
  v_fma_mix_f32 v69, v42, s65, v69 op_sel:[1,0,0] op_sel_hi:[1,0,0]
  v_fma_mix_f32 v70, v43, s65, v70 op_sel:[0,0,0] op_sel_hi:[1,0,0]
  v_fma_mix_f32 v71, v43, s65, v71 op_sel:[1,0,0] op_sel_hi:[1,0,0]
  v_fma_mix_f32 v64, v48, s66, v64 op_sel:[0,0,0] op_sel_hi:[1,0,0]
  v_fma_mix_f32 v65, v48, s66, v65 op_sel:[1,0,0] op_sel_hi:[1,0,0]
  v_fma_mix_f32 v66, v49, s66, v66 op_sel:[0,0,0] op_sel_hi:[1,0,0]
  v_fma_mix_f32 v67, v49, s66, v67 op_sel:[1,0,0] op_sel_hi:[1,0,0]
  v_fma_mix_f32 v68, v50, s66, v68 op_sel:[0,0,0] op_sel_hi:[1,0,0]
  v_fma_mix_f32 v69, v50, s66, v69 op_sel:[1,0,0] op_sel_hi:[1,0,0]
  v_fma_mix_f32 v70, v51, s66, v70 op_sel:[0,0,0] op_sel_hi:[1,0,0]
  v_fma_mix_f32 v71, v51, s66, v71 op_sel:[1,0,0] op_sel_hi:[1,0,0]
  v_cvt_pk_bf16_f32 v80, v64, v65
  v_cvt_pk_bf16_f32 v81, v66, v67
  buffer_store_dwordx2 v[80:81], v2, s[8:11], s12 offen offset:0
  v_cvt_pk_bf16_f32 v82, v68, v69
  v_cvt_pk_bf16_f32 v83, v70, v71
  buffer_store_dwordx2 v[82:83], v2, s[8:11], s16 offen offset:0
L_q87:
  s_cmp_lg_u32 s3, s5
  s_cbranch_scc1 L_q90
  s_nop 1
  v_perm_b32 v84, v37, v36, v7
  v_perm_b32 v85, v39, v38, v7
  v_perm_b32 v86, v45, v44, v7
  v_perm_b32 v87, v47, v46, v7
  v_perm_b32 v88, v53, v52, v7
  v_perm_b32 v89, v55, v54, v7
  v_lshl_or_b32 v84, v85, 16, v84
  v_lshl_or_b32 v86, v87, 16, v86
  v_lshl_or_b32 v88, v89, 16, v88
  v_readfirstlane_b32 s64, v84
  v_readfirstlane_b32 s65, v86
  v_readfirstlane_b32 s66, v88
  v_and_or_b32 v36, v36, v5, s36
  v_and_or_b32 v37, v37, v5, s36
  v_and_or_b32 v38, v38, v5, s36
  v_and_or_b32 v39, v39, v5, s36
  s_and_b32 s64, s64, 0x03030303
  s_mul_i32 s64, s64, 0x01041040
  s_lshr_b32 s64, s64, 24
  s_lshl_b32 s64, s64, 23
  v_and_or_b32 v44, v44, v5, s36
  v_and_or_b32 v45, v45, v5, s36
  v_and_or_b32 v46, v46, v5, s36
  v_and_or_b32 v47, v47, v5, s36
  s_and_b32 s65, s65, 0x03030303
  s_mul_i32 s65, s65, 0x01041040
  s_lshr_b32 s65, s65, 24
  s_lshl_b32 s65, s65, 23
  v_and_or_b32 v52, v52, v5, s36
  v_and_or_b32 v53, v53, v5, s36
  v_and_or_b32 v54, v54, v5, s36
  v_and_or_b32 v55, v55, v5, s36
  s_and_b32 s66, s66, 0x03030303
  s_mul_i32 s66, s66, 0x01041040
  s_lshr_b32 s66, s66, 24
  s_lshl_b32 s66, s66, 23
  s_waitcnt lgkmcnt(0)
  v_fma_mix_f32 v144, v36, s64, v144 op_sel:[0,0,0] op_sel_hi:[1,0,0]
  v_fma_mix_f32 v145, v36, s64, v145 op_sel:[1,0,0] op_sel_hi:[1,0,0]
  v_fma_mix_f32 v146, v37, s64, v146 op_sel:[0,0,0] op_sel_hi:[1,0,0]
  v_fma_mix_f32 v147, v37, s64, v147 op_sel:[1,0,0] op_sel_hi:[1,0,0]
  v_fma_mix_f32 v164, v38, s64, v164 op_sel:[0,0,0] op_sel_hi:[1,0,0]
  v_fma_mix_f32 v165, v38, s64, v165 op_sel:[1,0,0] op_sel_hi:[1,0,0]
  v_fma_mix_f32 v166, v39, s64, v166 op_sel:[0,0,0] op_sel_hi:[1,0,0]
  v_fma_mix_f32 v167, v39, s64, v167 op_sel:[1,0,0] op_sel_hi:[1,0,0]
  v_fma_mix_f32 v144, v44, s65, v144 op_sel:[0,0,0] op_sel_hi:[1,0,0]
  v_fma_mix_f32 v145, v44, s65, v145 op_sel:[1,0,0] op_sel_hi:[1,0,0]
  v_fma_mix_f32 v146, v45, s65, v146 op_sel:[0,0,0] op_sel_hi:[1,0,0]
  v_fma_mix_f32 v147, v45, s65, v147 op_sel:[1,0,0] op_sel_hi:[1,0,0]
  v_fma_mix_f32 v164, v46, s65, v164 op_sel:[0,0,0] op_sel_hi:[1,0,0]
  v_fma_mix_f32 v165, v46, s65, v165 op_sel:[1,0,0] op_sel_hi:[1,0,0]
  v_fma_mix_f32 v166, v47, s65, v166 op_sel:[0,0,0] op_sel_hi:[1,0,0]
  v_fma_mix_f32 v167, v47, s65, v167 op_sel:[1,0,0] op_sel_hi:[1,0,0]
  v_fma_mix_f32 v144, v52, s66, v144 op_sel:[0,0,0] op_sel_hi:[1,0,0]
  v_fma_mix_f32 v145, v52, s66, v145 op_sel:[1,0,0] op_sel_hi:[1,0,0]
  v_fma_mix_f32 v146, v53, s66, v146 op_sel:[0,0,0] op_sel_hi:[1,0,0]
  v_fma_mix_f32 v147, v53, s66, v147 op_sel:[1,0,0] op_sel_hi:[1,0,0]
  v_fma_mix_f32 v164, v54, s66, v164 op_sel:[0,0,0] op_sel_hi:[1,0,0]
  v_fma_mix_f32 v165, v54, s66, v165 op_sel:[1,0,0] op_sel_hi:[1,0,0]
  v_fma_mix_f32 v166, v55, s66, v166 op_sel:[0,0,0] op_sel_hi:[1,0,0]
  v_fma_mix_f32 v167, v55, s66, v167 op_sel:[1,0,0] op_sel_hi:[1,0,0]
  v_cvt_pk_bf16_f32 v80, v144, v145
  v_cvt_pk_bf16_f32 v81, v146, v147
  buffer_store_dwordx2 v[80:81], v2, s[8:11], 0 offen offset:128
  v_cvt_pk_bf16_f32 v82, v164, v165
  v_cvt_pk_bf16_f32 v83, v166, v167
  buffer_store_dwordx2 v[82:83], v2, s[8:11], s20 offen offset:128
L_q90:
  s_endpgm
L_rr1:
  v_mov_b32 v25, v20
  s_nop 1
  v_permlane32_swap_b32 v25, v20
  v_max3_f32 v20, v25, v20, 0
  v_exp_f32 v22, -v20
  v_sub_f32 v192, v192, v20
  v_sub_f32 v193, v193, v20
  v_sub_f32 v194, v194, v20
  v_sub_f32 v195, v195, v20
  v_sub_f32 v196, v196, v20
  v_sub_f32 v197, v197, v20
  v_sub_f32 v198, v198, v20
  v_sub_f32 v199, v199, v20
  v_sub_f32 v200, v200, v20
  v_sub_f32 v201, v201, v20
  v_sub_f32 v202, v202, v20
  v_sub_f32 v203, v203, v20
  v_sub_f32 v204, v204, v20
  v_sub_f32 v205, v205, v20
  v_sub_f32 v206, v206, v20
  v_sub_f32 v207, v207, v20
  v_sub_f32 v208, v208, v20
  v_sub_f32 v209, v209, v20
  v_sub_f32 v210, v210, v20
  v_sub_f32 v211, v211, v20
  v_sub_f32 v212, v212, v20
  v_sub_f32 v213, v213, v20
  v_sub_f32 v214, v214, v20
  v_sub_f32 v215, v215, v20
  v_sub_f32 v216, v216, v20
  v_sub_f32 v217, v217, v20
  v_sub_f32 v218, v218, v20
  v_sub_f32 v219, v219, v20
  v_sub_f32 v220, v220, v20
  v_sub_f32 v221, v221, v20
  v_sub_f32 v222, v222, v20
  v_sub_f32 v223, v223, v20
  v_sub_f32 v224, v224, v20
  v_sub_f32 v225, v225, v20
  v_sub_f32 v226, v226, v20
  v_sub_f32 v227, v227, v20
  v_sub_f32 v228, v228, v20
  v_sub_f32 v229, v229, v20
  v_sub_f32 v230, v230, v20
  v_sub_f32 v231, v231, v20
  v_sub_f32 v232, v232, v20
  v_sub_f32 v233, v233, v20
  v_sub_f32 v234, v234, v20
  v_sub_f32 v235, v235, v20
  v_sub_f32 v236, v236, v20
  v_sub_f32 v237, v237, v20
  v_sub_f32 v238, v238, v20
  v_sub_f32 v239, v239, v20
  v_sub_f32 v240, v240, v20
  v_sub_f32 v241, v241, v20
  v_sub_f32 v242, v242, v20
  v_sub_f32 v243, v243, v20
  v_sub_f32 v244, v244, v20
  v_sub_f32 v245, v245, v20
  v_sub_f32 v246, v246, v20
  v_sub_f32 v247, v247, v20
  v_sub_f32 v248, v248, v20
  v_sub_f32 v249, v249, v20
  v_sub_f32 v250, v250, v20
  v_sub_f32 v251, v251, v20
  v_sub_f32 v252, v252, v20
  v_sub_f32 v253, v253, v20
  v_sub_f32 v254, v254, v20
  v_sub_f32 v255, v255, v20
  v_sub_f32 v32, v32, v20
  v_sub_f32 v33, v33, v20
  v_sub_f32 v34, v34, v20
  v_sub_f32 v35, v35, v20
  v_sub_f32 v36, v36, v20
  v_sub_f32 v37, v37, v20
  v_sub_f32 v38, v38, v20
  v_sub_f32 v39, v39, v20
  v_sub_f32 v40, v40, v20
  v_sub_f32 v41, v41, v20
  v_sub_f32 v42, v42, v20
  v_sub_f32 v43, v43, v20
  v_sub_f32 v44, v44, v20
  v_sub_f32 v45, v45, v20
  v_sub_f32 v46, v46, v20
  v_sub_f32 v47, v47, v20
  s_mov_b32 s61, 1
  s_nop 1
  s_branch L_rb2
L_rr3:
  s_nop 15
  v_mul_f32 v64, v64, v22
  v_mul_f32 v65, v65, v22
  v_mul_f32 v66, v66, v22
  v_mul_f32 v67, v67, v22
  v_mul_f32 v68, v68, v22
  v_mul_f32 v69, v69, v22
  v_mul_f32 v70, v70, v22
  v_mul_f32 v71, v71, v22
  v_mul_f32 v72, v72, v22
  v_mul_f32 v73, v73, v22
  v_mul_f32 v74, v74, v22
  v_mul_f32 v75, v75, v22
  v_mul_f32 v76, v76, v22
  v_mul_f32 v77, v77, v22
  v_mul_f32 v78, v78, v22
  v_mul_f32 v79, v79, v22
  v_mul_f32 v80, v80, v22
  v_mul_f32 v81, v81, v22
  v_mul_f32 v82, v82, v22
  v_mul_f32 v83, v83, v22
  v_mul_f32 v84, v84, v22
  v_mul_f32 v85, v85, v22
  v_mul_f32 v86, v86, v22
  v_mul_f32 v87, v87, v22
  v_mul_f32 v88, v88, v22
  v_mul_f32 v89, v89, v22
  v_mul_f32 v90, v90, v22
  v_mul_f32 v91, v91, v22
  v_mul_f32 v92, v92, v22
  v_mul_f32 v93, v93, v22
  v_mul_f32 v94, v94, v22
  v_mul_f32 v95, v95, v22
  v_mul_f32 v96, v96, v22
  v_mul_f32 v97, v97, v22
  v_mul_f32 v98, v98, v22
  v_mul_f32 v99, v99, v22
  v_mul_f32 v100, v100, v22
  v_mul_f32 v101, v101, v22
  v_mul_f32 v102, v102, v22
  v_mul_f32 v103, v103, v22
  v_mul_f32 v104, v104, v22
  v_mul_f32 v105, v105, v22
  v_mul_f32 v106, v106, v22
  v_mul_f32 v107, v107, v22
  v_mul_f32 v108, v108, v22
  v_mul_f32 v109, v109, v22
  v_mul_f32 v110, v110, v22
  v_mul_f32 v111, v111, v22
  v_mul_f32 v112, v112, v22
  v_mul_f32 v113, v113, v22
  v_mul_f32 v114, v114, v22
  v_mul_f32 v115, v115, v22
  v_mul_f32 v116, v116, v22
  v_mul_f32 v117, v117, v22
  v_mul_f32 v118, v118, v22
  v_mul_f32 v119, v119, v22
  v_mul_f32 v120, v120, v22
  v_mul_f32 v121, v121, v22
  v_mul_f32 v122, v122, v22
  v_mul_f32 v123, v123, v22
  v_mul_f32 v124, v124, v22
  v_mul_f32 v125, v125, v22
  v_mul_f32 v126, v126, v22
  v_mul_f32 v127, v127, v22
  v_accvgpr_read_b32 v25, a120
  v_mul_f32 v25, v25, v22
  v_accvgpr_write_b32 a120, v25
  s_mov_b32 s61, 0
  s_nop 1
  s_branch L_rb4
L_rr7:
  v_mov_b32 v25, v20
  s_nop 1
  v_permlane32_swap_b32 v25, v20
  v_max3_f32 v20, v25, v20, 0
  v_exp_f32 v22, -v20
  v_sub_f32 v128, v128, v20
  v_sub_f32 v129, v129, v20
  v_sub_f32 v130, v130, v20
  v_sub_f32 v131, v131, v20
  v_sub_f32 v132, v132, v20
  v_sub_f32 v133, v133, v20
  v_sub_f32 v134, v134, v20
  v_sub_f32 v135, v135, v20
  v_sub_f32 v136, v136, v20
  v_sub_f32 v137, v137, v20
  v_sub_f32 v138, v138, v20
  v_sub_f32 v139, v139, v20
  v_sub_f32 v140, v140, v20
  v_sub_f32 v141, v141, v20
  v_sub_f32 v142, v142, v20
  v_sub_f32 v143, v143, v20
  v_sub_f32 v144, v144, v20
  v_sub_f32 v145, v145, v20
  v_sub_f32 v146, v146, v20
  v_sub_f32 v147, v147, v20
  v_sub_f32 v148, v148, v20
  v_sub_f32 v149, v149, v20
  v_sub_f32 v150, v150, v20
  v_sub_f32 v151, v151, v20
  v_sub_f32 v152, v152, v20
  v_sub_f32 v153, v153, v20
  v_sub_f32 v154, v154, v20
  v_sub_f32 v155, v155, v20
  v_sub_f32 v156, v156, v20
  v_sub_f32 v157, v157, v20
  v_sub_f32 v158, v158, v20
  v_sub_f32 v159, v159, v20
  v_sub_f32 v160, v160, v20
  v_sub_f32 v161, v161, v20
  v_sub_f32 v162, v162, v20
  v_sub_f32 v163, v163, v20
  v_sub_f32 v164, v164, v20
  v_sub_f32 v165, v165, v20
  v_sub_f32 v166, v166, v20
  v_sub_f32 v167, v167, v20
  v_sub_f32 v168, v168, v20
  v_sub_f32 v169, v169, v20
  v_sub_f32 v170, v170, v20
  v_sub_f32 v171, v171, v20
  v_sub_f32 v172, v172, v20
  v_sub_f32 v173, v173, v20
  v_sub_f32 v174, v174, v20
  v_sub_f32 v175, v175, v20
  v_sub_f32 v176, v176, v20
  v_sub_f32 v177, v177, v20
  v_sub_f32 v178, v178, v20
  v_sub_f32 v179, v179, v20
  v_sub_f32 v180, v180, v20
  v_sub_f32 v181, v181, v20
  v_sub_f32 v182, v182, v20
  v_sub_f32 v183, v183, v20
  v_sub_f32 v184, v184, v20
  v_sub_f32 v185, v185, v20
  v_sub_f32 v186, v186, v20
  v_sub_f32 v187, v187, v20
  v_sub_f32 v188, v188, v20
  v_sub_f32 v189, v189, v20
  v_sub_f32 v190, v190, v20
  v_sub_f32 v191, v191, v20
  v_sub_f32 v32, v32, v20
  v_sub_f32 v33, v33, v20
  v_sub_f32 v34, v34, v20
  v_sub_f32 v35, v35, v20
  v_sub_f32 v36, v36, v20
  v_sub_f32 v37, v37, v20
  v_sub_f32 v38, v38, v20
  v_sub_f32 v39, v39, v20
  v_sub_f32 v40, v40, v20
  v_sub_f32 v41, v41, v20
  v_sub_f32 v42, v42, v20
  v_sub_f32 v43, v43, v20
  v_sub_f32 v44, v44, v20
  v_sub_f32 v45, v45, v20
  v_sub_f32 v46, v46, v20
  v_sub_f32 v47, v47, v20
  s_mov_b32 s61, 1
  s_nop 1
  s_branch L_rb8
L_rr9:
  s_nop 15
  v_mul_f32 v64, v64, v22
  v_mul_f32 v65, v65, v22
  v_mul_f32 v66, v66, v22
  v_mul_f32 v67, v67, v22
  v_mul_f32 v68, v68, v22
  v_mul_f32 v69, v69, v22
  v_mul_f32 v70, v70, v22
  v_mul_f32 v71, v71, v22
  v_mul_f32 v72, v72, v22
  v_mul_f32 v73, v73, v22
  v_mul_f32 v74, v74, v22
  v_mul_f32 v75, v75, v22
  v_mul_f32 v76, v76, v22
  v_mul_f32 v77, v77, v22
  v_mul_f32 v78, v78, v22
  v_mul_f32 v79, v79, v22
  v_mul_f32 v80, v80, v22
  v_mul_f32 v81, v81, v22
  v_mul_f32 v82, v82, v22
  v_mul_f32 v83, v83, v22
  v_mul_f32 v84, v84, v22
  v_mul_f32 v85, v85, v22
  v_mul_f32 v86, v86, v22
  v_mul_f32 v87, v87, v22
  v_mul_f32 v88, v88, v22
  v_mul_f32 v89, v89, v22
  v_mul_f32 v90, v90, v22
  v_mul_f32 v91, v91, v22
  v_mul_f32 v92, v92, v22
  v_mul_f32 v93, v93, v22
  v_mul_f32 v94, v94, v22
  v_mul_f32 v95, v95, v22
  v_mul_f32 v96, v96, v22
  v_mul_f32 v97, v97, v22
  v_mul_f32 v98, v98, v22
  v_mul_f32 v99, v99, v22
  v_mul_f32 v100, v100, v22
  v_mul_f32 v101, v101, v22
  v_mul_f32 v102, v102, v22
  v_mul_f32 v103, v103, v22
  v_mul_f32 v104, v104, v22
  v_mul_f32 v105, v105, v22
  v_mul_f32 v106, v106, v22
  v_mul_f32 v107, v107, v22
  v_mul_f32 v108, v108, v22
  v_mul_f32 v109, v109, v22
  v_mul_f32 v110, v110, v22
  v_mul_f32 v111, v111, v22
  v_mul_f32 v112, v112, v22
  v_mul_f32 v113, v113, v22
  v_mul_f32 v114, v114, v22
  v_mul_f32 v115, v115, v22
  v_mul_f32 v116, v116, v22
  v_mul_f32 v117, v117, v22
  v_mul_f32 v118, v118, v22
  v_mul_f32 v119, v119, v22
  v_mul_f32 v120, v120, v22
  v_mul_f32 v121, v121, v22
  v_mul_f32 v122, v122, v22
  v_mul_f32 v123, v123, v22
  v_mul_f32 v124, v124, v22
  v_mul_f32 v125, v125, v22
  v_mul_f32 v126, v126, v22
  v_mul_f32 v127, v127, v22
  v_accvgpr_read_b32 v25, a120
  v_mul_f32 v25, v25, v22
  v_accvgpr_write_b32 a120, v25
  s_mov_b32 s61, 0
  s_nop 1
  s_branch L_rb10
L_rr11:
  v_mov_b32 v25, v20
  s_nop 1
  v_permlane32_swap_b32 v25, v20
  v_max3_f32 v20, v25, v20, 0
  v_exp_f32 v22, -v20
  v_sub_f32 v192, v192, v20
  v_sub_f32 v193, v193, v20
  v_sub_f32 v194, v194, v20
  v_sub_f32 v195, v195, v20
  v_sub_f32 v196, v196, v20
  v_sub_f32 v197, v197, v20
  v_sub_f32 v198, v198, v20
  v_sub_f32 v199, v199, v20
  v_sub_f32 v200, v200, v20
  v_sub_f32 v201, v201, v20
  v_sub_f32 v202, v202, v20
  v_sub_f32 v203, v203, v20
  v_sub_f32 v204, v204, v20
  v_sub_f32 v205, v205, v20
  v_sub_f32 v206, v206, v20
  v_sub_f32 v207, v207, v20
  v_sub_f32 v208, v208, v20
  v_sub_f32 v209, v209, v20
  v_sub_f32 v210, v210, v20
  v_sub_f32 v211, v211, v20
  v_sub_f32 v212, v212, v20
  v_sub_f32 v213, v213, v20
  v_sub_f32 v214, v214, v20
  v_sub_f32 v215, v215, v20
  v_sub_f32 v216, v216, v20
  v_sub_f32 v217, v217, v20
  v_sub_f32 v218, v218, v20
  v_sub_f32 v219, v219, v20
  v_sub_f32 v220, v220, v20
  v_sub_f32 v221, v221, v20
  v_sub_f32 v222, v222, v20
  v_sub_f32 v223, v223, v20
  v_sub_f32 v224, v224, v20
  v_sub_f32 v225, v225, v20
  v_sub_f32 v226, v226, v20
  v_sub_f32 v227, v227, v20
  v_sub_f32 v228, v228, v20
  v_sub_f32 v229, v229, v20
  v_sub_f32 v230, v230, v20
  v_sub_f32 v231, v231, v20
  v_sub_f32 v232, v232, v20
  v_sub_f32 v233, v233, v20
  v_sub_f32 v234, v234, v20
  v_sub_f32 v235, v235, v20
  v_sub_f32 v236, v236, v20
  v_sub_f32 v237, v237, v20
  v_sub_f32 v238, v238, v20
  v_sub_f32 v239, v239, v20
  v_sub_f32 v240, v240, v20
  v_sub_f32 v241, v241, v20
  v_sub_f32 v242, v242, v20
  v_sub_f32 v243, v243, v20
  v_sub_f32 v244, v244, v20
  v_sub_f32 v245, v245, v20
  v_sub_f32 v246, v246, v20
  v_sub_f32 v247, v247, v20
  v_sub_f32 v248, v248, v20
  v_sub_f32 v249, v249, v20
  v_sub_f32 v250, v250, v20
  v_sub_f32 v251, v251, v20
  v_sub_f32 v252, v252, v20
  v_sub_f32 v253, v253, v20
  v_sub_f32 v254, v254, v20
  v_sub_f32 v255, v255, v20
  v_sub_f32 v32, v32, v20
  v_sub_f32 v33, v33, v20
  v_sub_f32 v34, v34, v20
  v_sub_f32 v35, v35, v20
  v_sub_f32 v36, v36, v20
  v_sub_f32 v37, v37, v20
  v_sub_f32 v38, v38, v20
  v_sub_f32 v39, v39, v20
  v_sub_f32 v40, v40, v20
  v_sub_f32 v41, v41, v20
  v_sub_f32 v42, v42, v20
  v_sub_f32 v43, v43, v20
  v_sub_f32 v44, v44, v20
  v_sub_f32 v45, v45, v20
  v_sub_f32 v46, v46, v20
  v_sub_f32 v47, v47, v20
  s_mov_b32 s61, 1
  s_nop 1
  s_branch L_rb12
L_rr15:
  s_nop 15
  v_mul_f32 v64, v64, v22
  v_mul_f32 v65, v65, v22
  v_mul_f32 v66, v66, v22
  v_mul_f32 v67, v67, v22
  v_mul_f32 v68, v68, v22
  v_mul_f32 v69, v69, v22
  v_mul_f32 v70, v70, v22
  v_mul_f32 v71, v71, v22
  v_mul_f32 v72, v72, v22
  v_mul_f32 v73, v73, v22
  v_mul_f32 v74, v74, v22
  v_mul_f32 v75, v75, v22
  v_mul_f32 v76, v76, v22
  v_mul_f32 v77, v77, v22
  v_mul_f32 v78, v78, v22
  v_mul_f32 v79, v79, v22
  v_mul_f32 v80, v80, v22
  v_mul_f32 v81, v81, v22
  v_mul_f32 v82, v82, v22
  v_mul_f32 v83, v83, v22
  v_mul_f32 v84, v84, v22
  v_mul_f32 v85, v85, v22
  v_mul_f32 v86, v86, v22
  v_mul_f32 v87, v87, v22
  v_mul_f32 v88, v88, v22
  v_mul_f32 v89, v89, v22
  v_mul_f32 v90, v90, v22
  v_mul_f32 v91, v91, v22
  v_mul_f32 v92, v92, v22
  v_mul_f32 v93, v93, v22
  v_mul_f32 v94, v94, v22
  v_mul_f32 v95, v95, v22
  v_mul_f32 v96, v96, v22
  v_mul_f32 v97, v97, v22
  v_mul_f32 v98, v98, v22
  v_mul_f32 v99, v99, v22
  v_mul_f32 v100, v100, v22
  v_mul_f32 v101, v101, v22
  v_mul_f32 v102, v102, v22
  v_mul_f32 v103, v103, v22
  v_mul_f32 v104, v104, v22
  v_mul_f32 v105, v105, v22
  v_mul_f32 v106, v106, v22
  v_mul_f32 v107, v107, v22
  v_mul_f32 v108, v108, v22
  v_mul_f32 v109, v109, v22
  v_mul_f32 v110, v110, v22
  v_mul_f32 v111, v111, v22
  v_mul_f32 v112, v112, v22
  v_mul_f32 v113, v113, v22
  v_mul_f32 v114, v114, v22
  v_mul_f32 v115, v115, v22
  v_mul_f32 v116, v116, v22
  v_mul_f32 v117, v117, v22
  v_mul_f32 v118, v118, v22
  v_mul_f32 v119, v119, v22
  v_mul_f32 v120, v120, v22
  v_mul_f32 v121, v121, v22
  v_mul_f32 v122, v122, v22
  v_mul_f32 v123, v123, v22
  v_mul_f32 v124, v124, v22
  v_mul_f32 v125, v125, v22
  v_mul_f32 v126, v126, v22
  v_mul_f32 v127, v127, v22
  v_accvgpr_read_b32 v25, a120
  v_mul_f32 v25, v25, v22
  v_accvgpr_write_b32 a120, v25
  s_mov_b32 s61, 0
  s_nop 1
  s_branch L_rb16
L_rr25:
  v_mov_b32 v25, v20
  s_nop 1
  v_permlane32_swap_b32 v25, v20
  v_max3_f32 v20, v25, v20, 0
  v_exp_f32 v22, -v20
  v_sub_f32 v192, v192, v20
  v_sub_f32 v193, v193, v20
  v_sub_f32 v194, v194, v20
  v_sub_f32 v195, v195, v20
  v_sub_f32 v196, v196, v20
  v_sub_f32 v197, v197, v20
  v_sub_f32 v198, v198, v20
  v_sub_f32 v199, v199, v20
  v_sub_f32 v200, v200, v20
  v_sub_f32 v201, v201, v20
  v_sub_f32 v202, v202, v20
  v_sub_f32 v203, v203, v20
  v_sub_f32 v204, v204, v20
  v_sub_f32 v205, v205, v20
  v_sub_f32 v206, v206, v20
  v_sub_f32 v207, v207, v20
  v_sub_f32 v208, v208, v20
  v_sub_f32 v209, v209, v20
  v_sub_f32 v210, v210, v20
  v_sub_f32 v211, v211, v20
  v_sub_f32 v212, v212, v20
  v_sub_f32 v213, v213, v20
  v_sub_f32 v214, v214, v20
  v_sub_f32 v215, v215, v20
  v_sub_f32 v216, v216, v20
  v_sub_f32 v217, v217, v20
  v_sub_f32 v218, v218, v20
  v_sub_f32 v219, v219, v20
  v_sub_f32 v220, v220, v20
  v_sub_f32 v221, v221, v20
  v_sub_f32 v222, v222, v20
  v_sub_f32 v223, v223, v20
  v_sub_f32 v224, v224, v20
  v_sub_f32 v225, v225, v20
  v_sub_f32 v226, v226, v20
  v_sub_f32 v227, v227, v20
  v_sub_f32 v228, v228, v20
  v_sub_f32 v229, v229, v20
  v_sub_f32 v230, v230, v20
  v_sub_f32 v231, v231, v20
  v_sub_f32 v232, v232, v20
  v_sub_f32 v233, v233, v20
  v_sub_f32 v234, v234, v20
  v_sub_f32 v235, v235, v20
  v_sub_f32 v236, v236, v20
  v_sub_f32 v237, v237, v20
  v_sub_f32 v238, v238, v20
  v_sub_f32 v239, v239, v20
  v_sub_f32 v240, v240, v20
  v_sub_f32 v241, v241, v20
  v_sub_f32 v242, v242, v20
  v_sub_f32 v243, v243, v20
  v_sub_f32 v244, v244, v20
  v_sub_f32 v245, v245, v20
  v_sub_f32 v246, v246, v20
  v_sub_f32 v247, v247, v20
  v_sub_f32 v248, v248, v20
  v_sub_f32 v249, v249, v20
  v_sub_f32 v250, v250, v20
  v_sub_f32 v251, v251, v20
  v_sub_f32 v252, v252, v20
  v_sub_f32 v253, v253, v20
  v_sub_f32 v254, v254, v20
  v_sub_f32 v255, v255, v20
  v_sub_f32 v32, v32, v20
  v_sub_f32 v33, v33, v20
  v_sub_f32 v34, v34, v20
  v_sub_f32 v35, v35, v20
  v_sub_f32 v36, v36, v20
  v_sub_f32 v37, v37, v20
  v_sub_f32 v38, v38, v20
  v_sub_f32 v39, v39, v20
  v_sub_f32 v40, v40, v20
  v_sub_f32 v41, v41, v20
  v_sub_f32 v42, v42, v20
  v_sub_f32 v43, v43, v20
  v_sub_f32 v44, v44, v20
  v_sub_f32 v45, v45, v20
  v_sub_f32 v46, v46, v20
  v_sub_f32 v47, v47, v20
  s_mov_b32 s61, 1
  s_nop 1
  s_branch L_rb26
L_rr27:
  s_nop 15
  v_mul_f32 v64, v64, v22
  v_mul_f32 v65, v65, v22
  v_mul_f32 v66, v66, v22
  v_mul_f32 v67, v67, v22
  v_mul_f32 v68, v68, v22
  v_mul_f32 v69, v69, v22
  v_mul_f32 v70, v70, v22
  v_mul_f32 v71, v71, v22
  v_mul_f32 v72, v72, v22
  v_mul_f32 v73, v73, v22
  v_mul_f32 v74, v74, v22
  v_mul_f32 v75, v75, v22
  v_mul_f32 v76, v76, v22
  v_mul_f32 v77, v77, v22
  v_mul_f32 v78, v78, v22
  v_mul_f32 v79, v79, v22
  v_mul_f32 v80, v80, v22
  v_mul_f32 v81, v81, v22
  v_mul_f32 v82, v82, v22
  v_mul_f32 v83, v83, v22
  v_mul_f32 v84, v84, v22
  v_mul_f32 v85, v85, v22
  v_mul_f32 v86, v86, v22
  v_mul_f32 v87, v87, v22
  v_mul_f32 v88, v88, v22
  v_mul_f32 v89, v89, v22
  v_mul_f32 v90, v90, v22
  v_mul_f32 v91, v91, v22
  v_mul_f32 v92, v92, v22
  v_mul_f32 v93, v93, v22
  v_mul_f32 v94, v94, v22
  v_mul_f32 v95, v95, v22
  v_mul_f32 v96, v96, v22
  v_mul_f32 v97, v97, v22
  v_mul_f32 v98, v98, v22
  v_mul_f32 v99, v99, v22
  v_mul_f32 v100, v100, v22
  v_mul_f32 v101, v101, v22
  v_mul_f32 v102, v102, v22
  v_mul_f32 v103, v103, v22
  v_mul_f32 v104, v104, v22
  v_mul_f32 v105, v105, v22
  v_mul_f32 v106, v106, v22
  v_mul_f32 v107, v107, v22
  v_mul_f32 v108, v108, v22
  v_mul_f32 v109, v109, v22
  v_mul_f32 v110, v110, v22
  v_mul_f32 v111, v111, v22
  v_mul_f32 v112, v112, v22
  v_mul_f32 v113, v113, v22
  v_mul_f32 v114, v114, v22
  v_mul_f32 v115, v115, v22
  v_mul_f32 v116, v116, v22
  v_mul_f32 v117, v117, v22
  v_mul_f32 v118, v118, v22
  v_mul_f32 v119, v119, v22
  v_mul_f32 v120, v120, v22
  v_mul_f32 v121, v121, v22
  v_mul_f32 v122, v122, v22
  v_mul_f32 v123, v123, v22
  v_mul_f32 v124, v124, v22
  v_mul_f32 v125, v125, v22
  v_mul_f32 v126, v126, v22
  v_mul_f32 v127, v127, v22
  v_accvgpr_read_b32 v25, a120
  v_mul_f32 v25, v25, v22
  v_accvgpr_write_b32 a120, v25
  s_mov_b32 s61, 0
  s_nop 1
  s_branch L_rb28
L_rr31:
  v_mov_b32 v25, v20
  s_nop 1
  v_permlane32_swap_b32 v25, v20
  v_max3_f32 v20, v25, v20, 0
  v_exp_f32 v22, -v20
  v_sub_f32 v128, v128, v20
  v_sub_f32 v129, v129, v20
  v_sub_f32 v130, v130, v20
  v_sub_f32 v131, v131, v20
  v_sub_f32 v132, v132, v20
  v_sub_f32 v133, v133, v20
  v_sub_f32 v134, v134, v20
  v_sub_f32 v135, v135, v20
  v_sub_f32 v136, v136, v20
  v_sub_f32 v137, v137, v20
  v_sub_f32 v138, v138, v20
  v_sub_f32 v139, v139, v20
  v_sub_f32 v140, v140, v20
  v_sub_f32 v141, v141, v20
  v_sub_f32 v142, v142, v20
  v_sub_f32 v143, v143, v20
  v_sub_f32 v144, v144, v20
  v_sub_f32 v145, v145, v20
  v_sub_f32 v146, v146, v20
  v_sub_f32 v147, v147, v20
  v_sub_f32 v148, v148, v20
  v_sub_f32 v149, v149, v20
  v_sub_f32 v150, v150, v20
  v_sub_f32 v151, v151, v20
  v_sub_f32 v152, v152, v20
  v_sub_f32 v153, v153, v20
  v_sub_f32 v154, v154, v20
  v_sub_f32 v155, v155, v20
  v_sub_f32 v156, v156, v20
  v_sub_f32 v157, v157, v20
  v_sub_f32 v158, v158, v20
  v_sub_f32 v159, v159, v20
  v_sub_f32 v160, v160, v20
  v_sub_f32 v161, v161, v20
  v_sub_f32 v162, v162, v20
  v_sub_f32 v163, v163, v20
  v_sub_f32 v164, v164, v20
  v_sub_f32 v165, v165, v20
  v_sub_f32 v166, v166, v20
  v_sub_f32 v167, v167, v20
  v_sub_f32 v168, v168, v20
  v_sub_f32 v169, v169, v20
  v_sub_f32 v170, v170, v20
  v_sub_f32 v171, v171, v20
  v_sub_f32 v172, v172, v20
  v_sub_f32 v173, v173, v20
  v_sub_f32 v174, v174, v20
  v_sub_f32 v175, v175, v20
  v_sub_f32 v176, v176, v20
  v_sub_f32 v177, v177, v20
  v_sub_f32 v178, v178, v20
  v_sub_f32 v179, v179, v20
  v_sub_f32 v180, v180, v20
  v_sub_f32 v181, v181, v20
  v_sub_f32 v182, v182, v20
  v_sub_f32 v183, v183, v20
  v_sub_f32 v184, v184, v20
  v_sub_f32 v185, v185, v20
  v_sub_f32 v186, v186, v20
  v_sub_f32 v187, v187, v20
  v_sub_f32 v188, v188, v20
  v_sub_f32 v189, v189, v20
  v_sub_f32 v190, v190, v20
  v_sub_f32 v191, v191, v20
  v_sub_f32 v32, v32, v20
  v_sub_f32 v33, v33, v20
  v_sub_f32 v34, v34, v20
  v_sub_f32 v35, v35, v20
  v_sub_f32 v36, v36, v20
  v_sub_f32 v37, v37, v20
  v_sub_f32 v38, v38, v20
  v_sub_f32 v39, v39, v20
  v_sub_f32 v40, v40, v20
  v_sub_f32 v41, v41, v20
  v_sub_f32 v42, v42, v20
  v_sub_f32 v43, v43, v20
  v_sub_f32 v44, v44, v20
  v_sub_f32 v45, v45, v20
  v_sub_f32 v46, v46, v20
  v_sub_f32 v47, v47, v20
  s_mov_b32 s61, 1
  s_nop 1
  s_branch L_rb32
L_rr33:
  s_nop 15
  v_mul_f32 v64, v64, v22
  v_mul_f32 v65, v65, v22
  v_mul_f32 v66, v66, v22
  v_mul_f32 v67, v67, v22
  v_mul_f32 v68, v68, v22
  v_mul_f32 v69, v69, v22
  v_mul_f32 v70, v70, v22
  v_mul_f32 v71, v71, v22
  v_mul_f32 v72, v72, v22
  v_mul_f32 v73, v73, v22
  v_mul_f32 v74, v74, v22
  v_mul_f32 v75, v75, v22
  v_mul_f32 v76, v76, v22
  v_mul_f32 v77, v77, v22
  v_mul_f32 v78, v78, v22
  v_mul_f32 v79, v79, v22
  v_mul_f32 v80, v80, v22
  v_mul_f32 v81, v81, v22
  v_mul_f32 v82, v82, v22
  v_mul_f32 v83, v83, v22
  v_mul_f32 v84, v84, v22
  v_mul_f32 v85, v85, v22
  v_mul_f32 v86, v86, v22
  v_mul_f32 v87, v87, v22
  v_mul_f32 v88, v88, v22
  v_mul_f32 v89, v89, v22
  v_mul_f32 v90, v90, v22
  v_mul_f32 v91, v91, v22
  v_mul_f32 v92, v92, v22
  v_mul_f32 v93, v93, v22
  v_mul_f32 v94, v94, v22
  v_mul_f32 v95, v95, v22
  v_mul_f32 v96, v96, v22
  v_mul_f32 v97, v97, v22
  v_mul_f32 v98, v98, v22
  v_mul_f32 v99, v99, v22
  v_mul_f32 v100, v100, v22
  v_mul_f32 v101, v101, v22
  v_mul_f32 v102, v102, v22
  v_mul_f32 v103, v103, v22
  v_mul_f32 v104, v104, v22
  v_mul_f32 v105, v105, v22
  v_mul_f32 v106, v106, v22
  v_mul_f32 v107, v107, v22
  v_mul_f32 v108, v108, v22
  v_mul_f32 v109, v109, v22
  v_mul_f32 v110, v110, v22
  v_mul_f32 v111, v111, v22
  v_mul_f32 v112, v112, v22
  v_mul_f32 v113, v113, v22
  v_mul_f32 v114, v114, v22
  v_mul_f32 v115, v115, v22
  v_mul_f32 v116, v116, v22
  v_mul_f32 v117, v117, v22
  v_mul_f32 v118, v118, v22
  v_mul_f32 v119, v119, v22
  v_mul_f32 v120, v120, v22
  v_mul_f32 v121, v121, v22
  v_mul_f32 v122, v122, v22
  v_mul_f32 v123, v123, v22
  v_mul_f32 v124, v124, v22
  v_mul_f32 v125, v125, v22
  v_mul_f32 v126, v126, v22
  v_mul_f32 v127, v127, v22
  v_accvgpr_read_b32 v25, a120
  v_mul_f32 v25, v25, v22
  v_accvgpr_write_b32 a120, v25
  s_mov_b32 s61, 0
  s_nop 1
  s_branch L_rb34
L_rr35:
  v_mov_b32 v25, v20
  s_nop 1
  v_permlane32_swap_b32 v25, v20
  v_max3_f32 v20, v25, v20, 0
  v_exp_f32 v22, -v20
  v_sub_f32 v192, v192, v20
  v_sub_f32 v193, v193, v20
  v_sub_f32 v194, v194, v20
  v_sub_f32 v195, v195, v20
  v_sub_f32 v196, v196, v20
  v_sub_f32 v197, v197, v20
  v_sub_f32 v198, v198, v20
  v_sub_f32 v199, v199, v20
  v_sub_f32 v200, v200, v20
  v_sub_f32 v201, v201, v20
  v_sub_f32 v202, v202, v20
  v_sub_f32 v203, v203, v20
  v_sub_f32 v204, v204, v20
  v_sub_f32 v205, v205, v20
  v_sub_f32 v206, v206, v20
  v_sub_f32 v207, v207, v20
  v_sub_f32 v208, v208, v20
  v_sub_f32 v209, v209, v20
  v_sub_f32 v210, v210, v20
  v_sub_f32 v211, v211, v20
  v_sub_f32 v212, v212, v20
  v_sub_f32 v213, v213, v20
  v_sub_f32 v214, v214, v20
  v_sub_f32 v215, v215, v20
  v_sub_f32 v216, v216, v20
  v_sub_f32 v217, v217, v20
  v_sub_f32 v218, v218, v20
  v_sub_f32 v219, v219, v20
  v_sub_f32 v220, v220, v20
  v_sub_f32 v221, v221, v20
  v_sub_f32 v222, v222, v20
  v_sub_f32 v223, v223, v20
  v_sub_f32 v224, v224, v20
  v_sub_f32 v225, v225, v20
  v_sub_f32 v226, v226, v20
  v_sub_f32 v227, v227, v20
  v_sub_f32 v228, v228, v20
  v_sub_f32 v229, v229, v20
  v_sub_f32 v230, v230, v20
  v_sub_f32 v231, v231, v20
  v_sub_f32 v232, v232, v20
  v_sub_f32 v233, v233, v20
  v_sub_f32 v234, v234, v20
  v_sub_f32 v235, v235, v20
  v_sub_f32 v236, v236, v20
  v_sub_f32 v237, v237, v20
  v_sub_f32 v238, v238, v20
  v_sub_f32 v239, v239, v20
  v_sub_f32 v240, v240, v20
  v_sub_f32 v241, v241, v20
  v_sub_f32 v242, v242, v20
  v_sub_f32 v243, v243, v20
  v_sub_f32 v244, v244, v20
  v_sub_f32 v245, v245, v20
  v_sub_f32 v246, v246, v20
  v_sub_f32 v247, v247, v20
  v_sub_f32 v248, v248, v20
  v_sub_f32 v249, v249, v20
  v_sub_f32 v250, v250, v20
  v_sub_f32 v251, v251, v20
  v_sub_f32 v252, v252, v20
  v_sub_f32 v253, v253, v20
  v_sub_f32 v254, v254, v20
  v_sub_f32 v255, v255, v20
  v_sub_f32 v32, v32, v20
  v_sub_f32 v33, v33, v20
  v_sub_f32 v34, v34, v20
  v_sub_f32 v35, v35, v20
  v_sub_f32 v36, v36, v20
  v_sub_f32 v37, v37, v20
  v_sub_f32 v38, v38, v20
  v_sub_f32 v39, v39, v20
  v_sub_f32 v40, v40, v20
  v_sub_f32 v41, v41, v20
  v_sub_f32 v42, v42, v20
  v_sub_f32 v43, v43, v20
  v_sub_f32 v44, v44, v20
  v_sub_f32 v45, v45, v20
  v_sub_f32 v46, v46, v20
  v_sub_f32 v47, v47, v20
  s_mov_b32 s61, 1
  s_nop 1
  s_branch L_rb36
L_rr39:
  s_nop 15
  v_mul_f32 v64, v64, v22
  v_mul_f32 v65, v65, v22
  v_mul_f32 v66, v66, v22
  v_mul_f32 v67, v67, v22
  v_mul_f32 v68, v68, v22
  v_mul_f32 v69, v69, v22
  v_mul_f32 v70, v70, v22
  v_mul_f32 v71, v71, v22
  v_mul_f32 v72, v72, v22
  v_mul_f32 v73, v73, v22
  v_mul_f32 v74, v74, v22
  v_mul_f32 v75, v75, v22
  v_mul_f32 v76, v76, v22
  v_mul_f32 v77, v77, v22
  v_mul_f32 v78, v78, v22
  v_mul_f32 v79, v79, v22
  v_mul_f32 v80, v80, v22
  v_mul_f32 v81, v81, v22
  v_mul_f32 v82, v82, v22
  v_mul_f32 v83, v83, v22
  v_mul_f32 v84, v84, v22
  v_mul_f32 v85, v85, v22
  v_mul_f32 v86, v86, v22
  v_mul_f32 v87, v87, v22
  v_mul_f32 v88, v88, v22
  v_mul_f32 v89, v89, v22
  v_mul_f32 v90, v90, v22
  v_mul_f32 v91, v91, v22
  v_mul_f32 v92, v92, v22
  v_mul_f32 v93, v93, v22
  v_mul_f32 v94, v94, v22
  v_mul_f32 v95, v95, v22
  v_mul_f32 v96, v96, v22
  v_mul_f32 v97, v97, v22
  v_mul_f32 v98, v98, v22
  v_mul_f32 v99, v99, v22
  v_mul_f32 v100, v100, v22
  v_mul_f32 v101, v101, v22
  v_mul_f32 v102, v102, v22
  v_mul_f32 v103, v103, v22
  v_mul_f32 v104, v104, v22
  v_mul_f32 v105, v105, v22
  v_mul_f32 v106, v106, v22
  v_mul_f32 v107, v107, v22
  v_mul_f32 v108, v108, v22
  v_mul_f32 v109, v109, v22
  v_mul_f32 v110, v110, v22
  v_mul_f32 v111, v111, v22
  v_mul_f32 v112, v112, v22
  v_mul_f32 v113, v113, v22
  v_mul_f32 v114, v114, v22
  v_mul_f32 v115, v115, v22
  v_mul_f32 v116, v116, v22
  v_mul_f32 v117, v117, v22
  v_mul_f32 v118, v118, v22
  v_mul_f32 v119, v119, v22
  v_mul_f32 v120, v120, v22
  v_mul_f32 v121, v121, v22
  v_mul_f32 v122, v122, v22
  v_mul_f32 v123, v123, v22
  v_mul_f32 v124, v124, v22
  v_mul_f32 v125, v125, v22
  v_mul_f32 v126, v126, v22
  v_mul_f32 v127, v127, v22
  v_accvgpr_read_b32 v25, a120
  v_mul_f32 v25, v25, v22
  v_accvgpr_write_b32 a120, v25
  s_mov_b32 s61, 0
  s_nop 1
  s_branch L_rb40
L_xr51:
  v_mov_b32 v26, v25
  s_nop 1
  v_permlane32_swap_b32 v26, v25
  v_max_f32 v25, v25, v26
  v_mov_b32 v26, v25
  s_nop 1
  v_permlane16_swap_b32 v26, v25
  v_max_f32 v25, v25, v26
  s_nop 1
  v_max_f32_dpp v25, v25, v25 row_ror:8 row_mask:0xf bank_mask:0xf
  s_nop 1
  v_max_f32_dpp v25, v25, v25 row_ror:4 row_mask:0xf bank_mask:0xf
  s_nop 1
  v_max_f32_dpp v25, v25, v25 row_ror:2 row_mask:0xf bank_mask:0xf
  s_nop 1
  v_max_f32_dpp v25, v25, v25 row_ror:1 row_mask:0xf bank_mask:0xf
  s_nop 0
  v_readfirstlane_b32 s71, v25
  s_nop 0
  s_lshr_b32 s71, s71, 23
  s_max_u32 s71, s71, 1
  s_min_u32 s71, s71, 239
  s_sub_u32 s64, 254, s71
  s_lshl_b32 s64, s64, 23
  s_add_u32 s65, s71, 15
  s_lshl_b32 s65, s65, 23
  s_sub_i32 s66, s71, 8
  s_max_i32 s66, s66, 0
  s_lshl_b32 s66, s66, 23
  s_bfe_u32 s72, s71, 131072
  s_lshl_b32 s72, s72, 16
  s_or_b32 s67, s72, s80
  s_bfe_u32 s72, s71, 131074
  s_lshl_b32 s72, s72, 16
  s_or_b32 s68, s72, s81
  s_bfe_u32 s72, s71, 131076
  s_lshl_b32 s72, s72, 16
  s_or_b32 s69, s72, s82
  s_bfe_u32 s72, s71, 131078
  s_lshl_b32 s72, s72, 16
  s_or_b32 s70, s72, s83
  s_branch L_xb52
L_xr55:
  v_mov_b32 v26, v25
  s_nop 1
  v_permlane32_swap_b32 v26, v25
  v_max_f32 v25, v25, v26
  v_mov_b32 v26, v25
  s_nop 1
  v_permlane16_swap_b32 v26, v25
  v_max_f32 v25, v25, v26
  s_nop 1
  v_max_f32_dpp v25, v25, v25 row_ror:8 row_mask:0xf bank_mask:0xf
  s_nop 1
  v_max_f32_dpp v25, v25, v25 row_ror:4 row_mask:0xf bank_mask:0xf
  s_nop 1
  v_max_f32_dpp v25, v25, v25 row_ror:2 row_mask:0xf bank_mask:0xf
  s_nop 1
  v_max_f32_dpp v25, v25, v25 row_ror:1 row_mask:0xf bank_mask:0xf
  s_nop 0
  v_readfirstlane_b32 s71, v25
  s_nop 0
  s_lshr_b32 s71, s71, 23
  s_max_u32 s71, s71, 1
  s_min_u32 s71, s71, 239
  s_sub_u32 s64, 254, s71
  s_lshl_b32 s64, s64, 23
  s_add_u32 s65, s71, 15
  s_lshl_b32 s65, s65, 23
  s_sub_i32 s66, s71, 8
  s_max_i32 s66, s66, 0
  s_lshl_b32 s66, s66, 23
  s_bfe_u32 s72, s71, 131072
  s_lshl_b32 s72, s72, 16
  s_or_b32 s67, s72, s80
  s_bfe_u32 s72, s71, 131074
  s_lshl_b32 s72, s72, 16
  s_or_b32 s68, s72, s81
  s_bfe_u32 s72, s71, 131076
  s_lshl_b32 s72, s72, 16
  s_or_b32 s69, s72, s82
  s_bfe_u32 s72, s71, 131078
  s_lshl_b32 s72, s72, 16
  s_or_b32 s70, s72, s83
  s_branch L_xb56
L_xr59:
  v_mov_b32 v26, v25
  s_nop 1
  v_permlane32_swap_b32 v26, v25
  v_max_f32 v25, v25, v26
  v_mov_b32 v26, v25
  s_nop 1
  v_permlane16_swap_b32 v26, v25
  v_max_f32 v25, v25, v26
  s_nop 1
  v_max_f32_dpp v25, v25, v25 row_ror:8 row_mask:0xf bank_mask:0xf
  s_nop 1
  v_max_f32_dpp v25, v25, v25 row_ror:4 row_mask:0xf bank_mask:0xf
  s_nop 1
  v_max_f32_dpp v25, v25, v25 row_ror:2 row_mask:0xf bank_mask:0xf
  s_nop 1
  v_max_f32_dpp v25, v25, v25 row_ror:1 row_mask:0xf bank_mask:0xf
  s_nop 0
  v_readfirstlane_b32 s71, v25
  s_nop 0
  s_lshr_b32 s71, s71, 23
  s_max_u32 s71, s71, 1
  s_min_u32 s71, s71, 239
  s_sub_u32 s64, 254, s71
  s_lshl_b32 s64, s64, 23
  s_add_u32 s65, s71, 15
  s_lshl_b32 s65, s65, 23
  s_sub_i32 s66, s71, 8
  s_max_i32 s66, s66, 0
  s_lshl_b32 s66, s66, 23
  s_bfe_u32 s72, s71, 131072
  s_lshl_b32 s72, s72, 16
  s_or_b32 s67, s72, s80
  s_bfe_u32 s72, s71, 131074
  s_lshl_b32 s72, s72, 16
  s_or_b32 s68, s72, s81
  s_bfe_u32 s72, s71, 131076
  s_lshl_b32 s72, s72, 16
  s_or_b32 s69, s72, s82
  s_bfe_u32 s72, s71, 131078
  s_lshl_b32 s72, s72, 16
  s_or_b32 s70, s72, s83
  s_branch L_xb60
L_xr63:
  v_mov_b32 v26, v25
  s_nop 1
  v_permlane32_swap_b32 v26, v25
  v_max_f32 v25, v25, v26
  v_mov_b32 v26, v25
  s_nop 1
  v_permlane16_swap_b32 v26, v25
  v_max_f32 v25, v25, v26
  s_nop 1
  v_max_f32_dpp v25, v25, v25 row_ror:8 row_mask:0xf bank_mask:0xf
  s_nop 1
  v_max_f32_dpp v25, v25, v25 row_ror:4 row_mask:0xf bank_mask:0xf
  s_nop 1
  v_max_f32_dpp v25, v25, v25 row_ror:2 row_mask:0xf bank_mask:0xf
  s_nop 1
  v_max_f32_dpp v25, v25, v25 row_ror:1 row_mask:0xf bank_mask:0xf
  s_nop 0
  v_readfirstlane_b32 s71, v25
  s_nop 0
  s_lshr_b32 s71, s71, 23
  s_max_u32 s71, s71, 1
  s_min_u32 s71, s71, 239
  s_sub_u32 s64, 254, s71
  s_lshl_b32 s64, s64, 23
  s_add_u32 s65, s71, 15
  s_lshl_b32 s65, s65, 23
  s_sub_i32 s66, s71, 8
  s_max_i32 s66, s66, 0
  s_lshl_b32 s66, s66, 23
  s_bfe_u32 s72, s71, 131072
  s_lshl_b32 s72, s72, 16
  s_or_b32 s67, s72, s80
  s_bfe_u32 s72, s71, 131074
  s_lshl_b32 s72, s72, 16
  s_or_b32 s68, s72, s81
  s_bfe_u32 s72, s71, 131076
  s_lshl_b32 s72, s72, 16
  s_or_b32 s69, s72, s82
  s_bfe_u32 s72, s71, 131078
  s_lshl_b32 s72, s72, 16
  s_or_b32 s70, s72, s83
  s_branch L_xb64
L_xr83:
  v_mov_b32 v26, v25
  s_nop 1
  v_permlane32_swap_b32 v26, v25
  v_max_f32 v25, v25, v26
  v_mov_b32 v26, v25
  s_nop 1
  v_permlane16_swap_b32 v26, v25
  v_max_f32 v25, v25, v26
  s_nop 1
  v_max_f32_dpp v25, v25, v25 row_ror:8 row_mask:0xf bank_mask:0xf
  s_nop 1
  v_max_f32_dpp v25, v25, v25 row_ror:4 row_mask:0xf bank_mask:0xf
  s_nop 1
  v_max_f32_dpp v25, v25, v25 row_ror:2 row_mask:0xf bank_mask:0xf
  s_nop 1
  v_max_f32_dpp v25, v25, v25 row_ror:1 row_mask:0xf bank_mask:0xf
  s_nop 0
  v_readfirstlane_b32 s71, v25
  s_nop 0
  s_lshr_b32 s71, s71, 23
  s_max_u32 s71, s71, 1
  s_min_u32 s71, s71, 239
  s_sub_u32 s64, 254, s71
  s_lshl_b32 s64, s64, 23
  s_add_u32 s65, s71, 15
  s_lshl_b32 s65, s65, 23
  s_sub_i32 s66, s71, 8
  s_max_i32 s66, s66, 0
  s_lshl_b32 s66, s66, 23
  s_bfe_u32 s72, s71, 131072
  s_lshl_b32 s72, s72, 16
  s_or_b32 s67, s72, s80
  s_bfe_u32 s72, s71, 131074
  s_lshl_b32 s72, s72, 16
  s_or_b32 s68, s72, s81
  s_bfe_u32 s72, s71, 131076
  s_lshl_b32 s72, s72, 16
  s_or_b32 s69, s72, s82
  s_bfe_u32 s72, s71, 131078
  s_lshl_b32 s72, s72, 16
  s_or_b32 s70, s72, s83
  s_branch L_xb84
L_done:
  s_endpgm
.section .rodata,"a"
.p2align 6
.amdhsa_kernel standalone__gqa_block_cached__near_ridge_kernel
  .amdhsa_next_free_vgpr 512
  .amdhsa_next_free_sgpr 102
  .amdhsa_accum_offset 256
  .amdhsa_group_segment_fixed_size 0
  .amdhsa_kernarg_size 64
  .amdhsa_user_sgpr_count 2
  .amdhsa_user_sgpr_kernarg_segment_ptr 1
  .amdhsa_system_sgpr_workgroup_id_x 1
.end_amdhsa_kernel
```
